```python
import torch

def _softmax(x, axis=-1):
    return torch.softmax(x, dim=axis)

def _gelu(x):
    return torch.nn.functional.gelu(x, approximate='tanh')

def _silu(x):
    return torch.nn.functional.silu(x)

def _sigmoid(x):
    return torch.sigmoid(x)

def _layernorm(x, axis=-1, eps=1e-05):
    m = x.mean(dim=axis, keepdim=True)
    v = x.var(dim=axis, keepdim=True, unbiased=False)
    return (x - m) / torch.sqrt(v + eps)

def _scatter_add(tgt, idx, src, axis=0):
    return tgt.clone().index_add_(axis, idx, src)

def _segment_sum(src, seg, n):
    out = torch.zeros((n,) + src.shape[1:], dtype=src.dtype)
    return out.index_add_(0, seg, src)

def _pad(x, pw):
    flat = tuple((v for pair in reversed(pw) for v in pair))
    return torch.nn.functional.pad(x, flat)
kernel_name = 'adaLN_cond__ssm_conv_h3__glu_gated_geglu__prompt'

def setup_inputs():

    _w = lambda a: (lambda t: t.to(torch.bfloat16) if t.is_floating_point() else t)(torch.as_tensor(a))

    def _A_setup():
        B, S, D = (1, 2048, 576)
        ks = 4
        return {'q': _w((lambda *s: torch.randn(*s, dtype=torch.bfloat16) * 0.05)(B, S, D)), 'k': _w((lambda *s: torch.randn(*s, dtype=torch.bfloat16) * 0.8)(B, S, D)), 'v': _w((lambda *s: torch.randn(*s, dtype=torch.bfloat16) * 0.8)(B, S, D)), 'shift_k': _w((lambda *s: torch.randn(*s, dtype=torch.bfloat16) * 0.8)(D, ks) * 0.5), 'ssm_k': _w((lambda *s: torch.randn(*s, dtype=torch.bfloat16) * 0.8)(D, S) * (1.0 / S ** 0.5)), 'ssm_D': _w((lambda *s: torch.randn(*s, dtype=torch.bfloat16) * 0.8)(D))}
    _A_in = _A_setup()

    def _B_setup():
        B, S, Dm, Df = (1, 2048, 576, 4608)
        return {'x': _w((lambda *s: torch.randn(*s, dtype=torch.bfloat16) * 0.05)(B, S, Dm)), 'w_gate': _w((lambda *s: torch.randn(*s, dtype=torch.bfloat16) * 1.6)(Dm, Df) * Dm ** (-0.5)), 'w_up': _w((lambda *s: torch.randn(*s, dtype=torch.bfloat16) * 1.6)(Dm, Df) * Dm ** (-0.5)), 'w_down': _w((lambda *s: torch.randn(*s, dtype=torch.bfloat16) * 1.6)(Df, Dm) * Df ** (-0.5))}
    _B_in = _B_setup()
    return {'A_q': _A_in['q'], 'A_k': _A_in['k'], 'A_v': _A_in['v'], 'A_shift_k': _A_in['shift_k'], 'A_ssm_k': _A_in['ssm_k'], 'A_ssm_D': _A_in['ssm_D'], 'B_x': _B_in['x'], 'B_w_gate': _B_in['w_gate'], 'B_w_up': _B_in['w_up'], 'B_w_down': _B_in['w_down'], 'c': _w((lambda *s: torch.randn(*s, dtype=torch.bfloat16) * 0.1)(1, 576) * 8.0), 'w_mod': _w((lambda *s: torch.randn(*s, dtype=torch.bfloat16) * 0.1)(576, 6 * 576) * 576 ** (-0.5) * 8.0)}

def reference(A_q, A_k, A_v, A_shift_k, A_ssm_k, A_ssm_D, B_x, B_w_gate, B_w_up, B_w_down, c, w_mod):

    def _A_ref(q, k, v, shift_k, ssm_k, ssm_D):
        B, S, D = q.shape
        ks = shift_k.shape[-1]
        k_pad = _pad(k, ((0, 0), (ks - 1, 0), (0, 0)))
        k_shift = torch.zeros_like(k)
        for t in range(ks):
            k_shift = k_shift + k_pad[:, t:t + S, :] * shift_k[:, ks - 1 - t][None, None, :]
        kv = k_shift * v
        L = 2 * S
        kv_pad = _pad(kv, ((0, 0), (0, S), (0, 0)))
        kf_pad = _pad(ssm_k, ((0, 0), (0, S)))
        kv_f = (lambda x, axes=(-2, -1): torch.fft.rfft2(x.float(), dim=axes))(kv_pad[:, None, :, :], axes=(1, 2))
        kf_f = (lambda x, axes=(-2, -1): torch.fft.rfft2(x.float(), dim=axes))(kf_pad[:, None, :], axes=(1, 2))
        kf_f = (lambda x, *d: x.permute(*d))(kf_f, 1, 2, 0)
        y_f = kv_f * kf_f[None, :, :, :]
        y = (lambda x, s, axes=(-2, -1): torch.fft.irfft2(x, s=s, dim=axes).to(torch.bfloat16))(y_f, (1, L), axes=(1, 2))[:, 0, :S, :]
        y = y + kv * ssm_D[None, None, :]
        return q * y

    def _B_ref(x, w_gate, w_up, w_down):
        g = torch.einsum('bsd,df->bsf', x, w_gate)
        u = torch.einsum('bsd,df->bsf', x, w_up)
        h = _gelu(g) * u
        return torch.einsum('bsf,fd->bsd', h, w_down)
    x = A_q
    mod = (_silu(c) @ w_mod).reshape(c.shape[0], 6, 1, -1)
    sa, ca, ga, sb, cb, gb = (mod[:, 0].clone(), mod[:, 1].clone(), mod[:, 2].clone(), mod[:, 3].clone(), mod[:, 4].clone(), mod[:, 5].clone())
    h = _layernorm(x, axis=-1) * (1 + ca) + sa
    x = x + ga * _A_ref(h, A_k, A_v, A_shift_k, A_ssm_k, A_ssm_D)
    h = _layernorm(x, axis=-1) * (1 + cb) + sb
    x = x + gb * _B_ref(h, B_w_gate, B_w_up, B_w_down)
    return x
```

```asm
; @launch grid=(256,1,1) block=(256,1,1) lds=163328
.amdgcn_target "amdgcn-amd-amdhsa--gfx950"
.text
.globl adaLN_cond__ssm_conv_h3__glu_gated_geglu__prompt_kernel
.p2align 8
.type adaLN_cond__ssm_conv_h3__glu_gated_geglu__prompt_kernel,@function
adaLN_cond__ssm_conv_h3__glu_gated_geglu__prompt_kernel:
  s_cmp_ge_u32 s2, 256
  s_cbranch_scc1 L_end
  s_load_dwordx16 s[64:79], s[0:1], 0
  s_load_dwordx8 s[80:87], s[0:1], 64
  s_load_dwordx4 s[88:91], s[0:1], 96
  s_load_dwordx2 s[92:93], s[0:1], 112
  s_getpc_b64 s[4:5]
L_pc_1:
  s_add_u32 s56, s4, L_start-L_pc_1
  s_addc_u32 s57, s5, 0
  s_mov_b32 s58, L_common-L_start
  s_mov_b32 s59, 0x20000
L_start:
  v_lshlrev_b32 v1, 7, v0
  v_lshrrev_b32 v2, 6, v0
  v_and_b32 v254, 63, v0
  buffer_load_dword v238, v1, s[56:59], 0 offen
  v_readfirstlane_b32 s95, v2
  s_cmp_ge_u32 s2, 144
  s_cbranch_scc1 L_side
  s_lshr_b32 s40, s2, 4
  s_and_b32 s41, s2, 15
  v_and_b32 v1, 7, v0
  v_lshrrev_b32 v2, 3, v0
  s_lshl_b32 s42, s41, 7
  s_lshl_b32 s43, s40, 7
  v_lshl_add_u32 v3, v2, 2, s42
  v_mul_u32_u24 v3, 1152, v3
  v_lshl_add_u32 v4, v1, 4, s43
  v_add_u32 v13, v3, v4
  v_add_u32 v10, 0xfffff280, v13
  v_add_u32 v11, 0xfffff700, v13
  v_add_u32 v12, 0xfffffb80, v13
  v_lshlrev_b32 v5, 2, v4
  s_waitcnt lgkmcnt(0)
  s_mov_b32 s52, s66
  s_mov_b32 s53, s67
  s_mov_b32 s54, 0x240000
  s_mov_b32 s55, 0x20000
  s_mov_b32 s56, s68
  s_mov_b32 s57, s69
  s_mov_b32 s58, 0x240000
  s_mov_b32 s59, 0x20000
  s_mov_b32 s20, s70
  s_mov_b32 s21, s71
  s_mov_b32 s22, 0x1200
  s_mov_b32 s23, 0x20000
  buffer_load_dwordx4 v[28:31], v13, s[52:55], 0 offen nt
  buffer_load_dwordx4 v[32:35], v13, s[52:55], 0 offen offset:1152 nt
  buffer_load_dwordx4 v[36:39], v13, s[52:55], 0 offen offset:2304 nt
  buffer_load_dwordx4 v[40:43], v13, s[52:55], 0 offen offset:3456 nt
  buffer_load_dwordx4 v[16:19], v10, s[52:55], 0 offen nt
  buffer_load_dwordx4 v[20:23], v11, s[52:55], 0 offen nt
  buffer_load_dwordx4 v[24:27], v12, s[52:55], 0 offen nt
  buffer_load_dwordx4 v[60:63], v5, s[20:23], 0 offen
  buffer_load_dwordx4 v[64:67], v5, s[20:23], 0 offen offset:16
  buffer_load_dwordx4 v[68:71], v5, s[20:23], 0 offen offset:32
  buffer_load_dwordx4 v[72:75], v5, s[20:23], 0 offen offset:48
  buffer_load_dwordx4 v[44:47], v13, s[56:59], 0 offen nt
  buffer_load_dwordx4 v[48:51], v13, s[56:59], 0 offen offset:1152 nt
  buffer_load_dwordx4 v[52:55], v13, s[56:59], 0 offen offset:2304 nt
  buffer_load_dwordx4 v[56:59], v13, s[56:59], 0 offen offset:3456 nt
  s_lshr_b32 s3, s2, 3
  s_lshr_b32 s49, s3, 1
  s_add_u32 s6, s49, 7
  s_sub_u32 s7, s49, 9
  s_cmp_lt_u32 s7, 7
  s_cselect_b32 s7, s7, s49
  s_cmp_lt_u32 s49, 9
  s_cselect_b32 s49, s6, s7
  s_and_b32 s3, s3, 1
  s_and_b32 s50, s2, 7
  s_lshl_b32 s50, s50, 1
  s_add_u32 s50, s50, s3
  s_mov_b32 s97, 0x3f803f80
  s_cmp_eq_u32 s95, 0
  s_cselect_b32 s51, 0, 0x40000000
  s_add_u32 s4, s92, 0xa00000
  s_addc_u32 s5, s93, 0
  s_load_dword s28, s[4:5], 0
  s_add_u32 s60, s92, 0xa10000
  s_addc_u32 s61, s93, 0
  s_mov_b32 s62, 0x120000
  s_mov_b32 s63, 0x20000
  s_lshl_b32 s44, s2, 2
  s_add_u32 s44, s44, s95
  s_mul_i32 s45, s95, 21248
  s_lshl_b32 s46, s44, 12
  s_add_u32 s52, s72, s46
  s_addc_u32 s53, s73, 0
  s_mov_b32 s54, 4096
  s_mov_b32 s55, 0x20000
  v_lshrrev_b32 v144, 4, v254
  v_and_b32 v145, 15, v254
  v_add_u32 v142, v144, v145
  v_add_u32 v142, -16, v142
  v_lshlrev_b32 v142, 1, v142
  s_lshl_b32 s3, s44, 1
  s_mov_b32 s56, s74
  s_mov_b32 s57, s75
  s_mov_b32 s58, 0x480
  s_mov_b32 s59, 0x20000
  v_lshlrev_b32 v143, 4, v254
  s_mov_b32 s91, s3
  s_mov_b32 s24, s92
  s_mov_b32 s25, s93
  s_mov_b32 s26, 0x240000
  s_mov_b32 s27, 0x20000
  v_lshlrev_b32 v6, 9, v2
  v_lshl_add_u32 v6, v1, 4, v6
  v_add_u32 v6, 84992, v6
  v_bfe_u32 v7, v254, 1, 1
  v_lshl_add_u32 v7, v144, 1, v7
  v_lshlrev_b32 v7, 3, v7
  v_bfe_u32 v8, v254, 2, 2
  v_sub_u32 v7, v7, v8
  v_add_u32 v7, 3, v7
  v_lshlrev_b32 v7, 7, v7
  v_and_b32 v8, 1, v254
  v_lshl_add_u32 v7, v8, 3, v7
  s_lshl_b32 s3, s95, 5
  s_add_u32 s3, s3, 84992
  v_add_u32 v7, s3, v7
  s_lshl_b32 s3, s40, 6
  s_lshl_b32 s47, s95, 4
  s_add_u32 s3, s3, s47
  v_and_b32 v8, 7, v254
  v_add_u32 v8, s3, v8
  v_lshlrev_b32 v8, 12, v8
  v_bfe_u32 v9, v254, 3, 1
  v_lshl_add_u32 v9, v144, 1, v9
  v_lshl_add_u32 v8, v9, 4, v8
  s_lshl_b32 s3, s41, 8
  v_add_u32 v8, s3, v8
  v_add_u32 v9, 0x8000, v8
  v_mov_b32 v146, 0
  v_mov_b32 v147, 0
  v_lshl_add_u32 v148, v254, 3, s45
  ds_write_b64 v148, v[146:147] offset:16640
  v_mul_u32_u24 v214, 4160, v144
  v_lshl_add_u32 v214, v145, 1, v214
  v_add_u32 v214, s45, v214
  v_add_u32 v14, 1, v145
  v_and_b32 v192, 3, v14
  v_mul_u32_u24 v192, 4160, v192
  v_lshrrev_b32 v14, 2, v14
  v_lshl_add_u32 v192, v14, 3, v192
  v_lshlrev_b32 v14, 4, v144
  v_sub_u32 v192, v192, v14
  v_add_u32 v192, 48, v192
  v_add_u32 v192, s45, v192
  v_lshlrev_b32 v193, 5, v145
  v_lshl_add_u32 v193, v144, 4, v193
  s_add_u32 s3, s45, 16672
  v_add_u32 v193, s3, v193
  v_lshlrev_b32 v194, 4, v145
  v_lshl_add_u32 v194, v144, 2, v194
  s_mul_i32 s3, s95, 4160
  s_add_u32 s3, s3, 84992
  v_add_u32 v194, s3, v194
  v_bfe_u32 v195, v254, 2, 2
  v_mul_u32_u24 v195, 4160, v195
  v_lshl_add_u32 v195, v144, 5, v195
  v_and_b32 v14, 3, v254
  v_lshl_add_u32 v195, v14, 3, v195
  s_lshl_b32 s3, s95, 7
  s_add_u32 s3, s3, 84992
  v_add_u32 v195, s3, v195
  s_lshl_b32 s3, s2, 14
  s_lshl_b32 s47, s95, 10
  s_add_u32 s3, s3, s47
  v_lshl_add_u32 v211, v254, 4, s3
  v_lshlrev_b32 v212, 4, v254
  v_lshlrev_b32 v213, 7, v145
  s_lshr_b32 s4, s50, 1
  s_and_b32 s6, s50, 1
  s_mul_i32 s7, s4, 576
  s_mul_i32 s8, s6, 320
  s_add_u32 s8, s8, s7
  s_lshl_b32 s9, s6, 5
  s_add_u32 s9, s9, s7
  s_add_u32 s9, s9, 256
  s_lshl_b32 s31, s8, 1
  s_lshl_b32 s32, s9, 1
  s_lshl_b32 s10, s49, 2
  s_add_u32 s10, s10, s95
  s_mul_i32 s38, s10, 36864
  s_mul_i32 s29, s95, 6144
  s_lshl_b32 s30, s95, 10
  s_mov_b32 s37, 0xc09d30fc
  s_and_b32 s4, s95, 1
  s_mul_i32 s5, s4, 442368
  s_mul_i32 s6, s4, 884736
  s_mul_i32 s7, s95, 9216
  v_lshlrev_b32 v225, 4, v254
  v_lshrrev_b32 v100, 3, v254
  v_bfe_u32 v101, v254, 4, 1
  v_lshlrev_b32 v101, 1, v101
  v_and_b32 v102, 7, v254
  v_xor_b32 v101, v101, v102
  v_lshlrev_b32 v101, 4, v101
  v_mul_u32_u24 v103, 9216, v100
  v_add_u32 v103, s5, v103
  v_add_u32 v216, v103, v101
  v_xor_b32 v101, 64, v101
  v_add_u32 v217, v103, v101
  v_add_u32 v218, 145408, v216
  v_add_u32 v219, 218112, v217
  v_add_u32 v217, 72704, v217
  s_cmp_ge_u32 s95, 2
  s_cselect_b32 s12, s80, s78
  s_cselect_b32 s13, s81, s79
  s_mov_b32 s14, 0x510000
  s_mov_b32 s15, 0x20000
  s_mov_b32 s16, s82
  s_mov_b32 s17, s83
  s_mov_b32 s18, 0x510000
  s_mov_b32 s19, 0x20000
  v_lshrrev_b32 v100, 2, v254
  v_mul_u32_u24 v103, 9216, v100
  v_add_u32 v103, s6, v103
  v_and_b32 v100, 3, v254
  v_lshrrev_b32 v101, 5, v254
  v_lshlrev_b32 v101, 1, v101
  v_xor_b32 v100, v100, v101
  v_lshl_add_u32 v220, v100, 4, v103
  v_add_u32 v221, 146432, v220
  v_add_u32 v222, 292864, v220
  v_add_u32 v223, 439296, v220
  v_lshrrev_b32 v100, 3, v254
  v_mul_u32_u24 v101, 1152, v100
  v_add_u32 v101, s7, v101
  v_and_b32 v100, 6, v100
  v_and_b32 v102, 7, v254
  v_xor_b32 v100, v100, v102
  v_lshl_add_u32 v224, v100, 4, v101
  v_lshrrev_b32 v102, 4, v254
  v_bfe_u32 v100, v254, 2, 2
  v_and_b32 v103, 3, v254
  v_lshlrev_b32 v103, 3, v103
  v_lshl_add_u32 v101, v102, 3, v100
  v_lshl_add_u32 v208, v101, 7, v103
  v_lshl_add_u32 v209, v101, 6, v103
  v_lshl_add_u32 v101, v102, 2, v100
  v_lshl_add_u32 v210, v101, 7, v103
  v_bfe_u32 v101, v101, 1, 2
  v_lshl_add_u32 v210, v101, 5, v210
  v_and_b32 v102, 1, v102
  v_lshl_add_u32 v209, v102, 5, v209
  v_lshrrev_b32 v100, 1, v100
  v_lshl_add_u32 v100, v102, 1, v100
  v_lshl_add_u32 v208, v100, 5, v208
  v_add_u32 v226, 0, v208
  v_xor_b32 v227, 32, v226
  v_xor_b32 v228, 64, v226
  v_xor_b32 v229, 96, v226
  v_add_u32 v230, 49152, v208
  v_xor_b32 v231, 32, v230
  v_xor_b32 v232, 64, v230
  v_xor_b32 v233, 96, v230
  v_add_u32 v234, 98304, v208
  v_xor_b32 v235, 32, v234
  v_xor_b32 v236, 64, v234
  v_xor_b32 v237, 96, v234
  v_add_u32 v204, 0, v209
  v_xor_b32 v205, 32, v204
  v_add_u32 v206, 49152, v209
  v_xor_b32 v207, 32, v206
  v_lshrrev_b32 v100, 4, v254
  v_bfe_u32 v101, v254, 2, 2
  v_lshl_add_u32 v101, v100, 2, v101
  v_and_b32 v102, 3, v254
  v_lshlrev_b32 v103, 3, v102
  v_lshl_add_u32 v208, v101, 6, v103
  v_and_b32 v100, 1, v100
  v_lshl_add_u32 v208, v100, 5, v208
  v_lshlrev_b32 v100, 1, v100
  v_xor_b32 v102, v102, v100
  v_lshrrev_b32 v101, 2, v254
  s_lshl_b32 s4, s95, 4
  v_add_u32 v101, s4, v101
  v_mul_u32_u24 v101, 1152, v101
  v_lshl_add_u32 v209, v102, 4, v101
  s_mov_b32 s4, s49
  s_and_b32 s4, s4, 15
  s_mul_i32 s4, s4, 84
  s_and_b32 s5, s95, 1
  s_mul_i32 s5, s5, 42
  s_add_u32 s4, s4, s5
  v_min_u32 v215, 41, v254
  v_add_u32 v215, s4, v215
  v_mul_u32_u24 v215, 9216, v215
  s_lshl_b32 s3, s49, 4
  s_add_u32 s3, s3, s50
  s_lshl_b32 s3, s3, 3
  v_and_b32 v100, 7, v254
  v_add_u32 v100, s3, v100
  v_bfe_u32 v101, v254, 3, 1
  v_lshlrev_b32 v101, 2, v101
  v_bfe_u32 v102, v254, 5, 1
  v_lshl_add_u32 v101, v102, 1, v101
  v_bfe_u32 v102, v254, 4, 1
  v_add_u32 v101, v101, v102
  s_lshr_b32 s3, s95, 1
  s_mul_i32 s3, s3, 3
  s_add_u32 s3, s3, s95
  s_lshl_b32 s3, s3, 3
  v_add_u32 v101, s3, v101
  v_lshlrev_b32 v200, 15, v101
  v_lshl_add_u32 v200, v100, 3, v200
  v_lshlrev_b32 v201, 5, v101
  v_add_u32 v201, 148480, v201
  v_lshrrev_b32 v202, 4, v100
  v_mul_u32_u24 v202, 18432, v202
  v_lshl_add_u32 v202, v101, 8, v202
  v_and_b32 v102, 15, v100
  v_lshl_add_u32 v202, v102, 4, v202
  s_lshl_b32 s3, s49, 2
  s_add_u32 s3, s3, s95
  s_mul_i32 s3, s3, 36
  v_min_u32 v203, 35, v254
  v_add_u32 v203, s3, v203
  v_lshlrev_b32 v203, 7, v203
  s_waitcnt vmcnt(4)
  v_lshlrev_b32 v80, 16, v60
  v_lshlrev_b32 v81, 16, v62
  v_and_b32 v82, 0xffff0000, v60
  v_and_b32 v83, 0xffff0000, v62
  v_lshlrev_b32 v84, 16, v61
  v_lshlrev_b32 v85, 16, v63
  v_and_b32 v86, 0xffff0000, v61
  v_and_b32 v87, 0xffff0000, v63
  v_lshlrev_b32 v88, 16, v16
  v_and_b32 v89, 0xffff0000, v16
  v_lshlrev_b32 v90, 16, v20
  v_and_b32 v91, 0xffff0000, v20
  v_lshlrev_b32 v92, 16, v24
  v_and_b32 v93, 0xffff0000, v24
  v_lshlrev_b32 v94, 16, v28
  v_and_b32 v95, 0xffff0000, v28
  v_lshlrev_b32 v96, 16, v32
  v_and_b32 v97, 0xffff0000, v32
  v_lshlrev_b32 v98, 16, v36
  v_and_b32 v99, 0xffff0000, v36
  v_lshlrev_b32 v100, 16, v40
  v_and_b32 v101, 0xffff0000, v40
  v_pk_mul_f32 v[110:111], v[88:89], v[86:87]
  v_pk_mul_f32 v[112:113], v[90:91], v[86:87]
  v_pk_mul_f32 v[114:115], v[92:93], v[86:87]
  v_pk_mul_f32 v[116:117], v[94:95], v[86:87]
  v_pk_fma_f32 v[110:111], v[90:91], v[84:85], v[110:111]
  v_pk_fma_f32 v[112:113], v[92:93], v[84:85], v[112:113]
  v_pk_fma_f32 v[114:115], v[94:95], v[84:85], v[114:115]
  v_pk_fma_f32 v[116:117], v[96:97], v[84:85], v[116:117]
  v_pk_fma_f32 v[110:111], v[92:93], v[82:83], v[110:111]
  v_pk_fma_f32 v[112:113], v[94:95], v[82:83], v[112:113]
  v_pk_fma_f32 v[114:115], v[96:97], v[82:83], v[114:115]
  v_pk_fma_f32 v[116:117], v[98:99], v[82:83], v[116:117]
  v_pk_fma_f32 v[110:111], v[94:95], v[80:81], v[110:111]
  v_pk_fma_f32 v[112:113], v[96:97], v[80:81], v[112:113]
  v_pk_fma_f32 v[114:115], v[98:99], v[80:81], v[114:115]
  v_pk_fma_f32 v[116:117], v[100:101], v[80:81], v[116:117]
  s_waitcnt vmcnt(0)
  buffer_load_ushort v140, v142, s[52:55], 0 offen
  buffer_load_ushort v141, off, s[56:59], s91
  buffer_load_dwordx4 v[152:155], v143, s[52:55], 0 offen offset:0
  buffer_load_dwordx2 v[156:157], v143, s[52:55], 0 offen offset:16
  buffer_load_dwordx4 v[158:161], v143, s[52:55], 0 offen offset:1024
  buffer_load_dwordx2 v[162:163], v143, s[52:55], 0 offen offset:1040
  buffer_load_dwordx4 v[164:167], v143, s[52:55], 0 offen offset:2048
  buffer_load_dwordx2 v[168:169], v143, s[52:55], 0 offen offset:2064
  buffer_load_dwordx4 v[170:173], v143, s[52:55], 0 offen offset:3072
  buffer_load_dwordx2 v[174:175], v143, s[52:55], 0 offen offset:3088
  v_lshlrev_b32 v102, 16, v44
  v_and_b32 v103, 0xffff0000, v44
  v_lshlrev_b32 v104, 16, v48
  v_and_b32 v105, 0xffff0000, v48
  v_lshlrev_b32 v106, 16, v52
  v_and_b32 v107, 0xffff0000, v52
  v_lshlrev_b32 v108, 16, v56
  v_and_b32 v109, 0xffff0000, v56
  v_pk_mul_f32 v[110:111], v[110:111], v[102:103]
  v_pk_mul_f32 v[112:113], v[112:113], v[104:105]
  v_pk_mul_f32 v[114:115], v[114:115], v[106:107]
  v_pk_mul_f32 v[116:117], v[116:117], v[108:109]
  v_cvt_pk_bf16_f32 v120, v110, v111
  v_cvt_pk_bf16_f32 v124, v112, v113
  v_cvt_pk_bf16_f32 v128, v114, v115
  v_cvt_pk_bf16_f32 v132, v116, v117
  v_lshlrev_b32 v80, 16, v64
  v_lshlrev_b32 v81, 16, v66
  v_and_b32 v82, 0xffff0000, v64
  v_and_b32 v83, 0xffff0000, v66
  v_lshlrev_b32 v84, 16, v65
  v_lshlrev_b32 v85, 16, v67
  v_and_b32 v86, 0xffff0000, v65
  v_and_b32 v87, 0xffff0000, v67
  v_lshlrev_b32 v88, 16, v17
  v_and_b32 v89, 0xffff0000, v17
  v_lshlrev_b32 v90, 16, v21
  v_and_b32 v91, 0xffff0000, v21
  v_lshlrev_b32 v92, 16, v25
  v_and_b32 v93, 0xffff0000, v25
  v_lshlrev_b32 v94, 16, v29
  v_and_b32 v95, 0xffff0000, v29
  v_lshlrev_b32 v96, 16, v33
  v_and_b32 v97, 0xffff0000, v33
  v_lshlrev_b32 v98, 16, v37
  v_and_b32 v99, 0xffff0000, v37
  v_lshlrev_b32 v100, 16, v41
  v_and_b32 v101, 0xffff0000, v41
  v_pk_mul_f32 v[110:111], v[88:89], v[86:87]
  v_pk_mul_f32 v[112:113], v[90:91], v[86:87]
  v_pk_mul_f32 v[114:115], v[92:93], v[86:87]
  v_pk_mul_f32 v[116:117], v[94:95], v[86:87]
  v_pk_fma_f32 v[110:111], v[90:91], v[84:85], v[110:111]
  v_pk_fma_f32 v[112:113], v[92:93], v[84:85], v[112:113]
  v_pk_fma_f32 v[114:115], v[94:95], v[84:85], v[114:115]
  v_pk_fma_f32 v[116:117], v[96:97], v[84:85], v[116:117]
  v_pk_fma_f32 v[110:111], v[92:93], v[82:83], v[110:111]
  v_pk_fma_f32 v[112:113], v[94:95], v[82:83], v[112:113]
  v_pk_fma_f32 v[114:115], v[96:97], v[82:83], v[114:115]
  v_pk_fma_f32 v[116:117], v[98:99], v[82:83], v[116:117]
  v_pk_fma_f32 v[110:111], v[94:95], v[80:81], v[110:111]
  v_pk_fma_f32 v[112:113], v[96:97], v[80:81], v[112:113]
  v_pk_fma_f32 v[114:115], v[98:99], v[80:81], v[114:115]
  v_pk_fma_f32 v[116:117], v[100:101], v[80:81], v[116:117]
  v_lshlrev_b32 v102, 16, v45
  v_and_b32 v103, 0xffff0000, v45
  v_lshlrev_b32 v104, 16, v49
  v_and_b32 v105, 0xffff0000, v49
  v_lshlrev_b32 v106, 16, v53
  v_and_b32 v107, 0xffff0000, v53
  v_lshlrev_b32 v108, 16, v57
  v_and_b32 v109, 0xffff0000, v57
  v_pk_mul_f32 v[110:111], v[110:111], v[102:103]
  v_pk_mul_f32 v[112:113], v[112:113], v[104:105]
  v_pk_mul_f32 v[114:115], v[114:115], v[106:107]
  v_pk_mul_f32 v[116:117], v[116:117], v[108:109]
  v_cvt_pk_bf16_f32 v121, v110, v111
  v_cvt_pk_bf16_f32 v125, v112, v113
  v_cvt_pk_bf16_f32 v129, v114, v115
  v_cvt_pk_bf16_f32 v133, v116, v117
  v_lshlrev_b32 v80, 16, v68
  v_lshlrev_b32 v81, 16, v70
  v_and_b32 v82, 0xffff0000, v68
  v_and_b32 v83, 0xffff0000, v70
  v_lshlrev_b32 v84, 16, v69
  v_lshlrev_b32 v85, 16, v71
  v_and_b32 v86, 0xffff0000, v69
  v_and_b32 v87, 0xffff0000, v71
  v_lshlrev_b32 v88, 16, v18
  v_and_b32 v89, 0xffff0000, v18
  v_lshlrev_b32 v90, 16, v22
  v_and_b32 v91, 0xffff0000, v22
  v_lshlrev_b32 v92, 16, v26
  v_and_b32 v93, 0xffff0000, v26
  v_lshlrev_b32 v94, 16, v30
  v_and_b32 v95, 0xffff0000, v30
  v_lshlrev_b32 v96, 16, v34
  v_and_b32 v97, 0xffff0000, v34
  v_lshlrev_b32 v98, 16, v38
  v_and_b32 v99, 0xffff0000, v38
  v_lshlrev_b32 v100, 16, v42
  v_and_b32 v101, 0xffff0000, v42
  v_pk_mul_f32 v[110:111], v[88:89], v[86:87]
  v_pk_mul_f32 v[112:113], v[90:91], v[86:87]
  v_pk_mul_f32 v[114:115], v[92:93], v[86:87]
  v_pk_mul_f32 v[116:117], v[94:95], v[86:87]
  v_pk_fma_f32 v[110:111], v[90:91], v[84:85], v[110:111]
  v_pk_fma_f32 v[112:113], v[92:93], v[84:85], v[112:113]
  v_pk_fma_f32 v[114:115], v[94:95], v[84:85], v[114:115]
  v_pk_fma_f32 v[116:117], v[96:97], v[84:85], v[116:117]
  v_pk_fma_f32 v[110:111], v[92:93], v[82:83], v[110:111]
  v_pk_fma_f32 v[112:113], v[94:95], v[82:83], v[112:113]
  v_pk_fma_f32 v[114:115], v[96:97], v[82:83], v[114:115]
  v_pk_fma_f32 v[116:117], v[98:99], v[82:83], v[116:117]
  v_pk_fma_f32 v[110:111], v[94:95], v[80:81], v[110:111]
  v_pk_fma_f32 v[112:113], v[96:97], v[80:81], v[112:113]
  v_pk_fma_f32 v[114:115], v[98:99], v[80:81], v[114:115]
  v_pk_fma_f32 v[116:117], v[100:101], v[80:81], v[116:117]
  v_lshlrev_b32 v102, 16, v46
  v_and_b32 v103, 0xffff0000, v46
  v_lshlrev_b32 v104, 16, v50
  v_and_b32 v105, 0xffff0000, v50
  v_lshlrev_b32 v106, 16, v54
  v_and_b32 v107, 0xffff0000, v54
  v_lshlrev_b32 v108, 16, v58
  v_and_b32 v109, 0xffff0000, v58
  v_pk_mul_f32 v[110:111], v[110:111], v[102:103]
  v_pk_mul_f32 v[112:113], v[112:113], v[104:105]
  v_pk_mul_f32 v[114:115], v[114:115], v[106:107]
  v_pk_mul_f32 v[116:117], v[116:117], v[108:109]
  v_cvt_pk_bf16_f32 v122, v110, v111
  v_cvt_pk_bf16_f32 v126, v112, v113
  v_cvt_pk_bf16_f32 v130, v114, v115
  v_cvt_pk_bf16_f32 v134, v116, v117
  v_lshlrev_b32 v80, 16, v72
  v_lshlrev_b32 v81, 16, v74
  v_and_b32 v82, 0xffff0000, v72
  v_and_b32 v83, 0xffff0000, v74
  v_lshlrev_b32 v84, 16, v73
  v_lshlrev_b32 v85, 16, v75
  v_and_b32 v86, 0xffff0000, v73
  v_and_b32 v87, 0xffff0000, v75
  v_lshlrev_b32 v88, 16, v19
  v_and_b32 v89, 0xffff0000, v19
  v_lshlrev_b32 v90, 16, v23
  v_and_b32 v91, 0xffff0000, v23
  v_lshlrev_b32 v92, 16, v27
  v_and_b32 v93, 0xffff0000, v27
  v_lshlrev_b32 v94, 16, v31
  v_and_b32 v95, 0xffff0000, v31
  v_lshlrev_b32 v96, 16, v35
  v_and_b32 v97, 0xffff0000, v35
  v_lshlrev_b32 v98, 16, v39
  v_and_b32 v99, 0xffff0000, v39
  v_lshlrev_b32 v100, 16, v43
  v_and_b32 v101, 0xffff0000, v43
  v_pk_mul_f32 v[110:111], v[88:89], v[86:87]
  v_pk_mul_f32 v[112:113], v[90:91], v[86:87]
  v_pk_mul_f32 v[114:115], v[92:93], v[86:87]
  v_pk_mul_f32 v[116:117], v[94:95], v[86:87]
  v_pk_fma_f32 v[110:111], v[90:91], v[84:85], v[110:111]
  v_pk_fma_f32 v[112:113], v[92:93], v[84:85], v[112:113]
  v_pk_fma_f32 v[114:115], v[94:95], v[84:85], v[114:115]
  v_pk_fma_f32 v[116:117], v[96:97], v[84:85], v[116:117]
  v_pk_fma_f32 v[110:111], v[92:93], v[82:83], v[110:111]
  v_pk_fma_f32 v[112:113], v[94:95], v[82:83], v[112:113]
  v_pk_fma_f32 v[114:115], v[96:97], v[82:83], v[114:115]
  v_pk_fma_f32 v[116:117], v[98:99], v[82:83], v[116:117]
  v_pk_fma_f32 v[110:111], v[94:95], v[80:81], v[110:111]
  v_pk_fma_f32 v[112:113], v[96:97], v[80:81], v[112:113]
  v_pk_fma_f32 v[114:115], v[98:99], v[80:81], v[114:115]
  v_pk_fma_f32 v[116:117], v[100:101], v[80:81], v[116:117]
  v_lshlrev_b32 v102, 16, v47
  v_and_b32 v103, 0xffff0000, v47
  v_lshlrev_b32 v104, 16, v51
  v_and_b32 v105, 0xffff0000, v51
  v_lshlrev_b32 v106, 16, v55
  v_and_b32 v107, 0xffff0000, v55
  v_lshlrev_b32 v108, 16, v59
  v_and_b32 v109, 0xffff0000, v59
  v_pk_mul_f32 v[110:111], v[110:111], v[102:103]
  v_pk_mul_f32 v[112:113], v[112:113], v[104:105]
  v_pk_mul_f32 v[114:115], v[114:115], v[106:107]
  v_pk_mul_f32 v[116:117], v[116:117], v[108:109]
  v_cvt_pk_bf16_f32 v123, v110, v111
  v_cvt_pk_bf16_f32 v127, v112, v113
  v_cvt_pk_bf16_f32 v131, v114, v115
  v_cvt_pk_bf16_f32 v135, v116, v117
  ds_write_b128 v6, v[120:123]
  ds_write_b128 v6, v[124:127] offset:128
  ds_write_b128 v6, v[128:131] offset:256
  ds_write_b128 v6, v[132:135] offset:384
  s_waitcnt lgkmcnt(0)
  s_barrier
  ds_read_b64_tr_b16 v[16:17], v7 offset:512
  ds_read_b64_tr_b16 v[18:19], v7 offset:0
  ds_read_b64_tr_b16 v[20:21], v7 offset:8704
  ds_read_b64_tr_b16 v[22:23], v7 offset:8192
  ds_read_b64_tr_b16 v[24:25], v7 offset:528
  ds_read_b64_tr_b16 v[26:27], v7 offset:16
  ds_read_b64_tr_b16 v[28:29], v7 offset:8720
  ds_read_b64_tr_b16 v[30:31], v7 offset:8208
  s_waitcnt lgkmcnt(6)
  buffer_store_dwordx4 v[16:19], v8, s[24:27], 0 offen sc1
  s_waitcnt lgkmcnt(4)
  buffer_store_dwordx4 v[20:23], v8, s[24:27], 0 offen offset:128 sc1
  s_waitcnt lgkmcnt(2)
  buffer_store_dwordx4 v[24:27], v9, s[24:27], 0 offen sc1
  s_waitcnt lgkmcnt(0)
  buffer_store_dwordx4 v[28:31], v9, s[24:27], 0 offen offset:128 sc1
  s_waitcnt lgkmcnt(0)
  s_add_u32 s94, s28, 1
  s_mul_i32 s3, s95, 144
  s_add_u32 s3, s3, s2
  s_lshl_b32 s3, s3, 7
  s_add_u32 s3, s3, 950272
  v_mov_b32 v239, s94
  s_waitcnt vmcnt(0)
  buffer_store_dword v239, off, s[60:63], s3 sc1
  s_barrier
  s_add_u32 m0, s45, 32
  s_nop 0
  buffer_load_dwordx4 v143, s[52:55], 0 offen offset:0 lds
  buffer_load_dwordx4 v143, s[52:55], 0 offen offset:1024 lds
  buffer_load_dwordx4 v143, s[52:55], 0 offen offset:2048 lds
  buffer_load_dwordx4 v143, s[52:55], 0 offen offset:3072 lds
  s_add_u32 m0, s45, 8352
  v_add_u32 v143, 4, v143
  buffer_load_dwordx4 v143, s[52:55], 0 offen offset:0 lds
  buffer_load_dwordx4 v143, s[52:55], 0 offen offset:1024 lds
  buffer_load_dwordx4 v143, s[52:55], 0 offen offset:2048 lds
  buffer_load_dwordx4 v143, s[52:55], 0 offen offset:3072 lds
  v_lshl_add_u32 v14, v254, 4, s45
  v_alignbyte_b32 v40, v153, v152, 2
  v_alignbyte_b32 v41, v154, v153, 2
  v_alignbyte_b32 v42, v155, v154, 2
  v_alignbyte_b32 v43, v156, v155, 2
  ds_write_b128 v14, v[40:43] offset:4192
  v_alignbyte_b32 v44, v154, v153, 2
  v_alignbyte_b32 v45, v155, v154, 2
  v_alignbyte_b32 v46, v156, v155, 2
  v_alignbyte_b32 v47, v157, v156, 2
  ds_write_b128 v14, v[44:47] offset:12512
  v_alignbyte_b32 v48, v159, v158, 2
  v_alignbyte_b32 v49, v160, v159, 2
  v_alignbyte_b32 v50, v161, v160, 2
  v_alignbyte_b32 v51, v162, v161, 2
  ds_write_b128 v14, v[48:51] offset:5216
  v_alignbyte_b32 v52, v160, v159, 2
  v_alignbyte_b32 v53, v161, v160, 2
  v_alignbyte_b32 v54, v162, v161, 2
  v_alignbyte_b32 v55, v163, v162, 2
  ds_write_b128 v14, v[52:55] offset:13536
  v_alignbyte_b32 v40, v165, v164, 2
  v_alignbyte_b32 v41, v166, v165, 2
  v_alignbyte_b32 v42, v167, v166, 2
  v_alignbyte_b32 v43, v168, v167, 2
  ds_write_b128 v14, v[40:43] offset:6240
  v_alignbyte_b32 v44, v166, v165, 2
  v_alignbyte_b32 v45, v167, v166, 2
  v_alignbyte_b32 v46, v168, v167, 2
  v_alignbyte_b32 v47, v169, v168, 2
  ds_write_b128 v14, v[44:47] offset:14560
  v_alignbyte_b32 v48, v171, v170, 2
  v_alignbyte_b32 v49, v172, v171, 2
  v_alignbyte_b32 v50, v173, v172, 2
  v_alignbyte_b32 v51, v174, v173, 2
  ds_write_b128 v14, v[48:51] offset:7264
  v_alignbyte_b32 v52, v172, v171, 2
  v_alignbyte_b32 v53, v173, v172, 2
  v_alignbyte_b32 v54, v174, v173, 2
  v_alignbyte_b32 v55, v175, v174, 2
  ds_write_b128 v14, v[52:55] offset:15584
  ds_write_b16 v214, v140
  v_lshrrev_b32 v10, 3, v145
  v_add_u32 v10, 2, v10
  v_cmp_eq_u32 vcc, v10, v144
  v_and_b32 v11, 7, v145
  v_sub_u32 v11, 7, v11
  v_cndmask_b32 v9, 0, v141, vcc
  v_and_b32 v10, 1, v11
  v_lshlrev_b32 v10, 4, v10
  v_lshlrev_b32 v9, v10, v9
  v_lshrrev_b32 v11, 1, v11
  v_cmp_eq_u32 vcc, 0, v11
  s_nop 1
  v_cndmask_b32 v196, 0, v9, vcc
  v_cmp_eq_u32 vcc, 1, v11
  s_nop 1
  v_cndmask_b32 v197, 0, v9, vcc
  v_cmp_eq_u32 vcc, 2, v11
  s_nop 1
  v_cndmask_b32 v198, 0, v9, vcc
  v_cmp_eq_u32 vcc, 3, v11
  s_nop 1
  v_cndmask_b32 v199, 0, v9, vcc
  v_min_u32 v214, 55, v254
  v_lshlrev_b32 v214, 7, v214
  s_mov_b32 s90, 51200
  s_mov_b32 s8, 58368
  s_mul_i32 s6, s95, 144
  s_add_u32 s6, s6, s2
  s_lshl_b32 s6, s6, 7
  s_add_u32 s6, s6, 655360
  s_cmp_ge_u32 s95, 2
  s_cselect_b32 s7, 0x40000000, 0
  v_mov_b32 v23, s94
  s_add_u32 s56, s92, s46
  s_addc_u32 s57, s93, 0
  s_mov_b32 s58, 4096
  s_mov_b32 s59, 0x20000
  s_bfe_u32 s4, s2, 0x20002
  s_mul_i32 s4, s4, 9
  s_add_u32 s4, s4, s40
  s_lshl_b32 s4, s4, 11
  s_add_u32 s4, s4, 950272
  s_add_u32 s52, s92, 0x240000
  s_addc_u32 s53, s93, 0
  s_mov_b32 s54, 0x240000
  s_mov_b32 s55, 0x20000
  s_mov_b32 s96, 0
L_poll1:
  buffer_load_dword v239, v213, s[60:63], s4 offen sc1
  s_add_u32 s96, s96, 1
  s_waitcnt vmcnt(0)
  v_cmp_ne_u32 vcc, s94, v239
  s_cbranch_vccz L_pd2
  s_cmp_lt_u32 s96, 200000
  s_cbranch_scc1 L_poll1
L_pd2:
  s_add_u32 m0, s45, 17152
  s_nop 0
  buffer_load_dwordx4 v212, s[56:59], 0 offen offset:0 sc1 lds
  buffer_load_dwordx4 v212, s[56:59], 0 offen offset:1024 sc1 lds
  buffer_load_dwordx4 v212, s[56:59], 0 offen offset:2048 sc1 lds
  buffer_load_dwordx4 v212, s[56:59], 0 offen offset:3072 sc1 lds
  ds_read_b64 v[64:65], v192 offset:0
  ds_read_b64 v[66:67], v192 offset:8
  ds_read_b64 v[68:69], v192 offset:512
  ds_read_b64 v[70:71], v192 offset:520
  ds_read_b64 v[72:73], v192 offset:1024
  ds_read_b64 v[74:75], v192 offset:1032
  ds_read_b64 v[76:77], v192 offset:1536
  ds_read_b64 v[78:79], v192 offset:1544
  ds_read_b64 v[80:81], v192 offset:64
  ds_read_b64 v[82:83], v192 offset:72
  ds_read_b64 v[84:85], v192 offset:576
  ds_read_b64 v[86:87], v192 offset:584
  ds_read_b64 v[88:89], v192 offset:1088
  ds_read_b64 v[90:91], v192 offset:1096
  ds_read_b64 v[92:93], v192 offset:1600
  ds_read_b64 v[94:95], v192 offset:1608
  s_mov_b32 s5, s49
  s_and_b32 s5, s5, 15
  s_lshl_b32 s4, s5, 2
  s_add_u32 s4, s4, s95
  s_mul_i32 s4, s4, 94
  s_cmp_ge_u32 s5, 7
  s_cselect_b32 s4, 0x800000, s4
  v_min_u32 v238, 46, v254
  v_add_u32 v238, s4, v238
  v_lshlrev_b32 v238, 7, v238
  s_mul_i32 s40, s50, 331776
  s_and_b32 s9, s50, 1
  s_lshr_b32 s10, s50, 1
  s_mul_i32 s11, s10, 663552
  s_mul_i32 s3, s9, 640
  s_add_u32 s3, s3, s11
  s_mul_i32 s4, s9, 368640
  s_add_u32 s33, s3, s4
  s_sub_u32 s4, 368640, s4
  s_add_u32 s42, s3, s4
  s_mul_i32 s4, s9, 36864
  s_add_u32 s3, s3, 294912
  s_add_u32 s34, s3, s4
  s_sub_u32 s4, 36864, s4
  s_add_u32 s43, s3, s4
  s_mul_i32 s3, s9, 576
  s_sub_u32 s3, 512, s3
  s_add_u32 s44, s33, s3
  s_add_u32 s45, s42, s3
  s_sub_u32 s4, s43, 36864
  s_cmp_ge_u32 s95, 2
  s_cselect_b32 s4, s4, s34
  s_add_u32 s46, s4, s3
  s_lshl_b32 s10, s10, 6
  s_lshl_b32 s3, s49, 2
  s_add_u32 s10, s10, s3
  s_add_u32 s10, s10, s95
  s_mul_i32 s10, s10, 36864
  s_mul_i32 s3, s9, 20480
  s_add_u32 s36, s10, s3
  s_lshl_b32 s3, s9, 11
  s_add_u32 s3, s3, 16384
  s_add_u32 s47, s10, s3
  s_lshl_b32 s3, s2, 2
  s_add_u32 s3, s3, s95
  s_xor_b32 s9, s3, 32
  s_mul_i32 s76, s3, 18432
  s_mul_i32 s77, s9, 18432
  s_lshl_b32 s3, s3, 8
  s_add_u32 s100, s3, 131072
  s_lshl_b32 s9, s9, 8
  s_add_u32 s101, s9, 131072
  s_add_u32 s20, s92, 0x480000
  s_addc_u32 s21, s93, 0
  s_mov_b32 s22, 0x240000
  s_mov_b32 s23, 0x20000
  s_add_u32 s24, s92, 0x1000000
  s_addc_u32 s25, s93, 0
  s_mov_b32 s26, 0x2400000
  s_mov_b32 s27, 0x20000
  s_waitcnt vmcnt(0)
  ds_read_b128 v[96:99], v193 offset:448
  ds_read_b128 v[100:103], v193 offset:960
  ds_read_b128 v[104:107], v193 offset:1472
  ds_read_b128 v[108:111], v193 offset:1984
  ds_read_b128 v[112:115], v193 offset:384
  ds_read_b128 v[116:119], v193 offset:896
  ds_read_b128 v[120:123], v193 offset:1408
  ds_read_b128 v[124:127], v193 offset:1920
  s_lshl_b32 s3, s49, 4
  s_add_u32 s3, s3, s50
  s_lshl_b32 s3, s3, 3
  v_and_b32 v1, 7, v254
  v_add_u32 v1, s3, v1
  v_bfe_u32 v2, v254, 3, 1
  v_lshlrev_b32 v2, 2, v2
  v_bfe_u32 v3, v254, 5, 1
  v_lshl_add_u32 v2, v3, 1, v2
  v_bfe_u32 v3, v254, 4, 1
  v_add_u32 v2, v2, v3
  s_lshr_b32 s3, s95, 1
  s_mul_i32 s3, s3, 3
  s_add_u32 s3, s3, s95
  s_lshl_b32 s3, s3, 3
  v_add_u32 v2, s3, v2
  s_mov_b32 s56, s64
  s_mov_b32 s57, s65
  s_mov_b32 s58, 0x240000
  s_mov_b32 s59, 0x20000
  v_mul_u32_u24 v1, 1152, v1
  v_lshl_add_u32 v1, v2, 4, v1
  buffer_load_dwordx4 v[240:243], v1, s[56:59], 0 offen nt
  buffer_load_dwordx4 v[244:247], v1, s[56:59], 0 offen offset:256 nt
  buffer_load_dwordx4 v[248:251], v1, s[56:59], s51 offen offset:512 nt
  s_waitcnt lgkmcnt(0)
  v_mfma_f32_16x16x32_bf16 v[24:27], v[196:199], v[96:99], 0
  ds_read_b128 v[160:163], v193 offset:320
  ds_read_b128 v[164:167], v193 offset:832
  v_mfma_f32_16x16x32_bf16 v[28:31], v[196:199], v[100:103], 0
  ds_read_b128 v[168:171], v193 offset:1344
  ds_read_b128 v[172:175], v193 offset:1856
  v_mfma_f32_16x16x32_bf16 v[32:35], v[196:199], v[104:107], 0
  ds_read_b128 v[176:179], v193 offset:256
  ds_read_b128 v[180:183], v193 offset:768
  v_mfma_f32_16x16x32_bf16 v[36:39], v[196:199], v[108:111], 0
  ds_read_b128 v[184:187], v193 offset:1280
  ds_read_b128 v[188:191], v193 offset:1792
  v_mfma_f32_16x16x32_bf16 v[24:27], v[64:67], v[96:99], v[24:27]
  ds_read_b64 v[128:129], v192 offset:128
  ds_read_b64 v[130:131], v192 offset:136
  v_mfma_f32_16x16x32_bf16 v[28:31], v[64:67], v[100:103], v[28:31]
  ds_read_b64 v[132:133], v192 offset:640
  ds_read_b64 v[134:135], v192 offset:648
  v_mfma_f32_16x16x32_bf16 v[32:35], v[64:67], v[104:107], v[32:35]
  ds_read_b64 v[136:137], v192 offset:1152
  ds_read_b64 v[138:139], v192 offset:1160
  v_mfma_f32_16x16x32_bf16 v[36:39], v[64:67], v[108:111], v[36:39]
  ds_read_b64 v[140:141], v192 offset:1664
  ds_read_b64 v[142:143], v192 offset:1672
  v_mfma_f32_16x16x32_bf16 v[28:31], v[68:71], v[96:99], v[28:31]
  ds_read_b64 v[144:145], v192 offset:192
  v_mfma_f32_16x16x32_bf16 v[32:35], v[68:71], v[100:103], v[32:35]
  ds_read_b64 v[146:147], v192 offset:200
  v_mfma_f32_16x16x32_bf16 v[36:39], v[68:71], v[104:107], v[36:39]
  ds_read_b64 v[148:149], v192 offset:704
  v_mfma_f32_16x16x32_bf16 v[32:35], v[72:75], v[96:99], v[32:35]
  ds_read_b64 v[150:151], v192 offset:712
  v_mfma_f32_16x16x32_bf16 v[36:39], v[72:75], v[100:103], v[36:39]
  ds_read_b64 v[152:153], v192 offset:1216
  v_mfma_f32_16x16x32_bf16 v[36:39], v[76:79], v[96:99], v[36:39]
  ds_read_b64 v[154:155], v192 offset:1224
  v_mfma_f32_16x16x32_bf16 v[24:27], v[80:83], v[112:115], v[24:27]
  ds_read_b64 v[156:157], v192 offset:1728
  v_mfma_f32_16x16x32_bf16 v[28:31], v[80:83], v[116:119], v[28:31]
  ds_read_b64 v[158:159], v192 offset:1736
  v_mfma_f32_16x16x32_bf16 v[32:35], v[80:83], v[120:123], v[32:35]
  v_mfma_f32_16x16x32_bf16 v[36:39], v[80:83], v[124:127], v[36:39]
  v_mfma_f32_16x16x32_bf16 v[28:31], v[84:87], v[112:115], v[28:31]
  v_mfma_f32_16x16x32_bf16 v[32:35], v[84:87], v[116:119], v[32:35]
  v_mfma_f32_16x16x32_bf16 v[36:39], v[84:87], v[120:123], v[36:39]
  v_mfma_f32_16x16x32_bf16 v[32:35], v[88:91], v[112:115], v[32:35]
  v_mfma_f32_16x16x32_bf16 v[36:39], v[88:91], v[116:119], v[36:39]
  v_mfma_f32_16x16x32_bf16 v[36:39], v[92:95], v[112:115], v[36:39]
  s_waitcnt lgkmcnt(0)
  v_mfma_f32_16x16x32_bf16 v[24:27], v[128:131], v[160:163], v[24:27]
  ds_read_b128 v[96:99], v193 offset:192
  ds_read_b128 v[100:103], v193 offset:704
  v_mfma_f32_16x16x32_bf16 v[28:31], v[128:131], v[164:167], v[28:31]
  ds_read_b128 v[104:107], v193 offset:1216
  ds_read_b128 v[108:111], v193 offset:1728
  v_mfma_f32_16x16x32_bf16 v[32:35], v[128:131], v[168:171], v[32:35]
  ds_read_b128 v[112:115], v193 offset:128
  ds_read_b128 v[116:119], v193 offset:640
  v_mfma_f32_16x16x32_bf16 v[36:39], v[128:131], v[172:175], v[36:39]
  ds_read_b128 v[120:123], v193 offset:1152
  ds_read_b128 v[124:127], v193 offset:1664
  v_mfma_f32_16x16x32_bf16 v[28:31], v[132:135], v[160:163], v[28:31]
  ds_read_b64 v[64:65], v192 offset:256
  ds_read_b64 v[66:67], v192 offset:264
  v_mfma_f32_16x16x32_bf16 v[32:35], v[132:135], v[164:167], v[32:35]
  ds_read_b64 v[68:69], v192 offset:768
  ds_read_b64 v[70:71], v192 offset:776
  v_mfma_f32_16x16x32_bf16 v[36:39], v[132:135], v[168:171], v[36:39]
  ds_read_b64 v[72:73], v192 offset:1280
  ds_read_b64 v[74:75], v192 offset:1288
  v_mfma_f32_16x16x32_bf16 v[32:35], v[136:139], v[160:163], v[32:35]
  ds_read_b64 v[76:77], v192 offset:1792
  ds_read_b64 v[78:79], v192 offset:1800
  v_mfma_f32_16x16x32_bf16 v[36:39], v[136:139], v[164:167], v[36:39]
  ds_read_b64 v[80:81], v192 offset:320
  ds_read_b64 v[82:83], v192 offset:328
  v_mfma_f32_16x16x32_bf16 v[36:39], v[140:143], v[160:163], v[36:39]
  ds_read_b64 v[84:85], v192 offset:832
  ds_read_b64 v[86:87], v192 offset:840
  v_mfma_f32_16x16x32_bf16 v[24:27], v[144:147], v[176:179], v[24:27]
  ds_read_b64 v[88:89], v192 offset:1344
  ds_read_b64 v[90:91], v192 offset:1352
  v_mfma_f32_16x16x32_bf16 v[28:31], v[144:147], v[180:183], v[28:31]
  ds_read_b64 v[92:93], v192 offset:1856
  ds_read_b64 v[94:95], v192 offset:1864
  v_mfma_f32_16x16x32_bf16 v[32:35], v[144:147], v[184:187], v[32:35]
  v_mfma_f32_16x16x32_bf16 v[36:39], v[144:147], v[188:191], v[36:39]
  v_mfma_f32_16x16x32_bf16 v[28:31], v[148:151], v[176:179], v[28:31]
  v_mfma_f32_16x16x32_bf16 v[32:35], v[148:151], v[180:183], v[32:35]
  v_mfma_f32_16x16x32_bf16 v[36:39], v[148:151], v[184:187], v[36:39]
  v_mfma_f32_16x16x32_bf16 v[32:35], v[152:155], v[176:179], v[32:35]
  v_mfma_f32_16x16x32_bf16 v[36:39], v[152:155], v[180:183], v[36:39]
  v_mfma_f32_16x16x32_bf16 v[36:39], v[156:159], v[176:179], v[36:39]
  s_waitcnt lgkmcnt(0)
  v_mfma_f32_16x16x32_bf16 v[24:27], v[64:67], v[96:99], v[24:27]
  ds_read_b128 v[160:163], v193 offset:64
  ds_read_b128 v[164:167], v193 offset:576
  v_mfma_f32_16x16x32_bf16 v[28:31], v[64:67], v[100:103], v[28:31]
  ds_read_b128 v[168:171], v193 offset:1088
  ds_read_b128 v[172:175], v193 offset:1600
  v_mfma_f32_16x16x32_bf16 v[32:35], v[64:67], v[104:107], v[32:35]
  ds_read_b128 v[176:179], v193 offset:0
  ds_read_b128 v[180:183], v193 offset:512
  v_mfma_f32_16x16x32_bf16 v[36:39], v[64:67], v[108:111], v[36:39]
  ds_read_b128 v[184:187], v193 offset:1024
  ds_read_b128 v[188:191], v193 offset:1536
  v_mfma_f32_16x16x32_bf16 v[28:31], v[68:71], v[96:99], v[28:31]
  ds_read_b64 v[128:129], v192 offset:384
  ds_read_b64 v[130:131], v192 offset:392
  v_mfma_f32_16x16x32_bf16 v[32:35], v[68:71], v[100:103], v[32:35]
  ds_read_b64 v[132:133], v192 offset:896
  ds_read_b64 v[134:135], v192 offset:904
  v_mfma_f32_16x16x32_bf16 v[36:39], v[68:71], v[104:107], v[36:39]
  ds_read_b64 v[136:137], v192 offset:1408
  ds_read_b64 v[138:139], v192 offset:1416
  v_mfma_f32_16x16x32_bf16 v[32:35], v[72:75], v[96:99], v[32:35]
  ds_read_b64 v[140:141], v192 offset:1920
  ds_read_b64 v[142:143], v192 offset:1928
  v_mfma_f32_16x16x32_bf16 v[36:39], v[72:75], v[100:103], v[36:39]
  ds_read_b64 v[144:145], v192 offset:448
  ds_read_b64 v[146:147], v192 offset:456
  v_mfma_f32_16x16x32_bf16 v[36:39], v[76:79], v[96:99], v[36:39]
  ds_read_b64 v[148:149], v192 offset:960
  ds_read_b64 v[150:151], v192 offset:968
  v_mfma_f32_16x16x32_bf16 v[24:27], v[80:83], v[112:115], v[24:27]
  ds_read_b64 v[152:153], v192 offset:1472
  ds_read_b64 v[154:155], v192 offset:1480
  v_mfma_f32_16x16x32_bf16 v[28:31], v[80:83], v[116:119], v[28:31]
  ds_read_b64 v[156:157], v192 offset:1984
  ds_read_b64 v[158:159], v192 offset:1992
  v_mfma_f32_16x16x32_bf16 v[32:35], v[80:83], v[120:123], v[32:35]
  v_mfma_f32_16x16x32_bf16 v[36:39], v[80:83], v[124:127], v[36:39]
  v_mfma_f32_16x16x32_bf16 v[28:31], v[84:87], v[112:115], v[28:31]
  v_mfma_f32_16x16x32_bf16 v[32:35], v[84:87], v[116:119], v[32:35]
  v_mfma_f32_16x16x32_bf16 v[36:39], v[84:87], v[120:123], v[36:39]
  v_mfma_f32_16x16x32_bf16 v[32:35], v[88:91], v[112:115], v[32:35]
  v_mfma_f32_16x16x32_bf16 v[36:39], v[88:91], v[116:119], v[36:39]
  v_mfma_f32_16x16x32_bf16 v[36:39], v[92:95], v[112:115], v[36:39]
  s_waitcnt lgkmcnt(0)
  v_mfma_f32_16x16x32_bf16 v[24:27], v[128:131], v[160:163], v[24:27]
  ds_read_b128 v[96:99], v193 offset:448
  ds_read_b128 v[100:103], v193 offset:960
  v_mfma_f32_16x16x32_bf16 v[28:31], v[128:131], v[164:167], v[28:31]
  ds_read_b128 v[104:107], v193 offset:1472
  ds_read_b128 v[108:111], v193 offset:1984
  v_mfma_f32_16x16x32_bf16 v[32:35], v[128:131], v[168:171], v[32:35]
  ds_read_b128 v[112:115], v193 offset:2496
  ds_read_b128 v[116:119], v193 offset:3008
  v_mfma_f32_16x16x32_bf16 v[36:39], v[128:131], v[172:175], v[36:39]
  ds_read_b128 v[120:123], v193 offset:3520
  ds_read_b128 v[124:127], v193 offset:4032
  v_mfma_f32_16x16x32_bf16 v[28:31], v[132:135], v[160:163], v[28:31]
  ds_read_b64 v[64:65], v192 offset:0
  ds_read_b64 v[66:67], v192 offset:8
  v_mfma_f32_16x16x32_bf16 v[32:35], v[132:135], v[164:167], v[32:35]
  ds_read_b64 v[68:69], v192 offset:512
  ds_read_b64 v[70:71], v192 offset:520
  v_mfma_f32_16x16x32_bf16 v[36:39], v[132:135], v[168:171], v[36:39]
  ds_read_b64 v[72:73], v192 offset:1024
  ds_read_b64 v[74:75], v192 offset:1032
  v_mfma_f32_16x16x32_bf16 v[32:35], v[136:139], v[160:163], v[32:35]
  ds_read_b64 v[76:77], v192 offset:1536
  ds_read_b64 v[78:79], v192 offset:1544
  v_mfma_f32_16x16x32_bf16 v[36:39], v[136:139], v[164:167], v[36:39]
  ds_read_b64 v[80:81], v192 offset:2048
  ds_read_b64 v[82:83], v192 offset:2056
  v_mfma_f32_16x16x32_bf16 v[36:39], v[140:143], v[160:163], v[36:39]
  ds_read_b64 v[84:85], v192 offset:2560
  ds_read_b64 v[86:87], v192 offset:2568
  v_mfma_f32_16x16x32_bf16 v[24:27], v[144:147], v[176:179], v[24:27]
  ds_read_b64 v[88:89], v192 offset:3072
  ds_read_b64 v[90:91], v192 offset:3080
  v_mfma_f32_16x16x32_bf16 v[28:31], v[144:147], v[180:183], v[28:31]
  ds_read_b64 v[92:93], v192 offset:3584
  ds_read_b64 v[94:95], v192 offset:3592
  v_mfma_f32_16x16x32_bf16 v[32:35], v[144:147], v[184:187], v[32:35]
  v_mfma_f32_16x16x32_bf16 v[36:39], v[144:147], v[188:191], v[36:39]
  v_mfma_f32_16x16x32_bf16 v[28:31], v[148:151], v[176:179], v[28:31]
  v_mfma_f32_16x16x32_bf16 v[32:35], v[148:151], v[180:183], v[32:35]
  v_mfma_f32_16x16x32_bf16 v[36:39], v[148:151], v[184:187], v[36:39]
  v_mfma_f32_16x16x32_bf16 v[32:35], v[152:155], v[176:179], v[32:35]
  v_mfma_f32_16x16x32_bf16 v[36:39], v[152:155], v[180:183], v[36:39]
  v_mfma_f32_16x16x32_bf16 v[36:39], v[156:159], v[176:179], v[36:39]
  s_waitcnt lgkmcnt(0)
  v_mfma_f32_16x16x32_bf16 v[40:43], v[196:199], v[112:115], 0
  ds_read_b128 v[160:163], v193 offset:384
  v_mfma_f32_16x16x32_bf16 v[44:47], v[196:199], v[116:119], 0
  ds_read_b128 v[164:167], v193 offset:896
  v_mfma_f32_16x16x32_bf16 v[48:51], v[196:199], v[120:123], 0
  ds_read_b128 v[168:171], v193 offset:1408
  v_cvt_pk_bf16_f32 v4, v24, v26
  v_mfma_f32_16x16x32_bf16 v[52:55], v[196:199], v[124:127], 0
  ds_read_b128 v[172:175], v193 offset:1920
  v_cvt_pk_bf16_f32 v5, v25, v27
  v_mfma_f32_16x16x32_bf16 v[40:43], v[64:67], v[112:115], v[40:43]
  ds_read_b128 v[176:179], v193 offset:2432
  ds_write2st64_b32 v194, v4, v5 offset0:0 offset1:8
  v_mfma_f32_16x16x32_bf16 v[44:47], v[64:67], v[116:119], v[44:47]
  ds_read_b128 v[180:183], v193 offset:2944
  v_cvt_pk_bf16_f32 v6, v28, v30
  v_mfma_f32_16x16x32_bf16 v[48:51], v[64:67], v[120:123], v[48:51]
  ds_read_b128 v[184:187], v193 offset:3456
  v_cvt_pk_bf16_f32 v7, v29, v31
  v_mfma_f32_16x16x32_bf16 v[52:55], v[64:67], v[124:127], v[52:55]
  ds_read_b128 v[188:191], v193 offset:3968
  ds_write2st64_b32 v194, v6, v7 offset0:1 offset1:9
  v_mfma_f32_16x16x32_bf16 v[40:43], v[68:71], v[108:111], v[40:43]
  ds_read_b64 v[128:129], v192 offset:64
  v_cvt_pk_bf16_f32 v8, v32, v34
  v_mfma_f32_16x16x32_bf16 v[44:47], v[68:71], v[112:115], v[44:47]
  ds_read_b64 v[130:131], v192 offset:72
  v_cvt_pk_bf16_f32 v9, v33, v35
  v_mfma_f32_16x16x32_bf16 v[48:51], v[68:71], v[116:119], v[48:51]
  ds_read_b64 v[132:133], v192 offset:576
  ds_write2st64_b32 v194, v8, v9 offset0:2 offset1:10
  v_mfma_f32_16x16x32_bf16 v[52:55], v[68:71], v[120:123], v[52:55]
  ds_read_b64 v[134:135], v192 offset:584
  v_cvt_pk_bf16_f32 v10, v36, v38
  v_mfma_f32_16x16x32_bf16 v[40:43], v[72:75], v[104:107], v[40:43]
  ds_read_b64 v[136:137], v192 offset:1088
  v_cvt_pk_bf16_f32 v11, v37, v39
  v_mfma_f32_16x16x32_bf16 v[44:47], v[72:75], v[108:111], v[44:47]
  ds_read_b64 v[138:139], v192 offset:1096
  ds_write2st64_b32 v194, v10, v11 offset0:3 offset1:11
  v_mfma_f32_16x16x32_bf16 v[48:51], v[72:75], v[112:115], v[48:51]
  ds_read_b64 v[140:141], v192 offset:1600
  ds_read_b64 v[142:143], v192 offset:1608
  v_mfma_f32_16x16x32_bf16 v[52:55], v[72:75], v[116:119], v[52:55]
  ds_read_b64 v[144:145], v192 offset:2112
  ds_read_b64 v[146:147], v192 offset:2120
  v_mfma_f32_16x16x32_bf16 v[40:43], v[76:79], v[100:103], v[40:43]
  ds_read_b64 v[148:149], v192 offset:2624
  v_mfma_f32_16x16x32_bf16 v[44:47], v[76:79], v[104:107], v[44:47]
  ds_read_b64 v[150:151], v192 offset:2632
  v_mfma_f32_16x16x32_bf16 v[48:51], v[76:79], v[108:111], v[48:51]
  ds_read_b64 v[152:153], v192 offset:3136
  v_mfma_f32_16x16x32_bf16 v[52:55], v[76:79], v[112:115], v[52:55]
  ds_read_b64 v[154:155], v192 offset:3144
  v_mfma_f32_16x16x32_bf16 v[40:43], v[80:83], v[96:99], v[40:43]
  ds_read_b64 v[156:157], v192 offset:3648
  v_mfma_f32_16x16x32_bf16 v[44:47], v[80:83], v[100:103], v[44:47]
  ds_read_b64 v[158:159], v192 offset:3656
  v_mfma_f32_16x16x32_bf16 v[48:51], v[80:83], v[104:107], v[48:51]
  v_mfma_f32_16x16x32_bf16 v[52:55], v[80:83], v[108:111], v[52:55]
  v_mfma_f32_16x16x32_bf16 v[44:47], v[84:87], v[96:99], v[44:47]
  v_mfma_f32_16x16x32_bf16 v[48:51], v[84:87], v[100:103], v[48:51]
  v_mfma_f32_16x16x32_bf16 v[52:55], v[84:87], v[104:107], v[52:55]
  v_mfma_f32_16x16x32_bf16 v[48:51], v[88:91], v[96:99], v[48:51]
  v_mfma_f32_16x16x32_bf16 v[52:55], v[88:91], v[100:103], v[52:55]
  v_mfma_f32_16x16x32_bf16 v[52:55], v[92:95], v[96:99], v[52:55]
  s_waitcnt lgkmcnt(0)
  s_barrier
  v_mfma_f32_16x16x32_bf16 v[40:43], v[128:131], v[176:179], v[40:43]
  ds_read_b128 v[96:99], v193 offset:320
  ds_read_b64_tr_b16 v[4:5], v195 offset:0
  v_mfma_f32_16x16x32_bf16 v[44:47], v[128:131], v[180:183], v[44:47]
  ds_read_b128 v[100:103], v193 offset:832
  ds_read_b64_tr_b16 v[6:7], v195 offset:2048
  v_mfma_f32_16x16x32_bf16 v[48:51], v[128:131], v[184:187], v[48:51]
  ds_read_b128 v[104:107], v193 offset:1344
  ds_read_b64_tr_b16 v[8:9], v195 offset:512
  v_mfma_f32_16x16x32_bf16 v[52:55], v[128:131], v[188:191], v[52:55]
  ds_read_b128 v[108:111], v193 offset:1856
  ds_read_b64_tr_b16 v[10:11], v195 offset:2560
  v_mfma_f32_16x16x32_bf16 v[40:43], v[132:135], v[172:175], v[40:43]
  ds_read_b128 v[112:115], v193 offset:2368
  ds_read_b128 v[116:119], v193 offset:2880
  v_mfma_f32_16x16x32_bf16 v[44:47], v[132:135], v[176:179], v[44:47]
  ds_read_b128 v[120:123], v193 offset:3392
  ds_read_b128 v[124:127], v193 offset:3904
  v_mfma_f32_16x16x32_bf16 v[48:51], v[132:135], v[180:183], v[48:51]
  ds_read_b64 v[64:65], v192 offset:128
  ds_read_b64 v[66:67], v192 offset:136
  v_mfma_f32_16x16x32_bf16 v[52:55], v[132:135], v[184:187], v[52:55]
  ds_read_b64 v[68:69], v192 offset:640
  ds_read_b64 v[70:71], v192 offset:648
  v_mfma_f32_16x16x32_bf16 v[40:43], v[136:139], v[168:171], v[40:43]
  ds_read_b64 v[72:73], v192 offset:1152
  ds_read_b64 v[74:75], v192 offset:1160
  v_mfma_f32_16x16x32_bf16 v[44:47], v[136:139], v[172:175], v[44:47]
  ds_read_b64 v[76:77], v192 offset:1664
  ds_read_b64 v[78:79], v192 offset:1672
  v_mfma_f32_16x16x32_bf16 v[48:51], v[136:139], v[176:179], v[48:51]
  ds_read_b64 v[80:81], v192 offset:2176
  v_mfma_f32_16x16x32_bf16 v[52:55], v[136:139], v[180:183], v[52:55]
  ds_read_b64 v[82:83], v192 offset:2184
  v_mfma_f32_16x16x32_bf16 v[40:43], v[140:143], v[164:167], v[40:43]
  ds_read_b64 v[84:85], v192 offset:2688
  v_mfma_f32_16x16x32_bf16 v[44:47], v[140:143], v[168:171], v[44:47]
  ds_read_b64 v[86:87], v192 offset:2696
  v_mfma_f32_16x16x32_bf16 v[48:51], v[140:143], v[172:175], v[48:51]
  ds_read_b64 v[88:89], v192 offset:3200
  v_mfma_f32_16x16x32_bf16 v[52:55], v[140:143], v[176:179], v[52:55]
  ds_read_b64 v[90:91], v192 offset:3208
  v_mfma_f32_16x16x32_bf16 v[40:43], v[144:147], v[160:163], v[40:43]
  ds_read_b64 v[92:93], v192 offset:3712
  v_mfma_f32_16x16x32_bf16 v[44:47], v[144:147], v[164:167], v[44:47]
  ds_read_b64 v[94:95], v192 offset:3720
  v_mfma_f32_16x16x32_bf16 v[48:51], v[144:147], v[168:171], v[48:51]
  v_mfma_f32_16x16x32_bf16 v[52:55], v[144:147], v[172:175], v[52:55]
  v_mfma_f32_16x16x32_bf16 v[44:47], v[148:151], v[160:163], v[44:47]
  v_mfma_f32_16x16x32_bf16 v[48:51], v[148:151], v[164:167], v[48:51]
  v_mfma_f32_16x16x32_bf16 v[52:55], v[148:151], v[168:171], v[52:55]
  v_mfma_f32_16x16x32_bf16 v[48:51], v[152:155], v[160:163], v[48:51]
  v_mfma_f32_16x16x32_bf16 v[52:55], v[152:155], v[164:167], v[52:55]
  v_mfma_f32_16x16x32_bf16 v[52:55], v[156:159], v[160:163], v[52:55]
  s_waitcnt lgkmcnt(0)
  v_mfma_f32_16x16x32_bf16 v[40:43], v[64:67], v[112:115], v[40:43]
  ds_read_b128 v[160:163], v193 offset:256
  s_mov_b32 s96, 0
  buffer_store_dwordx4 v[4:7], v211, s[52:55], s96 offen sc1
  v_mfma_f32_16x16x32_bf16 v[44:47], v[64:67], v[116:119], v[44:47]
  ds_read_b128 v[164:167], v193 offset:768
  s_mov_b32 s96, 4096
  buffer_store_dwordx4 v[8:11], v211, s[52:55], s96 offen sc1
  v_mfma_f32_16x16x32_bf16 v[48:51], v[64:67], v[120:123], v[48:51]
  ds_read_b128 v[168:171], v193 offset:1280
  ds_read_b128 v[172:175], v193 offset:1792
  v_mfma_f32_16x16x32_bf16 v[52:55], v[64:67], v[124:127], v[52:55]
  ds_read_b128 v[176:179], v193 offset:2304
  ds_read_b128 v[180:183], v193 offset:2816
  v_mfma_f32_16x16x32_bf16 v[40:43], v[68:71], v[108:111], v[40:43]
  ds_read_b128 v[184:187], v193 offset:3328
  ds_read_b128 v[188:191], v193 offset:3840
  v_mfma_f32_16x16x32_bf16 v[44:47], v[68:71], v[112:115], v[44:47]
  ds_read_b64 v[128:129], v192 offset:192
  ds_read_b64 v[130:131], v192 offset:200
  v_mfma_f32_16x16x32_bf16 v[48:51], v[68:71], v[116:119], v[48:51]
  ds_read_b64 v[132:133], v192 offset:704
  ds_read_b64 v[134:135], v192 offset:712
  v_mfma_f32_16x16x32_bf16 v[52:55], v[68:71], v[120:123], v[52:55]
  ds_read_b64 v[136:137], v192 offset:1216
  ds_read_b64 v[138:139], v192 offset:1224
  v_mfma_f32_16x16x32_bf16 v[40:43], v[72:75], v[104:107], v[40:43]
  ds_read_b64 v[140:141], v192 offset:1728
  v_mfma_f32_16x16x32_bf16 v[44:47], v[72:75], v[108:111], v[44:47]
  ds_read_b64 v[142:143], v192 offset:1736
  v_mfma_f32_16x16x32_bf16 v[48:51], v[72:75], v[112:115], v[48:51]
  ds_read_b64 v[144:145], v192 offset:2240
  v_mfma_f32_16x16x32_bf16 v[52:55], v[72:75], v[116:119], v[52:55]
  ds_read_b64 v[146:147], v192 offset:2248
  v_mfma_f32_16x16x32_bf16 v[40:43], v[76:79], v[100:103], v[40:43]
  ds_read_b64 v[148:149], v192 offset:2752
  v_mfma_f32_16x16x32_bf16 v[44:47], v[76:79], v[104:107], v[44:47]
  ds_read_b64 v[150:151], v192 offset:2760
  v_mfma_f32_16x16x32_bf16 v[48:51], v[76:79], v[108:111], v[48:51]
  ds_read_b64 v[152:153], v192 offset:3264
  v_mfma_f32_16x16x32_bf16 v[52:55], v[76:79], v[112:115], v[52:55]
  ds_read_b64 v[154:155], v192 offset:3272
  v_mfma_f32_16x16x32_bf16 v[40:43], v[80:83], v[96:99], v[40:43]
  ds_read_b64 v[156:157], v192 offset:3776
  v_mfma_f32_16x16x32_bf16 v[44:47], v[80:83], v[100:103], v[44:47]
  ds_read_b64 v[158:159], v192 offset:3784
  v_mfma_f32_16x16x32_bf16 v[48:51], v[80:83], v[104:107], v[48:51]
  v_mfma_f32_16x16x32_bf16 v[52:55], v[80:83], v[108:111], v[52:55]
  v_mfma_f32_16x16x32_bf16 v[44:47], v[84:87], v[96:99], v[44:47]
  v_mfma_f32_16x16x32_bf16 v[48:51], v[84:87], v[100:103], v[48:51]
  v_mfma_f32_16x16x32_bf16 v[52:55], v[84:87], v[104:107], v[52:55]
  v_mfma_f32_16x16x32_bf16 v[48:51], v[88:91], v[96:99], v[48:51]
  v_mfma_f32_16x16x32_bf16 v[52:55], v[88:91], v[100:103], v[52:55]
  v_mfma_f32_16x16x32_bf16 v[52:55], v[92:95], v[96:99], v[52:55]
  s_waitcnt lgkmcnt(0)
  v_mfma_f32_16x16x32_bf16 v[40:43], v[128:131], v[176:179], v[40:43]
  ds_read_b128 v[96:99], v193 offset:192
  ds_read_b128 v[100:103], v193 offset:704
  v_mfma_f32_16x16x32_bf16 v[44:47], v[128:131], v[180:183], v[44:47]
  ds_read_b128 v[104:107], v193 offset:1216
  ds_read_b128 v[108:111], v193 offset:1728
  v_mfma_f32_16x16x32_bf16 v[48:51], v[128:131], v[184:187], v[48:51]
  ds_read_b128 v[112:115], v193 offset:2240
  ds_read_b128 v[116:119], v193 offset:2752
  v_mfma_f32_16x16x32_bf16 v[52:55], v[128:131], v[188:191], v[52:55]
  ds_read_b128 v[120:123], v193 offset:3264
  ds_read_b128 v[124:127], v193 offset:3776
  v_mfma_f32_16x16x32_bf16 v[40:43], v[132:135], v[172:175], v[40:43]
  ds_read_b64 v[64:65], v192 offset:256
  ds_read_b64 v[66:67], v192 offset:264
  v_mfma_f32_16x16x32_bf16 v[44:47], v[132:135], v[176:179], v[44:47]
  ds_read_b64 v[68:69], v192 offset:768
  ds_read_b64 v[70:71], v192 offset:776
  v_mfma_f32_16x16x32_bf16 v[48:51], v[132:135], v[180:183], v[48:51]
  ds_read_b64 v[72:73], v192 offset:1280
  v_mfma_f32_16x16x32_bf16 v[52:55], v[132:135], v[184:187], v[52:55]
  ds_read_b64 v[74:75], v192 offset:1288
  v_mfma_f32_16x16x32_bf16 v[40:43], v[136:139], v[168:171], v[40:43]
  ds_read_b64 v[76:77], v192 offset:1792
  v_mfma_f32_16x16x32_bf16 v[44:47], v[136:139], v[172:175], v[44:47]
  ds_read_b64 v[78:79], v192 offset:1800
  v_mfma_f32_16x16x32_bf16 v[48:51], v[136:139], v[176:179], v[48:51]
  ds_read_b64 v[80:81], v192 offset:2304
  v_mfma_f32_16x16x32_bf16 v[52:55], v[136:139], v[180:183], v[52:55]
  ds_read_b64 v[82:83], v192 offset:2312
  v_mfma_f32_16x16x32_bf16 v[40:43], v[140:143], v[164:167], v[40:43]
  ds_read_b64 v[84:85], v192 offset:2816
  v_mfma_f32_16x16x32_bf16 v[44:47], v[140:143], v[168:171], v[44:47]
  ds_read_b64 v[86:87], v192 offset:2824
  v_mfma_f32_16x16x32_bf16 v[48:51], v[140:143], v[172:175], v[48:51]
  ds_read_b64 v[88:89], v192 offset:3328
  v_mfma_f32_16x16x32_bf16 v[52:55], v[140:143], v[176:179], v[52:55]
  ds_read_b64 v[90:91], v192 offset:3336
  v_mfma_f32_16x16x32_bf16 v[40:43], v[144:147], v[160:163], v[40:43]
  ds_read_b64 v[92:93], v192 offset:3840
  v_mfma_f32_16x16x32_bf16 v[44:47], v[144:147], v[164:167], v[44:47]
  ds_read_b64 v[94:95], v192 offset:3848
  v_mfma_f32_16x16x32_bf16 v[48:51], v[144:147], v[168:171], v[48:51]
  v_mfma_f32_16x16x32_bf16 v[52:55], v[144:147], v[172:175], v[52:55]
  v_mfma_f32_16x16x32_bf16 v[44:47], v[148:151], v[160:163], v[44:47]
  v_mfma_f32_16x16x32_bf16 v[48:51], v[148:151], v[164:167], v[48:51]
  v_mfma_f32_16x16x32_bf16 v[52:55], v[148:151], v[168:171], v[52:55]
  v_mfma_f32_16x16x32_bf16 v[48:51], v[152:155], v[160:163], v[48:51]
  v_mfma_f32_16x16x32_bf16 v[52:55], v[152:155], v[164:167], v[52:55]
  v_mfma_f32_16x16x32_bf16 v[52:55], v[156:159], v[160:163], v[52:55]
  s_waitcnt lgkmcnt(0)
  s_waitcnt vmcnt(0)
  s_add_u32 s96, s6, 0
  buffer_store_dword v23, off, s[60:63], s96 sc1
  s_add_u32 s96, s6, 73728
  buffer_store_dword v23, off, s[60:63], s96 sc1
  v_mfma_f32_16x16x32_bf16 v[40:43], v[64:67], v[112:115], v[40:43]
  ds_read_b128 v[160:163], v193 offset:128
  ds_read_b128 v[164:167], v193 offset:640
  v_mfma_f32_16x16x32_bf16 v[44:47], v[64:67], v[116:119], v[44:47]
  ds_read_b128 v[168:171], v193 offset:1152
  ds_read_b128 v[172:175], v193 offset:1664
  v_mfma_f32_16x16x32_bf16 v[48:51], v[64:67], v[120:123], v[48:51]
  ds_read_b128 v[176:179], v193 offset:2176
  ds_read_b128 v[180:183], v193 offset:2688
  v_mfma_f32_16x16x32_bf16 v[52:55], v[64:67], v[124:127], v[52:55]
  ds_read_b128 v[184:187], v193 offset:3200
  ds_read_b128 v[188:191], v193 offset:3712
  v_mfma_f32_16x16x32_bf16 v[40:43], v[68:71], v[108:111], v[40:43]
  ds_read_b64 v[128:129], v192 offset:320
  ds_read_b64 v[130:131], v192 offset:328
  v_mfma_f32_16x16x32_bf16 v[44:47], v[68:71], v[112:115], v[44:47]
  ds_read_b64 v[132:133], v192 offset:832
  ds_read_b64 v[134:135], v192 offset:840
  v_mfma_f32_16x16x32_bf16 v[48:51], v[68:71], v[116:119], v[48:51]
  ds_read_b64 v[136:137], v192 offset:1344
  v_mfma_f32_16x16x32_bf16 v[52:55], v[68:71], v[120:123], v[52:55]
  ds_read_b64 v[138:139], v192 offset:1352
  v_mfma_f32_16x16x32_bf16 v[40:43], v[72:75], v[104:107], v[40:43]
  ds_read_b64 v[140:141], v192 offset:1856
  v_mfma_f32_16x16x32_bf16 v[44:47], v[72:75], v[108:111], v[44:47]
  ds_read_b64 v[142:143], v192 offset:1864
  v_mfma_f32_16x16x32_bf16 v[48:51], v[72:75], v[112:115], v[48:51]
  ds_read_b64 v[144:145], v192 offset:2368
  v_mfma_f32_16x16x32_bf16 v[52:55], v[72:75], v[116:119], v[52:55]
  ds_read_b64 v[146:147], v192 offset:2376
  v_mfma_f32_16x16x32_bf16 v[40:43], v[76:79], v[100:103], v[40:43]
  ds_read_b64 v[148:149], v192 offset:2880
  v_mfma_f32_16x16x32_bf16 v[44:47], v[76:79], v[104:107], v[44:47]
  ds_read_b64 v[150:151], v192 offset:2888
  v_mfma_f32_16x16x32_bf16 v[48:51], v[76:79], v[108:111], v[48:51]
  ds_read_b64 v[152:153], v192 offset:3392
  v_mfma_f32_16x16x32_bf16 v[52:55], v[76:79], v[112:115], v[52:55]
  ds_read_b64 v[154:155], v192 offset:3400
  v_mfma_f32_16x16x32_bf16 v[40:43], v[80:83], v[96:99], v[40:43]
  ds_read_b64 v[156:157], v192 offset:3904
  v_mfma_f32_16x16x32_bf16 v[44:47], v[80:83], v[100:103], v[44:47]
  ds_read_b64 v[158:159], v192 offset:3912
  v_mfma_f32_16x16x32_bf16 v[48:51], v[80:83], v[104:107], v[48:51]
  v_mfma_f32_16x16x32_bf16 v[52:55], v[80:83], v[108:111], v[52:55]
  v_mfma_f32_16x16x32_bf16 v[44:47], v[84:87], v[96:99], v[44:47]
  v_mfma_f32_16x16x32_bf16 v[48:51], v[84:87], v[100:103], v[48:51]
  v_mfma_f32_16x16x32_bf16 v[52:55], v[84:87], v[104:107], v[52:55]
  v_mfma_f32_16x16x32_bf16 v[48:51], v[88:91], v[96:99], v[48:51]
  v_mfma_f32_16x16x32_bf16 v[52:55], v[88:91], v[100:103], v[52:55]
  v_mfma_f32_16x16x32_bf16 v[52:55], v[92:95], v[96:99], v[52:55]
  s_waitcnt lgkmcnt(0)
  v_mfma_f32_16x16x32_bf16 v[40:43], v[128:131], v[176:179], v[40:43]
  ds_read_b128 v[96:99], v193 offset:64
  ds_read_b128 v[100:103], v193 offset:576
  v_mfma_f32_16x16x32_bf16 v[44:47], v[128:131], v[180:183], v[44:47]
  ds_read_b128 v[104:107], v193 offset:1088
  ds_read_b128 v[108:111], v193 offset:1600
  v_mfma_f32_16x16x32_bf16 v[48:51], v[128:131], v[184:187], v[48:51]
  ds_read_b128 v[112:115], v193 offset:2112
  ds_read_b128 v[116:119], v193 offset:2624
  v_mfma_f32_16x16x32_bf16 v[52:55], v[128:131], v[188:191], v[52:55]
  ds_read_b128 v[120:123], v193 offset:3136
  ds_read_b128 v[124:127], v193 offset:3648
  v_mfma_f32_16x16x32_bf16 v[40:43], v[132:135], v[172:175], v[40:43]
  ds_read_b64 v[64:65], v192 offset:384
  ds_read_b64 v[66:67], v192 offset:392
  v_mfma_f32_16x16x32_bf16 v[44:47], v[132:135], v[176:179], v[44:47]
  ds_read_b64 v[68:69], v192 offset:896
  ds_read_b64 v[70:71], v192 offset:904
  v_mfma_f32_16x16x32_bf16 v[48:51], v[132:135], v[180:183], v[48:51]
  ds_read_b64 v[72:73], v192 offset:1408
  v_mfma_f32_16x16x32_bf16 v[52:55], v[132:135], v[184:187], v[52:55]
  ds_read_b64 v[74:75], v192 offset:1416
  v_mfma_f32_16x16x32_bf16 v[40:43], v[136:139], v[168:171], v[40:43]
  ds_read_b64 v[76:77], v192 offset:1920
  v_mfma_f32_16x16x32_bf16 v[44:47], v[136:139], v[172:175], v[44:47]
  ds_read_b64 v[78:79], v192 offset:1928
  v_mfma_f32_16x16x32_bf16 v[48:51], v[136:139], v[176:179], v[48:51]
  ds_read_b64 v[80:81], v192 offset:2432
  v_mfma_f32_16x16x32_bf16 v[52:55], v[136:139], v[180:183], v[52:55]
  ds_read_b64 v[82:83], v192 offset:2440
  v_mfma_f32_16x16x32_bf16 v[40:43], v[140:143], v[164:167], v[40:43]
  ds_read_b64 v[84:85], v192 offset:2944
  v_mfma_f32_16x16x32_bf16 v[44:47], v[140:143], v[168:171], v[44:47]
  ds_read_b64 v[86:87], v192 offset:2952
  v_mfma_f32_16x16x32_bf16 v[48:51], v[140:143], v[172:175], v[48:51]
  ds_read_b64 v[88:89], v192 offset:3456
  v_mfma_f32_16x16x32_bf16 v[52:55], v[140:143], v[176:179], v[52:55]
  ds_read_b64 v[90:91], v192 offset:3464
  v_mfma_f32_16x16x32_bf16 v[40:43], v[144:147], v[160:163], v[40:43]
  ds_read_b64 v[92:93], v192 offset:3968
  v_mfma_f32_16x16x32_bf16 v[44:47], v[144:147], v[164:167], v[44:47]
  ds_read_b64 v[94:95], v192 offset:3976
  v_mfma_f32_16x16x32_bf16 v[48:51], v[144:147], v[168:171], v[48:51]
  v_mfma_f32_16x16x32_bf16 v[52:55], v[144:147], v[172:175], v[52:55]
  v_mfma_f32_16x16x32_bf16 v[44:47], v[148:151], v[160:163], v[44:47]
  v_mfma_f32_16x16x32_bf16 v[48:51], v[148:151], v[164:167], v[48:51]
  v_mfma_f32_16x16x32_bf16 v[52:55], v[148:151], v[168:171], v[52:55]
  v_mfma_f32_16x16x32_bf16 v[48:51], v[152:155], v[160:163], v[48:51]
  v_mfma_f32_16x16x32_bf16 v[52:55], v[152:155], v[164:167], v[52:55]
  v_mfma_f32_16x16x32_bf16 v[52:55], v[156:159], v[160:163], v[52:55]
  s_waitcnt lgkmcnt(0)
  v_mfma_f32_16x16x32_bf16 v[40:43], v[64:67], v[112:115], v[40:43]
  ds_read_b128 v[160:163], v193 offset:0
  buffer_load_dword v239, v214, s[60:63], s90 offen sc1
  v_mfma_f32_16x16x32_bf16 v[44:47], v[64:67], v[116:119], v[44:47]
  ds_read_b128 v[164:167], v193 offset:512
  buffer_load_dword v22, v214, s[60:63], s8 offen sc1
  v_mfma_f32_16x16x32_bf16 v[48:51], v[64:67], v[120:123], v[48:51]
  ds_read_b128 v[168:171], v193 offset:1024
  ds_read_b128 v[172:175], v193 offset:1536
  v_mfma_f32_16x16x32_bf16 v[52:55], v[64:67], v[124:127], v[52:55]
  ds_read_b128 v[176:179], v193 offset:2048
  ds_read_b128 v[180:183], v193 offset:2560
  v_mfma_f32_16x16x32_bf16 v[40:43], v[68:71], v[108:111], v[40:43]
  ds_read_b128 v[184:187], v193 offset:3072
  ds_read_b128 v[188:191], v193 offset:3584
  v_mfma_f32_16x16x32_bf16 v[44:47], v[68:71], v[112:115], v[44:47]
  ds_read_b64 v[128:129], v192 offset:448
  ds_read_b64 v[130:131], v192 offset:456
  v_mfma_f32_16x16x32_bf16 v[48:51], v[68:71], v[116:119], v[48:51]
  ds_read_b64 v[132:133], v192 offset:960
  ds_read_b64 v[134:135], v192 offset:968
  v_mfma_f32_16x16x32_bf16 v[52:55], v[68:71], v[120:123], v[52:55]
  ds_read_b64 v[136:137], v192 offset:1472
  ds_read_b64 v[138:139], v192 offset:1480
  v_mfma_f32_16x16x32_bf16 v[40:43], v[72:75], v[104:107], v[40:43]
  ds_read_b64 v[140:141], v192 offset:1984
  v_mfma_f32_16x16x32_bf16 v[44:47], v[72:75], v[108:111], v[44:47]
  ds_read_b64 v[142:143], v192 offset:1992
  v_mfma_f32_16x16x32_bf16 v[48:51], v[72:75], v[112:115], v[48:51]
  ds_read_b64 v[144:145], v192 offset:2496
  v_mfma_f32_16x16x32_bf16 v[52:55], v[72:75], v[116:119], v[52:55]
  ds_read_b64 v[146:147], v192 offset:2504
  v_mfma_f32_16x16x32_bf16 v[40:43], v[76:79], v[100:103], v[40:43]
  ds_read_b64 v[148:149], v192 offset:3008
  v_mfma_f32_16x16x32_bf16 v[44:47], v[76:79], v[104:107], v[44:47]
  ds_read_b64 v[150:151], v192 offset:3016
  v_mfma_f32_16x16x32_bf16 v[48:51], v[76:79], v[108:111], v[48:51]
  ds_read_b64 v[152:153], v192 offset:3520
  v_mfma_f32_16x16x32_bf16 v[52:55], v[76:79], v[112:115], v[52:55]
  ds_read_b64 v[154:155], v192 offset:3528
  v_mfma_f32_16x16x32_bf16 v[40:43], v[80:83], v[96:99], v[40:43]
  ds_read_b64 v[156:157], v192 offset:4032
  v_mfma_f32_16x16x32_bf16 v[44:47], v[80:83], v[100:103], v[44:47]
  ds_read_b64 v[158:159], v192 offset:4040
  v_mfma_f32_16x16x32_bf16 v[48:51], v[80:83], v[104:107], v[48:51]
  v_mfma_f32_16x16x32_bf16 v[52:55], v[80:83], v[108:111], v[52:55]
  v_mfma_f32_16x16x32_bf16 v[44:47], v[84:87], v[96:99], v[44:47]
  v_mfma_f32_16x16x32_bf16 v[48:51], v[84:87], v[100:103], v[48:51]
  v_mfma_f32_16x16x32_bf16 v[52:55], v[84:87], v[104:107], v[52:55]
  v_mfma_f32_16x16x32_bf16 v[48:51], v[88:91], v[96:99], v[48:51]
  v_mfma_f32_16x16x32_bf16 v[52:55], v[88:91], v[100:103], v[52:55]
  v_mfma_f32_16x16x32_bf16 v[52:55], v[92:95], v[96:99], v[52:55]
  s_waitcnt lgkmcnt(0)
  v_mfma_f32_16x16x32_bf16 v[40:43], v[128:131], v[176:179], v[40:43]
  v_mfma_f32_16x16x32_bf16 v[44:47], v[128:131], v[180:183], v[44:47]
  v_mfma_f32_16x16x32_bf16 v[48:51], v[128:131], v[184:187], v[48:51]
  v_mfma_f32_16x16x32_bf16 v[52:55], v[128:131], v[188:191], v[52:55]
  v_mfma_f32_16x16x32_bf16 v[40:43], v[132:135], v[172:175], v[40:43]
  v_mfma_f32_16x16x32_bf16 v[44:47], v[132:135], v[176:179], v[44:47]
  v_mfma_f32_16x16x32_bf16 v[48:51], v[132:135], v[180:183], v[48:51]
  v_mfma_f32_16x16x32_bf16 v[52:55], v[132:135], v[184:187], v[52:55]
  v_mfma_f32_16x16x32_bf16 v[40:43], v[136:139], v[168:171], v[40:43]
  v_mfma_f32_16x16x32_bf16 v[44:47], v[136:139], v[172:175], v[44:47]
  v_mfma_f32_16x16x32_bf16 v[48:51], v[136:139], v[176:179], v[48:51]
  v_mfma_f32_16x16x32_bf16 v[52:55], v[136:139], v[180:183], v[52:55]
  v_mfma_f32_16x16x32_bf16 v[40:43], v[140:143], v[164:167], v[40:43]
  v_mfma_f32_16x16x32_bf16 v[44:47], v[140:143], v[168:171], v[44:47]
  v_mfma_f32_16x16x32_bf16 v[48:51], v[140:143], v[172:175], v[48:51]
  v_mfma_f32_16x16x32_bf16 v[52:55], v[140:143], v[176:179], v[52:55]
  v_mfma_f32_16x16x32_bf16 v[40:43], v[144:147], v[160:163], v[40:43]
  v_mfma_f32_16x16x32_bf16 v[44:47], v[144:147], v[164:167], v[44:47]
  v_mfma_f32_16x16x32_bf16 v[48:51], v[144:147], v[168:171], v[48:51]
  v_mfma_f32_16x16x32_bf16 v[52:55], v[144:147], v[172:175], v[52:55]
  v_mfma_f32_16x16x32_bf16 v[44:47], v[148:151], v[160:163], v[44:47]
  v_mfma_f32_16x16x32_bf16 v[48:51], v[148:151], v[164:167], v[48:51]
  v_mfma_f32_16x16x32_bf16 v[52:55], v[148:151], v[168:171], v[52:55]
  v_mfma_f32_16x16x32_bf16 v[48:51], v[152:155], v[160:163], v[48:51]
  v_mfma_f32_16x16x32_bf16 v[52:55], v[152:155], v[164:167], v[52:55]
  v_mfma_f32_16x16x32_bf16 v[52:55], v[156:159], v[160:163], v[52:55]
  s_nop 7
  v_cvt_pk_bf16_f32 v72, v40, v42
  v_cvt_pk_bf16_f32 v73, v41, v43
  ds_write2st64_b32 v194, v72, v73 offset0:4 offset1:12
  v_cvt_pk_bf16_f32 v74, v44, v46
  v_cvt_pk_bf16_f32 v75, v45, v47
  ds_write2st64_b32 v194, v74, v75 offset0:5 offset1:13
  v_cvt_pk_bf16_f32 v76, v48, v50
  v_cvt_pk_bf16_f32 v77, v49, v51
  ds_write2st64_b32 v194, v76, v77 offset0:6 offset1:14
  v_cvt_pk_bf16_f32 v78, v52, v54
  v_cvt_pk_bf16_f32 v79, v53, v55
  ds_write2st64_b32 v194, v78, v79 offset0:7 offset1:15
  s_waitcnt lgkmcnt(0)
  s_barrier
  ds_read_b64_tr_b16 v[80:81], v195 offset:1024
  ds_read_b64_tr_b16 v[82:83], v195 offset:3072
  ds_read_b64_tr_b16 v[84:85], v195 offset:1536
  ds_read_b64_tr_b16 v[86:87], v195 offset:3584
  s_waitcnt lgkmcnt(2)
  s_mov_b32 s96, 8192
  buffer_store_dwordx4 v[80:83], v211, s[52:55], s96 offen sc1
  s_waitcnt lgkmcnt(0)
  s_mov_b32 s96, 12288
  buffer_store_dwordx4 v[84:87], v211, s[52:55], s96 offen sc1
  s_waitcnt vmcnt(0)
  s_add_u32 s96, s6, 147456
  buffer_store_dword v23, off, s[60:63], s96 sc1
  s_add_u32 s96, s6, 221184
  buffer_store_dword v23, off, s[60:63], s96 sc1
  v_mov_b32 v150, 0
  v_mov_b32 v151, 0
  v_bfe_u32 v152, v254, 5, 1
  v_and_b32 v153, 7, v254
  v_lshl_add_u32 v152, v152, 3, v153
  v_lshlrev_b32 v152, 4, v152
  s_lshl_b32 s3, s95, 2
  v_add_u32 v152, 147456, v152
  v_add_u32 v153, s3, v152
  v_dot2_f32_bf16 v150, v240, s97, v150
  v_dot2_f32_bf16 v151, v240, v240, v151
  v_dot2_f32_bf16 v150, v241, s97, v150
  v_dot2_f32_bf16 v151, v241, v241, v151
  v_dot2_f32_bf16 v150, v242, s97, v150
  v_dot2_f32_bf16 v151, v242, v242, v151
  v_dot2_f32_bf16 v150, v243, s97, v150
  v_dot2_f32_bf16 v151, v243, v243, v151
  v_dot2_f32_bf16 v150, v244, s97, v150
  v_dot2_f32_bf16 v151, v244, v244, v151
  v_dot2_f32_bf16 v150, v245, s97, v150
  v_dot2_f32_bf16 v151, v245, v245, v151
  v_dot2_f32_bf16 v150, v246, s97, v150
  v_dot2_f32_bf16 v151, v246, v246, v151
  v_dot2_f32_bf16 v150, v247, s97, v150
  v_dot2_f32_bf16 v151, v247, v247, v151
  v_dot2_f32_bf16 v150, v248, s97, v150
  v_dot2_f32_bf16 v151, v248, v248, v151
  v_dot2_f32_bf16 v150, v249, s97, v150
  v_dot2_f32_bf16 v151, v249, v249, v151
  v_dot2_f32_bf16 v150, v250, s97, v150
  v_dot2_f32_bf16 v151, v250, v250, v151
  v_dot2_f32_bf16 v150, v251, s97, v150
  v_dot2_f32_bf16 v151, v251, v251, v151
  s_nop 2
  v_permlane32_swap_b32 v150, v151
  s_nop 1
  v_add_f32 v150, v150, v151
  v_mov_b32 v151, v150
  s_nop 1
  v_permlane16_swap_b32 v150, v151
  s_nop 1
  v_add_f32 v150, v150, v151
  s_nop 1
  v_add_f32_dpp v150, v150, v150 row_ror:8 row_mask:0xf bank_mask:0xf
  ds_write_b32 v153, v150
  s_waitcnt lgkmcnt(0)
  s_barrier
  v_cmp_ne_u32 vcc, s94, v239
  v_cmp_ne_u32 s[4:5], s94, v22
  s_nop 1
  s_or_b64 vcc, vcc, s[4:5]
  s_cbranch_vccz L_modok
  s_mov_b32 s96, 0
L_poll3:
  buffer_load_dword v239, v214, s[60:63], s90 offen sc1
  s_add_u32 s96, s96, 1
  s_waitcnt vmcnt(0)
  v_cmp_ne_u32 vcc, s94, v239
  s_cbranch_vccz L_pd4
  s_sleep 1
  s_cmp_lt_u32 s96, 200000
  s_cbranch_scc1 L_poll3
L_pd4:
  s_mov_b32 s96, 0
L_poll5:
  buffer_load_dword v239, v214, s[60:63], s8 offen sc1
  s_add_u32 s96, s96, 1
  s_waitcnt vmcnt(0)
  v_cmp_ne_u32 vcc, s94, v239
  s_cbranch_vccz L_pd6
  s_sleep 1
  s_cmp_lt_u32 s96, 200000
  s_cbranch_scc1 L_poll5
L_pd6:
L_modok:
  s_add_u32 s56, s92, 0x900000
  s_addc_u32 s57, s93, 0
  s_mov_b32 s58, 0x3600
  s_mov_b32 s59, 0x20000
  s_mul_i32 s91, s95, 3584
  s_add_u32 m0, s91, 148480
  s_nop 0
  buffer_load_dwordx4 v225, s[56:59], s91 offen offset:0 sc1 lds
  buffer_load_dwordx4 v225, s[56:59], s91 offen offset:1024 sc1 lds
  buffer_load_dwordx4 v225, s[56:59], s91 offen offset:2048 sc1 lds
  buffer_load_dwordx4 v225, s[56:59], s91 offen offset:3072 sc1 lds
  ds_read_b128 v[154:157], v152
  s_waitcnt lgkmcnt(0)
  v_add_f32 v154, v154, v155
  v_add_f32 v156, v156, v157
  v_add_f32 v150, v154, v156
  v_mul_f32 v150, 0x3ae38e39, v150
  v_mov_b32 v151, v150
  s_nop 1
  v_permlane32_swap_b32 v150, v151
  s_nop 1
  v_fma_f32 v151, -v150, v150, v151
  v_max_f32 v151, 0, v151
  v_add_f32 v151, 0x3727c5ac, v151
  v_rsq_f32 v252, v151
  s_nop 0
  v_mul_f32 v253, v150, v252
  v_sub_f32 v253, 0, v253
  s_branch L_common
L_xslow0:
  s_mov_b32 s96, 0
L_xspin0:
  buffer_load_dword v211, off, s[60:63], s101 sc1
  s_add_u32 s96, s96, 1
  s_waitcnt vmcnt(0)
  v_cmp_ne_u32 vcc, s94, v211
  s_cbranch_vccz L_xok0
  s_cmp_lt_u32 s96, 200000
  s_cbranch_scc1 L_xspin0
  s_branch L_xok0
L_xslow1:
  s_mov_b32 s96, 0
L_xspin1:
  buffer_load_dword v211, off, s[60:63], s101 offset:128 sc1
  s_add_u32 s96, s96, 1
  s_waitcnt vmcnt(0)
  v_cmp_ne_u32 vcc, s94, v211
  s_cbranch_vccz L_xok1
  s_cmp_lt_u32 s96, 200000
  s_cbranch_scc1 L_xspin1
  s_branch L_xok1
L_side:
  s_waitcnt lgkmcnt(0)
  s_lshr_b32 s3, s2, 3
  s_lshr_b32 s49, s3, 1
  s_add_u32 s6, s49, 7
  s_sub_u32 s7, s49, 9
  s_cmp_lt_u32 s7, 7
  s_cselect_b32 s7, s7, s49
  s_cmp_lt_u32 s49, 9
  s_cselect_b32 s49, s6, s7
  s_and_b32 s3, s3, 1
  s_and_b32 s50, s2, 7
  s_lshl_b32 s50, s50, 1
  s_add_u32 s50, s50, s3
  s_mov_b32 s97, 0x3f803f80
  s_cmp_eq_u32 s95, 0
  s_cselect_b32 s51, 0, 0x40000000
  s_add_u32 s4, s92, 0xa00000
  s_addc_u32 s5, s93, 0
  s_load_dword s28, s[4:5], 0
  s_add_u32 s60, s92, 0xa10000
  s_addc_u32 s61, s93, 0
  s_mov_b32 s62, 0x120000
  s_mov_b32 s63, 0x20000
  s_getpc_b64 s[4:5]
L_pc_2:
  s_add_u32 s56, s4, L_common-L_pc_2
  s_addc_u32 s57, s5, 0
  s_mov_b32 s58, L_code_end-L_common
  s_mov_b32 s59, 0x20000
  s_mov_b32 s52, s72
  s_mov_b32 s53, s73
  s_mov_b32 s54, 0x240000
  s_mov_b32 s55, 0x20000
  s_sub_u32 s47, s2, 144
  s_lshr_b32 s47, s47, 3
  s_lshl_b32 s47, s47, 2
  s_add_u32 s47, s47, s95
  v_min_u32 v2, 7, v254
  s_lshl_b32 s43, s47, 10
  v_lshlrev_b32 v2, 7, v2
  buffer_load_dword v238, v2, s[56:59], s43 offen
  s_mul_i32 s42, s47, 42
  v_min_u32 v1, 41, v254
  v_add_u32 v1, s42, v1
  v_lshrrev_b32 v2, 7, v1
  v_and_b32 v1, 127, v1
  v_lshlrev_b32 v1, 7, v1
  v_lshl_add_u32 v1, v2, 17, v1
  s_and_b32 s3, s2, 7
  s_lshl_b32 s3, s3, 14
  s_mul_hi_u32 s42, s47, 0x2aaaaaab
  s_mul_i32 s43, s42, 6
  s_sub_u32 s43, s47, s43
  s_mul_i32 s43, s43, 3072
  s_add_u32 s42, s42, 7
  s_mul_i32 s42, s42, 147456
  s_add_u32 s42, s42, s43
  s_and_b32 s3, s2, 7
  s_mul_i32 s3, s3, 18432
  s_add_u32 s42, s42, s3
  v_min_u32 v1, 23, v254
  v_lshlrev_b32 v1, 7, v1
  s_mov_b32 s52, s64
  s_mov_b32 s53, s65
  s_mov_b32 s54, 0x240000
  s_mov_b32 s55, 0x20000
  s_cmp_ge_u32 s2, 198
  s_cbranch_scc1 L_nomod
  s_sub_u32 s40, s2, 144
  v_and_b32 v1, 7, v0
  v_lshrrev_b32 v2, 3, v0
  v_mul_u32_u24 v3, 6912, v2
  v_lshl_add_u32 v3, v1, 4, v3
  s_lshl_b32 s3, s40, 7
  v_add_u32 v3, s3, v3
  v_lshlrev_b32 v4, 1, v0
  s_mov_b32 s24, s84
  s_mov_b32 s25, s85
  s_mov_b32 s26, 0x480
  s_mov_b32 s27, 0x20000
  s_mov_b32 s52, s86
  s_mov_b32 s53, s87
  s_mov_b32 s54, 0x3cc000
  s_mov_b32 s55, 0x20000
  s_add_u32 s20, s92, 0x900000
  s_addc_u32 s21, s93, 0
  s_mov_b32 s22, 0x3600
  s_mov_b32 s23, 0x20000
  buffer_load_ushort v5, v4, s[24:27], 0 offen
  buffer_load_ushort v6, v4, s[24:27], 0 offen offset:512
  buffer_load_ushort v7, v4, s[24:27], 0 offen offset:1024
  s_mov_b32 s41, 0
  s_waitcnt vmcnt(0)
  buffer_load_dwordx4 v[32:35], v3, s[52:55], s41 offen nt
  s_add_u32 s41, s41, 221184
  buffer_load_dwordx4 v[36:39], v3, s[52:55], s41 offen nt
  s_add_u32 s41, s41, 221184
  buffer_load_dwordx4 v[40:43], v3, s[52:55], s41 offen nt
  s_add_u32 s41, s41, 221184
  buffer_load_dwordx4 v[44:47], v3, s[52:55], s41 offen nt
  s_add_u32 s41, s41, 221184
  buffer_load_dwordx4 v[48:51], v3, s[52:55], s41 offen nt
  s_add_u32 s41, s41, 221184
  buffer_load_dwordx4 v[52:55], v3, s[52:55], s41 offen nt
  s_add_u32 s41, s41, 221184
  buffer_load_dwordx4 v[56:59], v3, s[52:55], s41 offen nt
  s_add_u32 s41, s41, 221184
  buffer_load_dwordx4 v[60:63], v3, s[52:55], s41 offen nt
  s_add_u32 s41, s41, 221184
  buffer_load_dwordx4 v[64:67], v3, s[52:55], s41 offen nt
  s_add_u32 s41, s41, 221184
  buffer_load_dwordx4 v[68:71], v3, s[52:55], s41 offen nt
  s_add_u32 s41, s41, 221184
  buffer_load_dwordx4 v[72:75], v3, s[52:55], s41 offen nt
  s_add_u32 s41, s41, 221184
  buffer_load_dwordx4 v[76:79], v3, s[52:55], s41 offen nt
  s_add_u32 s41, s41, 221184
  buffer_load_dwordx4 v[80:83], v3, s[52:55], s41 offen nt
  s_add_u32 s41, s41, 221184
  buffer_load_dwordx4 v[84:87], v3, s[52:55], s41 offen nt
  s_add_u32 s41, s41, 221184
  buffer_load_dwordx4 v[88:91], v3, s[52:55], s41 offen nt
  s_add_u32 s41, s41, 221184
  buffer_load_dwordx4 v[92:95], v3, s[52:55], s41 offen nt
  s_add_u32 s41, s41, 221184
  buffer_load_dwordx4 v[96:99], v3, s[52:55], s41 offen nt
  s_add_u32 s41, s41, 221184
  buffer_load_dwordx4 v[100:103], v3, s[52:55], s41 offen nt
  v_lshlrev_b32 v5, 16, v5
  v_mul_f32 v8, 0xbfb8aa3b, v5
  v_exp_f32 v8, v8
  s_nop 0
  v_add_f32 v8, 1.0, v8
  v_rcp_f32 v8, v8
  s_nop 0
  v_mul_f32 v5, v5, v8
  v_cvt_pk_bf16_f32 v5, v5, v5
  v_lshlrev_b32 v5, 16, v5
  v_lshlrev_b32 v6, 16, v6
  v_mul_f32 v8, 0xbfb8aa3b, v6
  v_exp_f32 v8, v8
  s_nop 0
  v_add_f32 v8, 1.0, v8
  v_rcp_f32 v8, v8
  s_nop 0
  v_mul_f32 v6, v6, v8
  v_cvt_pk_bf16_f32 v6, v6, v6
  v_lshlrev_b32 v6, 16, v6
  v_lshlrev_b32 v7, 16, v7
  v_mul_f32 v8, 0xbfb8aa3b, v7
  v_exp_f32 v8, v8
  s_nop 0
  v_add_f32 v8, 1.0, v8
  v_rcp_f32 v8, v8
  s_nop 0
  v_mul_f32 v7, v7, v8
  v_cvt_pk_bf16_f32 v7, v7, v7
  v_lshlrev_b32 v7, 16, v7
  v_lshlrev_b32 v9, 2, v0
  ds_write_b32 v9, v5
  ds_write_b32 v9, v6 offset:1024
  ds_write_b32 v9, v7 offset:2048
  v_lshlrev_b32 v10, 2, v2
  s_waitcnt lgkmcnt(0)
  s_barrier
  ds_read_b32 v104, v10 offset:0
  ds_read_b32 v106, v10 offset:128
  ds_read_b32 v108, v10 offset:256
  ds_read_b32 v110, v10 offset:384
  ds_read_b32 v112, v10 offset:512
  ds_read_b32 v114, v10 offset:640
  ds_read_b32 v116, v10 offset:768
  ds_read_b32 v118, v10 offset:896
  ds_read_b32 v120, v10 offset:1024
  ds_read_b32 v122, v10 offset:1152
  ds_read_b32 v124, v10 offset:1280
  ds_read_b32 v126, v10 offset:1408
  ds_read_b32 v128, v10 offset:1536
  ds_read_b32 v130, v10 offset:1664
  ds_read_b32 v132, v10 offset:1792
  ds_read_b32 v134, v10 offset:1920
  ds_read_b32 v136, v10 offset:2048
  ds_read_b32 v138, v10 offset:2176
  s_waitcnt lgkmcnt(0)
  s_waitcnt vmcnt(17)
  v_lshlrev_b32 v24, 16, v32
  v_and_b32 v25, 0xffff0000, v32
  v_pk_mul_f32 v[16:17], v[24:25], v[104:105] op_sel_hi:[1,0]
  v_lshlrev_b32 v26, 16, v33
  v_and_b32 v27, 0xffff0000, v33
  v_pk_mul_f32 v[18:19], v[26:27], v[104:105] op_sel_hi:[1,0]
  v_lshlrev_b32 v24, 16, v34
  v_and_b32 v25, 0xffff0000, v34
  v_pk_mul_f32 v[20:21], v[24:25], v[104:105] op_sel_hi:[1,0]
  v_lshlrev_b32 v26, 16, v35
  v_and_b32 v27, 0xffff0000, v35
  v_pk_mul_f32 v[22:23], v[26:27], v[104:105] op_sel_hi:[1,0]
  s_waitcnt vmcnt(16)
  v_lshlrev_b32 v24, 16, v36
  v_and_b32 v25, 0xffff0000, v36
  v_pk_fma_f32 v[16:17], v[24:25], v[106:107], v[16:17] op_sel_hi:[1,0,1]
  v_lshlrev_b32 v26, 16, v37
  v_and_b32 v27, 0xffff0000, v37
  v_pk_fma_f32 v[18:19], v[26:27], v[106:107], v[18:19] op_sel_hi:[1,0,1]
  v_lshlrev_b32 v24, 16, v38
  v_and_b32 v25, 0xffff0000, v38
  v_pk_fma_f32 v[20:21], v[24:25], v[106:107], v[20:21] op_sel_hi:[1,0,1]
  v_lshlrev_b32 v26, 16, v39
  v_and_b32 v27, 0xffff0000, v39
  v_pk_fma_f32 v[22:23], v[26:27], v[106:107], v[22:23] op_sel_hi:[1,0,1]
  s_waitcnt vmcnt(15)
  v_lshlrev_b32 v24, 16, v40
  v_and_b32 v25, 0xffff0000, v40
  v_pk_fma_f32 v[16:17], v[24:25], v[108:109], v[16:17] op_sel_hi:[1,0,1]
  v_lshlrev_b32 v26, 16, v41
  v_and_b32 v27, 0xffff0000, v41
  v_pk_fma_f32 v[18:19], v[26:27], v[108:109], v[18:19] op_sel_hi:[1,0,1]
  v_lshlrev_b32 v24, 16, v42
  v_and_b32 v25, 0xffff0000, v42
  v_pk_fma_f32 v[20:21], v[24:25], v[108:109], v[20:21] op_sel_hi:[1,0,1]
  v_lshlrev_b32 v26, 16, v43
  v_and_b32 v27, 0xffff0000, v43
  v_pk_fma_f32 v[22:23], v[26:27], v[108:109], v[22:23] op_sel_hi:[1,0,1]
  s_waitcnt vmcnt(14)
  v_lshlrev_b32 v24, 16, v44
  v_and_b32 v25, 0xffff0000, v44
  v_pk_fma_f32 v[16:17], v[24:25], v[110:111], v[16:17] op_sel_hi:[1,0,1]
  v_lshlrev_b32 v26, 16, v45
  v_and_b32 v27, 0xffff0000, v45
  v_pk_fma_f32 v[18:19], v[26:27], v[110:111], v[18:19] op_sel_hi:[1,0,1]
  v_lshlrev_b32 v24, 16, v46
  v_and_b32 v25, 0xffff0000, v46
  v_pk_fma_f32 v[20:21], v[24:25], v[110:111], v[20:21] op_sel_hi:[1,0,1]
  v_lshlrev_b32 v26, 16, v47
  v_and_b32 v27, 0xffff0000, v47
  v_pk_fma_f32 v[22:23], v[26:27], v[110:111], v[22:23] op_sel_hi:[1,0,1]
  s_waitcnt vmcnt(13)
  v_lshlrev_b32 v24, 16, v48
  v_and_b32 v25, 0xffff0000, v48
  v_pk_fma_f32 v[16:17], v[24:25], v[112:113], v[16:17] op_sel_hi:[1,0,1]
  v_lshlrev_b32 v26, 16, v49
  v_and_b32 v27, 0xffff0000, v49
  v_pk_fma_f32 v[18:19], v[26:27], v[112:113], v[18:19] op_sel_hi:[1,0,1]
  v_lshlrev_b32 v24, 16, v50
  v_and_b32 v25, 0xffff0000, v50
  v_pk_fma_f32 v[20:21], v[24:25], v[112:113], v[20:21] op_sel_hi:[1,0,1]
  v_lshlrev_b32 v26, 16, v51
  v_and_b32 v27, 0xffff0000, v51
  v_pk_fma_f32 v[22:23], v[26:27], v[112:113], v[22:23] op_sel_hi:[1,0,1]
  s_waitcnt vmcnt(12)
  v_lshlrev_b32 v24, 16, v52
  v_and_b32 v25, 0xffff0000, v52
  v_pk_fma_f32 v[16:17], v[24:25], v[114:115], v[16:17] op_sel_hi:[1,0,1]
  v_lshlrev_b32 v26, 16, v53
  v_and_b32 v27, 0xffff0000, v53
  v_pk_fma_f32 v[18:19], v[26:27], v[114:115], v[18:19] op_sel_hi:[1,0,1]
  v_lshlrev_b32 v24, 16, v54
  v_and_b32 v25, 0xffff0000, v54
  v_pk_fma_f32 v[20:21], v[24:25], v[114:115], v[20:21] op_sel_hi:[1,0,1]
  v_lshlrev_b32 v26, 16, v55
  v_and_b32 v27, 0xffff0000, v55
  v_pk_fma_f32 v[22:23], v[26:27], v[114:115], v[22:23] op_sel_hi:[1,0,1]
  s_waitcnt vmcnt(11)
  v_lshlrev_b32 v24, 16, v56
  v_and_b32 v25, 0xffff0000, v56
  v_pk_fma_f32 v[16:17], v[24:25], v[116:117], v[16:17] op_sel_hi:[1,0,1]
  v_lshlrev_b32 v26, 16, v57
  v_and_b32 v27, 0xffff0000, v57
  v_pk_fma_f32 v[18:19], v[26:27], v[116:117], v[18:19] op_sel_hi:[1,0,1]
  v_lshlrev_b32 v24, 16, v58
  v_and_b32 v25, 0xffff0000, v58
  v_pk_fma_f32 v[20:21], v[24:25], v[116:117], v[20:21] op_sel_hi:[1,0,1]
  v_lshlrev_b32 v26, 16, v59
  v_and_b32 v27, 0xffff0000, v59
  v_pk_fma_f32 v[22:23], v[26:27], v[116:117], v[22:23] op_sel_hi:[1,0,1]
  s_waitcnt vmcnt(10)
  v_lshlrev_b32 v24, 16, v60
  v_and_b32 v25, 0xffff0000, v60
  v_pk_fma_f32 v[16:17], v[24:25], v[118:119], v[16:17] op_sel_hi:[1,0,1]
  v_lshlrev_b32 v26, 16, v61
  v_and_b32 v27, 0xffff0000, v61
  v_pk_fma_f32 v[18:19], v[26:27], v[118:119], v[18:19] op_sel_hi:[1,0,1]
  v_lshlrev_b32 v24, 16, v62
  v_and_b32 v25, 0xffff0000, v62
  v_pk_fma_f32 v[20:21], v[24:25], v[118:119], v[20:21] op_sel_hi:[1,0,1]
  v_lshlrev_b32 v26, 16, v63
  v_and_b32 v27, 0xffff0000, v63
  v_pk_fma_f32 v[22:23], v[26:27], v[118:119], v[22:23] op_sel_hi:[1,0,1]
  s_waitcnt vmcnt(9)
  v_lshlrev_b32 v24, 16, v64
  v_and_b32 v25, 0xffff0000, v64
  v_pk_fma_f32 v[16:17], v[24:25], v[120:121], v[16:17] op_sel_hi:[1,0,1]
  v_lshlrev_b32 v26, 16, v65
  v_and_b32 v27, 0xffff0000, v65
  v_pk_fma_f32 v[18:19], v[26:27], v[120:121], v[18:19] op_sel_hi:[1,0,1]
  v_lshlrev_b32 v24, 16, v66
  v_and_b32 v25, 0xffff0000, v66
  v_pk_fma_f32 v[20:21], v[24:25], v[120:121], v[20:21] op_sel_hi:[1,0,1]
  v_lshlrev_b32 v26, 16, v67
  v_and_b32 v27, 0xffff0000, v67
  v_pk_fma_f32 v[22:23], v[26:27], v[120:121], v[22:23] op_sel_hi:[1,0,1]
  s_waitcnt vmcnt(8)
  v_lshlrev_b32 v24, 16, v68
  v_and_b32 v25, 0xffff0000, v68
  v_pk_fma_f32 v[16:17], v[24:25], v[122:123], v[16:17] op_sel_hi:[1,0,1]
  v_lshlrev_b32 v26, 16, v69
  v_and_b32 v27, 0xffff0000, v69
  v_pk_fma_f32 v[18:19], v[26:27], v[122:123], v[18:19] op_sel_hi:[1,0,1]
  v_lshlrev_b32 v24, 16, v70
  v_and_b32 v25, 0xffff0000, v70
  v_pk_fma_f32 v[20:21], v[24:25], v[122:123], v[20:21] op_sel_hi:[1,0,1]
  v_lshlrev_b32 v26, 16, v71
  v_and_b32 v27, 0xffff0000, v71
  v_pk_fma_f32 v[22:23], v[26:27], v[122:123], v[22:23] op_sel_hi:[1,0,1]
  s_waitcnt vmcnt(7)
  v_lshlrev_b32 v24, 16, v72
  v_and_b32 v25, 0xffff0000, v72
  v_pk_fma_f32 v[16:17], v[24:25], v[124:125], v[16:17] op_sel_hi:[1,0,1]
  v_lshlrev_b32 v26, 16, v73
  v_and_b32 v27, 0xffff0000, v73
  v_pk_fma_f32 v[18:19], v[26:27], v[124:125], v[18:19] op_sel_hi:[1,0,1]
  v_lshlrev_b32 v24, 16, v74
  v_and_b32 v25, 0xffff0000, v74
  v_pk_fma_f32 v[20:21], v[24:25], v[124:125], v[20:21] op_sel_hi:[1,0,1]
  v_lshlrev_b32 v26, 16, v75
  v_and_b32 v27, 0xffff0000, v75
  v_pk_fma_f32 v[22:23], v[26:27], v[124:125], v[22:23] op_sel_hi:[1,0,1]
  s_waitcnt vmcnt(6)
  v_lshlrev_b32 v24, 16, v76
  v_and_b32 v25, 0xffff0000, v76
  v_pk_fma_f32 v[16:17], v[24:25], v[126:127], v[16:17] op_sel_hi:[1,0,1]
  v_lshlrev_b32 v26, 16, v77
  v_and_b32 v27, 0xffff0000, v77
  v_pk_fma_f32 v[18:19], v[26:27], v[126:127], v[18:19] op_sel_hi:[1,0,1]
  v_lshlrev_b32 v24, 16, v78
  v_and_b32 v25, 0xffff0000, v78
  v_pk_fma_f32 v[20:21], v[24:25], v[126:127], v[20:21] op_sel_hi:[1,0,1]
  v_lshlrev_b32 v26, 16, v79
  v_and_b32 v27, 0xffff0000, v79
  v_pk_fma_f32 v[22:23], v[26:27], v[126:127], v[22:23] op_sel_hi:[1,0,1]
  s_waitcnt vmcnt(5)
  v_lshlrev_b32 v24, 16, v80
  v_and_b32 v25, 0xffff0000, v80
  v_pk_fma_f32 v[16:17], v[24:25], v[128:129], v[16:17] op_sel_hi:[1,0,1]
  v_lshlrev_b32 v26, 16, v81
  v_and_b32 v27, 0xffff0000, v81
  v_pk_fma_f32 v[18:19], v[26:27], v[128:129], v[18:19] op_sel_hi:[1,0,1]
  v_lshlrev_b32 v24, 16, v82
  v_and_b32 v25, 0xffff0000, v82
  v_pk_fma_f32 v[20:21], v[24:25], v[128:129], v[20:21] op_sel_hi:[1,0,1]
  v_lshlrev_b32 v26, 16, v83
  v_and_b32 v27, 0xffff0000, v83
  v_pk_fma_f32 v[22:23], v[26:27], v[128:129], v[22:23] op_sel_hi:[1,0,1]
  s_waitcnt vmcnt(4)
  v_lshlrev_b32 v24, 16, v84
  v_and_b32 v25, 0xffff0000, v84
  v_pk_fma_f32 v[16:17], v[24:25], v[130:131], v[16:17] op_sel_hi:[1,0,1]
  v_lshlrev_b32 v26, 16, v85
  v_and_b32 v27, 0xffff0000, v85
  v_pk_fma_f32 v[18:19], v[26:27], v[130:131], v[18:19] op_sel_hi:[1,0,1]
  v_lshlrev_b32 v24, 16, v86
  v_and_b32 v25, 0xffff0000, v86
  v_pk_fma_f32 v[20:21], v[24:25], v[130:131], v[20:21] op_sel_hi:[1,0,1]
  v_lshlrev_b32 v26, 16, v87
  v_and_b32 v27, 0xffff0000, v87
  v_pk_fma_f32 v[22:23], v[26:27], v[130:131], v[22:23] op_sel_hi:[1,0,1]
  s_waitcnt vmcnt(3)
  v_lshlrev_b32 v24, 16, v88
  v_and_b32 v25, 0xffff0000, v88
  v_pk_fma_f32 v[16:17], v[24:25], v[132:133], v[16:17] op_sel_hi:[1,0,1]
  v_lshlrev_b32 v26, 16, v89
  v_and_b32 v27, 0xffff0000, v89
  v_pk_fma_f32 v[18:19], v[26:27], v[132:133], v[18:19] op_sel_hi:[1,0,1]
  v_lshlrev_b32 v24, 16, v90
  v_and_b32 v25, 0xffff0000, v90
  v_pk_fma_f32 v[20:21], v[24:25], v[132:133], v[20:21] op_sel_hi:[1,0,1]
  v_lshlrev_b32 v26, 16, v91
  v_and_b32 v27, 0xffff0000, v91
  v_pk_fma_f32 v[22:23], v[26:27], v[132:133], v[22:23] op_sel_hi:[1,0,1]
  s_waitcnt vmcnt(2)
  v_lshlrev_b32 v24, 16, v92
  v_and_b32 v25, 0xffff0000, v92
  v_pk_fma_f32 v[16:17], v[24:25], v[134:135], v[16:17] op_sel_hi:[1,0,1]
  v_lshlrev_b32 v26, 16, v93
  v_and_b32 v27, 0xffff0000, v93
  v_pk_fma_f32 v[18:19], v[26:27], v[134:135], v[18:19] op_sel_hi:[1,0,1]
  v_lshlrev_b32 v24, 16, v94
  v_and_b32 v25, 0xffff0000, v94
  v_pk_fma_f32 v[20:21], v[24:25], v[134:135], v[20:21] op_sel_hi:[1,0,1]
  v_lshlrev_b32 v26, 16, v95
  v_and_b32 v27, 0xffff0000, v95
  v_pk_fma_f32 v[22:23], v[26:27], v[134:135], v[22:23] op_sel_hi:[1,0,1]
  s_waitcnt vmcnt(1)
  v_lshlrev_b32 v24, 16, v96
  v_and_b32 v25, 0xffff0000, v96
  v_pk_fma_f32 v[16:17], v[24:25], v[136:137], v[16:17] op_sel_hi:[1,0,1]
  v_lshlrev_b32 v26, 16, v97
  v_and_b32 v27, 0xffff0000, v97
  v_pk_fma_f32 v[18:19], v[26:27], v[136:137], v[18:19] op_sel_hi:[1,0,1]
  v_lshlrev_b32 v24, 16, v98
  v_and_b32 v25, 0xffff0000, v98
  v_pk_fma_f32 v[20:21], v[24:25], v[136:137], v[20:21] op_sel_hi:[1,0,1]
  v_lshlrev_b32 v26, 16, v99
  v_and_b32 v27, 0xffff0000, v99
  v_pk_fma_f32 v[22:23], v[26:27], v[136:137], v[22:23] op_sel_hi:[1,0,1]
  s_waitcnt vmcnt(0)
  v_lshlrev_b32 v24, 16, v100
  v_and_b32 v25, 0xffff0000, v100
  v_pk_fma_f32 v[16:17], v[24:25], v[138:139], v[16:17] op_sel_hi:[1,0,1]
  v_lshlrev_b32 v26, 16, v101
  v_and_b32 v27, 0xffff0000, v101
  v_pk_fma_f32 v[18:19], v[26:27], v[138:139], v[18:19] op_sel_hi:[1,0,1]
  v_lshlrev_b32 v24, 16, v102
  v_and_b32 v25, 0xffff0000, v102
  v_pk_fma_f32 v[20:21], v[24:25], v[138:139], v[20:21] op_sel_hi:[1,0,1]
  v_lshlrev_b32 v26, 16, v103
  v_and_b32 v27, 0xffff0000, v103
  v_pk_fma_f32 v[22:23], v[26:27], v[138:139], v[22:23] op_sel_hi:[1,0,1]
  v_lshlrev_b32 v13, 8, v2
  v_lshl_add_u32 v13, v1, 5, v13
  ds_write_b128 v13, v[16:19] offset:4096
  ds_write_b128 v13, v[20:23] offset:4112
  s_waitcnt lgkmcnt(0)
  s_barrier
  s_cmp_lg_u32 s95, 0
  s_cbranch_scc1 L_nomod
  ds_read_b32 v32, v9 offset:4096
  ds_read_b32 v33, v9 offset:4352
  ds_read_b32 v34, v9 offset:4608
  ds_read_b32 v35, v9 offset:4864
  ds_read_b32 v36, v9 offset:5120
  ds_read_b32 v37, v9 offset:5376
  ds_read_b32 v38, v9 offset:5632
  ds_read_b32 v39, v9 offset:5888
  ds_read_b32 v40, v9 offset:6144
  ds_read_b32 v41, v9 offset:6400
  ds_read_b32 v42, v9 offset:6656
  ds_read_b32 v43, v9 offset:6912
  ds_read_b32 v44, v9 offset:7168
  ds_read_b32 v45, v9 offset:7424
  ds_read_b32 v46, v9 offset:7680
  ds_read_b32 v47, v9 offset:7936
  ds_read_b32 v48, v9 offset:8192
  ds_read_b32 v49, v9 offset:8448
  ds_read_b32 v50, v9 offset:8704
  ds_read_b32 v51, v9 offset:8960
  ds_read_b32 v52, v9 offset:9216
  ds_read_b32 v53, v9 offset:9472
  ds_read_b32 v54, v9 offset:9728
  ds_read_b32 v55, v9 offset:9984
  ds_read_b32 v56, v9 offset:10240
  ds_read_b32 v57, v9 offset:10496
  ds_read_b32 v58, v9 offset:10752
  ds_read_b32 v59, v9 offset:11008
  ds_read_b32 v60, v9 offset:11264
  ds_read_b32 v61, v9 offset:11520
  ds_read_b32 v62, v9 offset:11776
  ds_read_b32 v63, v9 offset:12032
  s_waitcnt lgkmcnt(0)
  v_pk_add_f32 v[32:33], v[32:33], v[48:49]
  v_pk_add_f32 v[34:35], v[34:35], v[50:51]
  v_pk_add_f32 v[36:37], v[36:37], v[52:53]
  v_pk_add_f32 v[38:39], v[38:39], v[54:55]
  v_pk_add_f32 v[40:41], v[40:41], v[56:57]
  v_pk_add_f32 v[42:43], v[42:43], v[58:59]
  v_pk_add_f32 v[44:45], v[44:45], v[60:61]
  v_pk_add_f32 v[46:47], v[46:47], v[62:63]
  v_pk_add_f32 v[32:33], v[32:33], v[40:41]
  v_pk_add_f32 v[34:35], v[34:35], v[42:43]
  v_pk_add_f32 v[36:37], v[36:37], v[44:45]
  v_pk_add_f32 v[38:39], v[38:39], v[46:47]
  v_pk_add_f32 v[32:33], v[32:33], v[36:37]
  v_pk_add_f32 v[34:35], v[34:35], v[38:39]
  v_pk_add_f32 v[32:33], v[32:33], v[34:35]
  v_add_f32 v32, v32, v33
  s_mov_b32 s3, 0x1c71c71d
  v_cvt_pk_bf16_f32 v32, v32, v32
  s_mul_hi_u32 s41, s40, s3
  s_cmp_eq_u32 s41, 1
  s_cselect_b32 s42, 1.0, 0
  s_cmp_eq_u32 s41, 4
  s_cselect_b32 s42, 1.0, s42
  v_lshlrev_b32 v32, 16, v32
  v_add_f32 v32, s42, v32
  s_cmp_eq_u32 s41, 3
  s_cselect_b32 s43, 0x3eeff558, 1.0
  s_cmp_eq_u32 s41, 5
  s_cselect_b32 s43, 0x4091afa4, s43
  v_cvt_pk_bf16_f32 v32, v32, v32
  v_lshlrev_b32 v32, 16, v32
  v_mul_f32 v32, s43, v32
  s_lshl_b32 s3, s40, 8
  buffer_store_dword v32, v9, s[20:23], s3 offen sc1
L_nomod:
  s_waitcnt lgkmcnt(0)
  s_add_u32 s94, s28, 1
  s_waitcnt vmcnt(0)
  s_barrier
  s_cmp_lg_u32 s95, 0
  s_cbranch_scc1 L_sig7
  s_lshl_b32 s3, s2, 7
  s_add_u32 s3, s3, 32768
  v_mov_b32 v239, s94
  s_mov_b64 exec, 1
  buffer_store_dword v239, off, s[60:63], s3 sc1
  s_mov_b64 exec, -1
L_sig7:
  v_and_b32 v146, 15, v254
  v_lshlrev_b32 v146, 7, v146
  s_and_b32 s40, s2, 7
  s_lshl_b32 s4, s40, 11
  s_add_u32 s4, s4, 950272
  s_mov_b32 s96, 0
L_poll8:
  buffer_load_dword v239, v146, s[60:63], s4 offen sc1
  s_add_u32 s96, s96, 1
  s_waitcnt vmcnt(0)
  v_cmp_ne_u32 vcc, s94, v239
  s_cbranch_vccz L_pd9
  s_sleep 2
  s_cmp_lt_u32 s96, 200000
  s_cbranch_scc1 L_poll8
L_pd9:
  s_lshl_b32 s3, s49, 4
  s_add_u32 s3, s3, s50
  s_lshl_b32 s3, s3, 3
  v_and_b32 v146, 7, v254
  v_add_u32 v146, s3, v146
  v_bfe_u32 v147, v254, 3, 1
  v_lshlrev_b32 v147, 2, v147
  v_bfe_u32 v148, v254, 5, 1
  v_lshl_add_u32 v147, v148, 1, v147
  v_bfe_u32 v148, v254, 4, 1
  v_add_u32 v147, v147, v148
  s_lshr_b32 s3, s95, 1
  s_mul_i32 s3, s3, 3
  s_add_u32 s3, s3, s95
  s_lshl_b32 s3, s3, 3
  v_add_u32 v147, s3, v147
  s_mov_b32 s56, s64
  s_mov_b32 s57, s65
  s_mov_b32 s58, 0x240000
  s_mov_b32 s59, 0x20000
  v_mul_u32_u24 v146, 1152, v146
  v_lshl_add_u32 v146, v147, 4, v146
  buffer_load_dwordx4 v[240:243], v146, s[56:59], 0 offen nt
  buffer_load_dwordx4 v[244:247], v146, s[56:59], 0 offen offset:256 nt
  buffer_load_dwordx4 v[248:251], v146, s[56:59], s51 offen offset:512 nt
  s_mov_b32 s20, s78
  s_mov_b32 s21, s79
  s_mov_b32 s22, 0x510000
  s_mov_b32 s23, 0x20000
  s_mov_b32 s24, s80
  s_mov_b32 s25, s81
  s_mov_b32 s26, 0x510000
  s_mov_b32 s27, 0x20000
  s_and_b32 s40, s2, 7
  s_mul_i32 s43, s40, 1152
  s_and_b32 s40, s50, 0
  s_mul_i32 s40, s40, 640
  s_add_u32 s43, s43, s40
  s_sub_u32 s47, s2, 144
  s_lshr_b32 s47, s47, 3
  s_lshl_b32 s47, s47, 2
  s_add_u32 s47, s47, s95
  s_mul_i32 s42, s47, 62
  v_min_u32 v1, 61, v254
  v_add_u32 v1, s42, v1
  s_mov_b32 s44, 0x38e38f
  v_mul_hi_u32 v3, s44, v1
  v_mul_u32_u24 v4, 1152, v3
  v_sub_u32 v4, v1, v4
  v_lshlrev_b32 v3, 7, v3
  v_and_b32 v5, 1, v4
  v_mul_u32_u24 v5, 640, v5
  v_add_u32 v3, v3, v5
  v_lshrrev_b32 v4, 1, v4
  v_mul_u32_u24 v4, 9216, v4
  v_add_u32 v3, v3, v4
  buffer_load_dword v149, v3, s[20:23], s43 offen
  buffer_load_dword v149, v3, s[24:27], s43 offen
  s_lshr_b32 s4, s50, 1
  s_and_b32 s6, s50, 1
  s_mul_i32 s7, s4, 576
  s_mul_i32 s8, s6, 320
  s_add_u32 s8, s8, s7
  s_lshl_b32 s9, s6, 5
  s_add_u32 s9, s9, s7
  s_add_u32 s9, s9, 256
  s_lshl_b32 s31, s8, 1
  s_lshl_b32 s32, s9, 1
  s_lshl_b32 s10, s49, 2
  s_add_u32 s10, s10, s95
  s_mul_i32 s38, s10, 36864
  s_mul_i32 s29, s95, 6144
  s_lshl_b32 s30, s95, 10
  s_mov_b32 s37, 0xc09d30fc
  s_and_b32 s4, s95, 1
  s_mul_i32 s5, s4, 442368
  s_mul_i32 s6, s4, 884736
  s_mul_i32 s7, s95, 9216
  v_lshlrev_b32 v225, 4, v254
  v_lshrrev_b32 v100, 3, v254
  v_bfe_u32 v101, v254, 4, 1
  v_lshlrev_b32 v101, 1, v101
  v_and_b32 v102, 7, v254
  v_xor_b32 v101, v101, v102
  v_lshlrev_b32 v101, 4, v101
  v_mul_u32_u24 v103, 9216, v100
  v_add_u32 v103, s5, v103
  v_add_u32 v216, v103, v101
  v_xor_b32 v101, 64, v101
  v_add_u32 v217, v103, v101
  v_add_u32 v218, 145408, v216
  v_add_u32 v219, 218112, v217
  v_add_u32 v217, 72704, v217
  s_cmp_ge_u32 s95, 2
  s_cselect_b32 s12, s80, s78
  s_cselect_b32 s13, s81, s79
  s_mov_b32 s14, 0x510000
  s_mov_b32 s15, 0x20000
  s_mov_b32 s16, s82
  s_mov_b32 s17, s83
  s_mov_b32 s18, 0x510000
  s_mov_b32 s19, 0x20000
  v_lshrrev_b32 v100, 2, v254
  v_mul_u32_u24 v103, 9216, v100
  v_add_u32 v103, s6, v103
  v_and_b32 v100, 3, v254
  v_lshrrev_b32 v101, 5, v254
  v_lshlrev_b32 v101, 1, v101
  v_xor_b32 v100, v100, v101
  v_lshl_add_u32 v220, v100, 4, v103
  v_add_u32 v221, 146432, v220
  v_add_u32 v222, 292864, v220
  v_add_u32 v223, 439296, v220
  v_lshrrev_b32 v100, 3, v254
  v_mul_u32_u24 v101, 1152, v100
  v_add_u32 v101, s7, v101
  v_and_b32 v100, 6, v100
  v_and_b32 v102, 7, v254
  v_xor_b32 v100, v100, v102
  v_lshl_add_u32 v224, v100, 4, v101
  v_lshrrev_b32 v102, 4, v254
  v_bfe_u32 v100, v254, 2, 2
  v_and_b32 v103, 3, v254
  v_lshlrev_b32 v103, 3, v103
  v_lshl_add_u32 v101, v102, 3, v100
  v_lshl_add_u32 v208, v101, 7, v103
  v_lshl_add_u32 v209, v101, 6, v103
  v_lshl_add_u32 v101, v102, 2, v100
  v_lshl_add_u32 v210, v101, 7, v103
  v_bfe_u32 v101, v101, 1, 2
  v_lshl_add_u32 v210, v101, 5, v210
  v_and_b32 v102, 1, v102
  v_lshl_add_u32 v209, v102, 5, v209
  v_lshrrev_b32 v100, 1, v100
  v_lshl_add_u32 v100, v102, 1, v100
  v_lshl_add_u32 v208, v100, 5, v208
  v_add_u32 v226, 0, v208
  v_xor_b32 v227, 32, v226
  v_xor_b32 v228, 64, v226
  v_xor_b32 v229, 96, v226
  v_add_u32 v230, 49152, v208
  v_xor_b32 v231, 32, v230
  v_xor_b32 v232, 64, v230
  v_xor_b32 v233, 96, v230
  v_add_u32 v234, 98304, v208
  v_xor_b32 v235, 32, v234
  v_xor_b32 v236, 64, v234
  v_xor_b32 v237, 96, v234
  v_add_u32 v204, 0, v209
  v_xor_b32 v205, 32, v204
  v_add_u32 v206, 49152, v209
  v_xor_b32 v207, 32, v206
  v_lshrrev_b32 v100, 4, v254
  v_bfe_u32 v101, v254, 2, 2
  v_lshl_add_u32 v101, v100, 2, v101
  v_and_b32 v102, 3, v254
  v_lshlrev_b32 v103, 3, v102
  v_lshl_add_u32 v208, v101, 6, v103
  v_and_b32 v100, 1, v100
  v_lshl_add_u32 v208, v100, 5, v208
  v_lshlrev_b32 v100, 1, v100
  v_xor_b32 v102, v102, v100
  v_lshrrev_b32 v101, 2, v254
  s_lshl_b32 s4, s95, 4
  v_add_u32 v101, s4, v101
  v_mul_u32_u24 v101, 1152, v101
  v_lshl_add_u32 v209, v102, 4, v101
  s_mov_b32 s4, s49
  s_and_b32 s4, s4, 15
  s_mul_i32 s4, s4, 84
  s_and_b32 s5, s95, 1
  s_mul_i32 s5, s5, 42
  s_add_u32 s4, s4, s5
  v_min_u32 v215, 41, v254
  v_add_u32 v215, s4, v215
  v_mul_u32_u24 v215, 9216, v215
  s_lshl_b32 s3, s49, 4
  s_add_u32 s3, s3, s50
  s_lshl_b32 s3, s3, 3
  v_and_b32 v100, 7, v254
  v_add_u32 v100, s3, v100
  v_bfe_u32 v101, v254, 3, 1
  v_lshlrev_b32 v101, 2, v101
  v_bfe_u32 v102, v254, 5, 1
  v_lshl_add_u32 v101, v102, 1, v101
  v_bfe_u32 v102, v254, 4, 1
  v_add_u32 v101, v101, v102
  s_lshr_b32 s3, s95, 1
  s_mul_i32 s3, s3, 3
  s_add_u32 s3, s3, s95
  s_lshl_b32 s3, s3, 3
  v_add_u32 v101, s3, v101
  v_lshlrev_b32 v200, 15, v101
  v_lshl_add_u32 v200, v100, 3, v200
  v_lshlrev_b32 v201, 5, v101
  v_add_u32 v201, 148480, v201
  v_lshrrev_b32 v202, 4, v100
  v_mul_u32_u24 v202, 18432, v202
  v_lshl_add_u32 v202, v101, 8, v202
  v_and_b32 v102, 15, v100
  v_lshl_add_u32 v202, v102, 4, v202
  s_lshl_b32 s3, s49, 2
  s_add_u32 s3, s3, s95
  s_mul_i32 s3, s3, 36
  v_min_u32 v203, 35, v254
  v_add_u32 v203, s3, v203
  v_lshlrev_b32 v203, 7, v203
  s_waitcnt vmcnt(2)
  v_mov_b32 v150, 0
  v_mov_b32 v151, 0
  v_bfe_u32 v152, v254, 5, 1
  v_and_b32 v153, 7, v254
  v_lshl_add_u32 v152, v152, 3, v153
  v_lshlrev_b32 v152, 4, v152
  s_lshl_b32 s3, s95, 2
  v_add_u32 v152, 147456, v152
  v_add_u32 v153, s3, v152
  v_dot2_f32_bf16 v150, v240, s97, v150
  v_dot2_f32_bf16 v151, v240, v240, v151
  v_dot2_f32_bf16 v150, v241, s97, v150
  v_dot2_f32_bf16 v151, v241, v241, v151
  v_dot2_f32_bf16 v150, v242, s97, v150
  v_dot2_f32_bf16 v151, v242, v242, v151
  v_dot2_f32_bf16 v150, v243, s97, v150
  v_dot2_f32_bf16 v151, v243, v243, v151
  v_dot2_f32_bf16 v150, v244, s97, v150
  v_dot2_f32_bf16 v151, v244, v244, v151
  v_dot2_f32_bf16 v150, v245, s97, v150
  v_dot2_f32_bf16 v151, v245, v245, v151
  v_dot2_f32_bf16 v150, v246, s97, v150
  v_dot2_f32_bf16 v151, v246, v246, v151
  v_dot2_f32_bf16 v150, v247, s97, v150
  v_dot2_f32_bf16 v151, v247, v247, v151
  v_dot2_f32_bf16 v150, v248, s97, v150
  v_dot2_f32_bf16 v151, v248, v248, v151
  v_dot2_f32_bf16 v150, v249, s97, v150
  v_dot2_f32_bf16 v151, v249, v249, v151
  v_dot2_f32_bf16 v150, v250, s97, v150
  v_dot2_f32_bf16 v151, v250, v250, v151
  v_dot2_f32_bf16 v150, v251, s97, v150
  v_dot2_f32_bf16 v151, v251, v251, v151
  s_nop 2
  v_permlane32_swap_b32 v150, v151
  s_nop 1
  v_add_f32 v150, v150, v151
  v_mov_b32 v151, v150
  s_nop 1
  v_permlane16_swap_b32 v150, v151
  s_nop 1
  v_add_f32 v150, v150, v151
  s_nop 1
  v_add_f32_dpp v150, v150, v150 row_ror:8 row_mask:0xf bank_mask:0xf
  ds_write_b32 v153, v150
  s_waitcnt lgkmcnt(0)
  s_barrier
  ds_read_b128 v[154:157], v152
  s_waitcnt lgkmcnt(0)
  v_add_f32 v154, v154, v155
  v_add_f32 v156, v156, v157
  v_add_f32 v150, v154, v156
  v_mul_f32 v150, 0x3ae38e39, v150
  v_mov_b32 v151, v150
  s_nop 1
  v_permlane32_swap_b32 v150, v151
  s_nop 1
  v_fma_f32 v151, -v150, v150, v151
  v_max_f32 v151, 0, v151
  v_add_f32 v151, 0x3727c5ac, v151
  v_rsq_f32 v252, v151
  s_nop 0
  v_mul_f32 v253, v150, v252
  v_sub_f32 v253, 0, v253
  v_min_u32 v147, 53, v254
  v_lshlrev_b32 v147, 7, v147
  s_mov_b32 s11, 51200
  s_mov_b32 s96, 0
L_poll10:
  buffer_load_dword v239, v147, s[60:63], s11 offen sc1
  s_add_u32 s96, s96, 1
  s_waitcnt vmcnt(0)
  v_cmp_ne_u32 vcc, s94, v239
  s_cbranch_vccz L_pd11
  s_sleep 2
  s_cmp_lt_u32 s96, 200000
  s_cbranch_scc1 L_poll10
L_pd11:
  s_add_u32 s52, s92, 0x900000
  s_addc_u32 s53, s93, 0
  s_mov_b32 s54, 0x3600
  s_mov_b32 s55, 0x20000
  s_mul_i32 s91, s95, 3584
  s_add_u32 m0, s91, 148480
  s_nop 0
  buffer_load_dwordx4 v225, s[52:55], s91 offen offset:0 sc1 lds
  buffer_load_dwordx4 v225, s[52:55], s91 offen offset:1024 sc1 lds
  buffer_load_dwordx4 v225, s[52:55], s91 offen offset:2048 sc1 lds
  buffer_load_dwordx4 v225, s[52:55], s91 offen offset:3072 sc1 lds
  s_mov_b32 s5, s49
  s_and_b32 s5, s5, 15
  s_lshl_b32 s4, s5, 2
  s_add_u32 s4, s4, s95
  s_mul_i32 s4, s4, 94
  s_cmp_ge_u32 s5, 7
  s_cselect_b32 s4, 0x800000, s4
  v_min_u32 v238, 46, v254
  v_add_u32 v238, s4, v238
  v_lshlrev_b32 v238, 7, v238
  s_mul_i32 s40, s50, 331776
  s_and_b32 s9, s50, 1
  s_lshr_b32 s10, s50, 1
  s_mul_i32 s11, s10, 663552
  s_mul_i32 s3, s9, 640
  s_add_u32 s3, s3, s11
  s_mul_i32 s4, s9, 368640
  s_add_u32 s33, s3, s4
  s_sub_u32 s4, 368640, s4
  s_add_u32 s42, s3, s4
  s_mul_i32 s4, s9, 36864
  s_add_u32 s3, s3, 294912
  s_add_u32 s34, s3, s4
  s_sub_u32 s4, 36864, s4
  s_add_u32 s43, s3, s4
  s_mul_i32 s3, s9, 576
  s_sub_u32 s3, 512, s3
  s_add_u32 s44, s33, s3
  s_add_u32 s45, s42, s3
  s_sub_u32 s4, s43, 36864
  s_cmp_ge_u32 s95, 2
  s_cselect_b32 s4, s4, s34
  s_add_u32 s46, s4, s3
  s_lshl_b32 s10, s10, 6
  s_lshl_b32 s3, s49, 2
  s_add_u32 s10, s10, s3
  s_add_u32 s10, s10, s95
  s_mul_i32 s10, s10, 36864
  s_mul_i32 s3, s9, 20480
  s_add_u32 s36, s10, s3
  s_lshl_b32 s3, s9, 11
  s_add_u32 s3, s3, 16384
  s_add_u32 s47, s10, s3
  s_lshl_b32 s3, s2, 2
  s_add_u32 s3, s3, s95
  s_xor_b32 s9, s3, 32
  s_mul_i32 s76, s3, 18432
  s_mul_i32 s77, s9, 18432
  s_lshl_b32 s3, s3, 8
  s_add_u32 s100, s3, 131072
  s_lshl_b32 s9, s9, 8
  s_add_u32 s101, s9, 131072
  s_add_u32 s20, s92, 0x480000
  s_addc_u32 s21, s93, 0
  s_mov_b32 s22, 0x240000
  s_mov_b32 s23, 0x20000
  s_add_u32 s24, s92, 0x1000000
  s_addc_u32 s25, s93, 0
  s_mov_b32 s26, 0x2400000
  s_mov_b32 s27, 0x20000
L_common:
  s_add_u32 m0, s29, 0
  s_add_u32 s35, s31, 0
  buffer_load_dwordx4 v216, s[12:15], s35 offen lds
  buffer_load_dwordx4 v217, s[12:15], s35 offen offset:1024 lds
  buffer_load_dwordx4 v218, s[12:15], s35 offen offset:2048 lds
  buffer_load_dwordx4 v219, s[12:15], s35 offen offset:3072 lds
  s_add_u32 m0, s29, 4096
  s_add_u32 s35, s31, 294912
  buffer_load_dwordx4 v216, s[12:15], s35 offen lds
  buffer_load_dwordx4 v217, s[12:15], s35 offen offset:1024 lds
  s_add_u32 m0, s29, 24576
  s_add_u32 s35, s31, 884736
  buffer_load_dwordx4 v216, s[12:15], s35 offen lds
  buffer_load_dwordx4 v217, s[12:15], s35 offen offset:1024 lds
  buffer_load_dwordx4 v218, s[12:15], s35 offen offset:2048 lds
  buffer_load_dwordx4 v219, s[12:15], s35 offen offset:3072 lds
  s_add_u32 m0, s29, 28672
  s_add_u32 s35, s31, 1179648
  buffer_load_dwordx4 v216, s[12:15], s35 offen lds
  buffer_load_dwordx4 v217, s[12:15], s35 offen offset:1024 lds
  s_add_u32 m0, s29, 49152
  s_add_u32 s35, s31, 1769472
  buffer_load_dwordx4 v216, s[12:15], s35 offen lds
  buffer_load_dwordx4 v217, s[12:15], s35 offen offset:1024 lds
  buffer_load_dwordx4 v218, s[12:15], s35 offen offset:2048 lds
  buffer_load_dwordx4 v219, s[12:15], s35 offen offset:3072 lds
  s_add_u32 m0, s29, 53248
  s_add_u32 s35, s31, 2064384
  buffer_load_dwordx4 v216, s[12:15], s35 offen lds
  buffer_load_dwordx4 v217, s[12:15], s35 offen offset:1024 lds
  s_add_u32 s56, s92, 0x2400000
  s_addc_u32 s57, s93, 0
  s_mov_b32 s58, 0x1200000
  s_mov_b32 s59, 0x20000
  s_add_u32 s52, s92, 0x240000
  s_addc_u32 s53, s93, 0
  s_mov_b32 s54, 0x240000
  s_mov_b32 s55, 0x20000
  s_mov_b32 s4, 655360
  s_mov_b32 s5, 0x4000
  s_mov_b32 s6, 0x80000
  s_mov_b32 s7, 0x84000
  s_add_u32 s8, s51, 0x100000
  s_add_u32 s11, s51, 0x104000
  s_mov_b32 s9, 4096
  s_add_u32 s10, s51, 8192
  s_mov_b32 s96, 0
L_poll12:
  buffer_load_dword v239, v203, s[60:63], s4 offen sc1
  s_add_u32 s96, s96, 1
  s_waitcnt vmcnt(0)
  v_cmp_ne_u32 vcc, s94, v239
  s_cbranch_vccz L_pd13
  s_sleep 1
  s_cmp_lt_u32 s96, 200000
  s_cbranch_scc1 L_poll12
L_pd13:
  s_barrier
  buffer_load_dwordx2 v[0:1], v200, s[52:55], 0 offen sc1
  buffer_load_dwordx2 v[2:3], v200, s[52:55], s5 offen sc1
  buffer_load_dwordx2 v[4:5], v200, s[52:55], s6 offen sc1
  buffer_load_dwordx2 v[6:7], v200, s[52:55], s7 offen sc1
  buffer_load_dwordx2 v[8:9], v200, s[52:55], s8 offen sc1
  buffer_load_dwordx2 v[10:11], v200, s[52:55], s11 offen sc1
  ds_read_b128 v[16:19], v201 offset:0
  ds_read_b128 v[20:23], v201 offset:16
  ds_read_b128 v[24:27], v201 offset:2304
  ds_read_b128 v[28:31], v201 offset:2320
  ds_read_b128 v[32:35], v201 offset:4608
  ds_read_b128 v[36:39], v201 offset:4624
  ds_read_b128 v[56:59], v201 offset:512
  ds_read_b128 v[60:63], v201 offset:528
  ds_read_b128 v[64:67], v201 offset:2816
  ds_read_b128 v[68:71], v201 offset:2832
  ds_read_b128 v[72:75], v201 offset:5120
  ds_read_b128 v[76:79], v201 offset:5136
  ds_read_b128 v[96:99], v201 offset:1024
  ds_read_b128 v[100:103], v201 offset:1040
  ds_read_b128 v[104:107], v201 offset:3328
  ds_read_b128 v[108:111], v201 offset:3344
  ds_read_b128 v[112:115], v201 offset:5632
  ds_read_b128 v[116:119], v201 offset:5648
  ds_read_b128 v[40:43], v201 offset:6912
  ds_read_b128 v[44:47], v201 offset:6928
  ds_read_b128 v[48:51], v201 offset:9216
  ds_read_b128 v[52:55], v201 offset:9232
  ds_read_b128 v[80:83], v201 offset:7424
  ds_read_b128 v[84:87], v201 offset:7440
  ds_read_b128 v[88:91], v201 offset:9728
  ds_read_b128 v[92:95], v201 offset:9744
  ds_read_b128 v[120:123], v201 offset:7936
  ds_read_b128 v[124:127], v201 offset:7952
  ds_read_b128 v[128:131], v201 offset:10240
  ds_read_b128 v[132:135], v201 offset:10256
  s_waitcnt lgkmcnt(12)
  s_waitcnt vmcnt(4)
  v_lshlrev_b32 v144, 16, v240
  v_and_b32 v145, 0xffff0000, v240
  v_lshlrev_b32 v150, 16, v241
  v_and_b32 v151, 0xffff0000, v241
  v_pk_fma_f32 v[146:147], v[144:145], v[252:253], v[252:253] op_sel:[0,0,1] op_sel_hi:[1,0,1]
  v_pk_fma_f32 v[152:153], v[150:151], v[252:253], v[252:253] op_sel:[0,0,1] op_sel_hi:[1,0,1]
  v_lshlrev_b32 v148, 16, v0
  v_and_b32 v149, 0xffff0000, v0
  v_lshlrev_b32 v154, 16, v1
  v_and_b32 v155, 0xffff0000, v1
  v_pk_fma_f32 v[146:147], v[146:147], v[24:25], v[16:17]
  v_pk_fma_f32 v[152:153], v[152:153], v[26:27], v[18:19]
  v_pk_mul_f32 v[146:147], v[146:147], v[148:149]
  v_pk_mul_f32 v[152:153], v[152:153], v[154:155]
  v_pk_fma_f32 v[146:147], v[146:147], v[32:33], v[144:145]
  v_pk_fma_f32 v[152:153], v[152:153], v[34:35], v[150:151]
  v_cvt_pk_bf16_f32 v240, v146, v147
  v_cvt_pk_bf16_f32 v241, v152, v153
  v_lshlrev_b32 v144, 16, v242
  v_and_b32 v145, 0xffff0000, v242
  v_lshlrev_b32 v150, 16, v243
  v_and_b32 v151, 0xffff0000, v243
  v_pk_fma_f32 v[146:147], v[144:145], v[252:253], v[252:253] op_sel:[0,0,1] op_sel_hi:[1,0,1]
  v_pk_fma_f32 v[152:153], v[150:151], v[252:253], v[252:253] op_sel:[0,0,1] op_sel_hi:[1,0,1]
  v_lshlrev_b32 v148, 16, v2
  v_and_b32 v149, 0xffff0000, v2
  v_lshlrev_b32 v154, 16, v3
  v_and_b32 v155, 0xffff0000, v3
  v_pk_fma_f32 v[146:147], v[146:147], v[28:29], v[20:21]
  v_pk_fma_f32 v[152:153], v[152:153], v[30:31], v[22:23]
  v_pk_mul_f32 v[146:147], v[146:147], v[148:149]
  v_pk_mul_f32 v[152:153], v[152:153], v[154:155]
  v_pk_fma_f32 v[146:147], v[146:147], v[36:37], v[144:145]
  v_pk_fma_f32 v[152:153], v[152:153], v[38:39], v[150:151]
  v_cvt_pk_bf16_f32 v242, v146, v147
  v_cvt_pk_bf16_f32 v243, v152, v153
  s_waitcnt vmcnt(2)
  v_lshlrev_b32 v144, 16, v244
  v_and_b32 v145, 0xffff0000, v244
  v_lshlrev_b32 v150, 16, v245
  v_and_b32 v151, 0xffff0000, v245
  v_pk_fma_f32 v[146:147], v[144:145], v[252:253], v[252:253] op_sel:[0,0,1] op_sel_hi:[1,0,1]
  v_pk_fma_f32 v[152:153], v[150:151], v[252:253], v[252:253] op_sel:[0,0,1] op_sel_hi:[1,0,1]
  v_lshlrev_b32 v148, 16, v4
  v_and_b32 v149, 0xffff0000, v4
  v_lshlrev_b32 v154, 16, v5
  v_and_b32 v155, 0xffff0000, v5
  v_pk_fma_f32 v[146:147], v[146:147], v[64:65], v[56:57]
  v_pk_fma_f32 v[152:153], v[152:153], v[66:67], v[58:59]
  v_pk_mul_f32 v[146:147], v[146:147], v[148:149]
  v_pk_mul_f32 v[152:153], v[152:153], v[154:155]
  v_pk_fma_f32 v[146:147], v[146:147], v[72:73], v[144:145]
  v_pk_fma_f32 v[152:153], v[152:153], v[74:75], v[150:151]
  v_cvt_pk_bf16_f32 v244, v146, v147
  v_cvt_pk_bf16_f32 v245, v152, v153
  v_lshlrev_b32 v144, 16, v246
  v_and_b32 v145, 0xffff0000, v246
  v_lshlrev_b32 v150, 16, v247
  v_and_b32 v151, 0xffff0000, v247
  v_pk_fma_f32 v[146:147], v[144:145], v[252:253], v[252:253] op_sel:[0,0,1] op_sel_hi:[1,0,1]
  v_pk_fma_f32 v[152:153], v[150:151], v[252:253], v[252:253] op_sel:[0,0,1] op_sel_hi:[1,0,1]
  v_lshlrev_b32 v148, 16, v6
  v_and_b32 v149, 0xffff0000, v6
  v_lshlrev_b32 v154, 16, v7
  v_and_b32 v155, 0xffff0000, v7
  v_pk_fma_f32 v[146:147], v[146:147], v[68:69], v[60:61]
  v_pk_fma_f32 v[152:153], v[152:153], v[70:71], v[62:63]
  v_pk_mul_f32 v[146:147], v[146:147], v[148:149]
  v_pk_mul_f32 v[152:153], v[152:153], v[154:155]
  v_pk_fma_f32 v[146:147], v[146:147], v[76:77], v[144:145]
  v_pk_fma_f32 v[152:153], v[152:153], v[78:79], v[150:151]
  v_cvt_pk_bf16_f32 v246, v146, v147
  v_cvt_pk_bf16_f32 v247, v152, v153
  s_waitcnt vmcnt(0)
  v_lshlrev_b32 v144, 16, v248
  v_and_b32 v145, 0xffff0000, v248
  v_lshlrev_b32 v150, 16, v249
  v_and_b32 v151, 0xffff0000, v249
  v_pk_fma_f32 v[146:147], v[144:145], v[252:253], v[252:253] op_sel:[0,0,1] op_sel_hi:[1,0,1]
  v_pk_fma_f32 v[152:153], v[150:151], v[252:253], v[252:253] op_sel:[0,0,1] op_sel_hi:[1,0,1]
  v_lshlrev_b32 v148, 16, v8
  v_and_b32 v149, 0xffff0000, v8
  v_lshlrev_b32 v154, 16, v9
  v_and_b32 v155, 0xffff0000, v9
  v_pk_fma_f32 v[146:147], v[146:147], v[104:105], v[96:97]
  v_pk_fma_f32 v[152:153], v[152:153], v[106:107], v[98:99]
  v_pk_mul_f32 v[146:147], v[146:147], v[148:149]
  v_pk_mul_f32 v[152:153], v[152:153], v[154:155]
  v_pk_fma_f32 v[146:147], v[146:147], v[112:113], v[144:145]
  v_pk_fma_f32 v[152:153], v[152:153], v[114:115], v[150:151]
  v_cvt_pk_bf16_f32 v248, v146, v147
  v_cvt_pk_bf16_f32 v249, v152, v153
  v_lshlrev_b32 v144, 16, v250
  v_and_b32 v145, 0xffff0000, v250
  v_lshlrev_b32 v150, 16, v251
  v_and_b32 v151, 0xffff0000, v251
  v_pk_fma_f32 v[146:147], v[144:145], v[252:253], v[252:253] op_sel:[0,0,1] op_sel_hi:[1,0,1]
  v_pk_fma_f32 v[152:153], v[150:151], v[252:253], v[252:253] op_sel:[0,0,1] op_sel_hi:[1,0,1]
  v_lshlrev_b32 v148, 16, v10
  v_and_b32 v149, 0xffff0000, v10
  v_lshlrev_b32 v154, 16, v11
  v_and_b32 v155, 0xffff0000, v11
  v_pk_fma_f32 v[146:147], v[146:147], v[108:109], v[100:101]
  v_pk_fma_f32 v[152:153], v[152:153], v[110:111], v[102:103]
  v_pk_mul_f32 v[146:147], v[146:147], v[148:149]
  v_pk_mul_f32 v[152:153], v[152:153], v[154:155]
  v_pk_fma_f32 v[146:147], v[146:147], v[116:117], v[144:145]
  v_pk_fma_f32 v[152:153], v[152:153], v[118:119], v[150:151]
  v_cvt_pk_bf16_f32 v250, v146, v147
  v_cvt_pk_bf16_f32 v251, v152, v153
  v_mov_b32 v160, 0
  v_mov_b32 v161, 0
  v_bfe_u32 v162, v254, 5, 1
  v_and_b32 v163, 7, v254
  v_lshl_add_u32 v162, v162, 3, v163
  v_lshlrev_b32 v162, 4, v162
  s_lshl_b32 s3, s95, 2
  v_add_u32 v162, 147712, v162
  v_add_u32 v163, s3, v162
  v_dot2_f32_bf16 v160, v240, s97, v160
  v_dot2_f32_bf16 v161, v240, v240, v161
  v_dot2_f32_bf16 v160, v241, s97, v160
  v_dot2_f32_bf16 v161, v241, v241, v161
  v_dot2_f32_bf16 v160, v242, s97, v160
  v_dot2_f32_bf16 v161, v242, v242, v161
  v_dot2_f32_bf16 v160, v243, s97, v160
  v_dot2_f32_bf16 v161, v243, v243, v161
  v_dot2_f32_bf16 v160, v244, s97, v160
  v_dot2_f32_bf16 v161, v244, v244, v161
  v_dot2_f32_bf16 v160, v245, s97, v160
  v_dot2_f32_bf16 v161, v245, v245, v161
  v_dot2_f32_bf16 v160, v246, s97, v160
  v_dot2_f32_bf16 v161, v246, v246, v161
  v_dot2_f32_bf16 v160, v247, s97, v160
  v_dot2_f32_bf16 v161, v247, v247, v161
  v_dot2_f32_bf16 v160, v248, s97, v160
  v_dot2_f32_bf16 v161, v248, v248, v161
  v_dot2_f32_bf16 v160, v249, s97, v160
  v_dot2_f32_bf16 v161, v249, v249, v161
  v_dot2_f32_bf16 v160, v250, s97, v160
  v_dot2_f32_bf16 v161, v250, v250, v161
  v_dot2_f32_bf16 v160, v251, s97, v160
  v_dot2_f32_bf16 v161, v251, v251, v161
  s_nop 2
  v_permlane32_swap_b32 v160, v161
  s_nop 1
  v_add_f32 v160, v160, v161
  v_mov_b32 v161, v160
  s_nop 1
  v_permlane16_swap_b32 v160, v161
  s_nop 1
  v_add_f32 v160, v160, v161
  s_nop 1
  v_add_f32_dpp v160, v160, v160 row_ror:8 row_mask:0xf bank_mask:0xf
  ds_write_b32 v163, v160
  s_waitcnt lgkmcnt(0)
  s_barrier
  ds_read_b128 v[164:167], v162
  s_waitcnt lgkmcnt(0)
  v_add_f32 v164, v164, v165
  v_add_f32 v166, v166, v167
  v_add_f32 v160, v164, v166
  v_mul_f32 v160, 0x3ae38e39, v160
  v_mov_b32 v161, v160
  s_nop 1
  v_permlane32_swap_b32 v160, v161
  s_nop 1
  v_fma_f32 v161, -v160, v160, v161
  v_max_f32 v161, 0, v161
  v_add_f32 v161, 0x3727c5ac, v161
  v_rsq_f32 v252, v161
  s_nop 0
  v_mul_f32 v252, 0x3eeff558, v252
  v_mul_f32 v253, v160, v252
  v_sub_f32 v253, 0, v253
  v_lshlrev_b32 v144, 16, v240
  v_and_b32 v145, 0xffff0000, v240
  v_lshlrev_b32 v150, 16, v241
  v_and_b32 v151, 0xffff0000, v241
  v_pk_fma_f32 v[144:145], v[144:145], v[252:253], v[252:253] op_sel:[0,0,1] op_sel_hi:[1,0,1]
  v_pk_fma_f32 v[150:151], v[150:151], v[252:253], v[252:253] op_sel:[0,0,1] op_sel_hi:[1,0,1]
  v_pk_fma_f32 v[144:145], v[144:145], v[48:49], v[40:41]
  v_pk_fma_f32 v[150:151], v[150:151], v[50:51], v[42:43]
  v_cvt_pk_bf16_f32 v0, v144, v145
  v_cvt_pk_bf16_f32 v1, v150, v151
  v_lshlrev_b32 v144, 16, v242
  v_and_b32 v145, 0xffff0000, v242
  v_lshlrev_b32 v150, 16, v243
  v_and_b32 v151, 0xffff0000, v243
  v_pk_fma_f32 v[144:145], v[144:145], v[252:253], v[252:253] op_sel:[0,0,1] op_sel_hi:[1,0,1]
  v_pk_fma_f32 v[150:151], v[150:151], v[252:253], v[252:253] op_sel:[0,0,1] op_sel_hi:[1,0,1]
  v_pk_fma_f32 v[144:145], v[144:145], v[52:53], v[44:45]
  v_pk_fma_f32 v[150:151], v[150:151], v[54:55], v[46:47]
  v_cvt_pk_bf16_f32 v2, v144, v145
  v_cvt_pk_bf16_f32 v3, v150, v151
  buffer_store_dwordx4 v[0:3], v202, s[20:23], 0 offen sc1
  v_lshlrev_b32 v144, 16, v244
  v_and_b32 v145, 0xffff0000, v244
  v_lshlrev_b32 v150, 16, v245
  v_and_b32 v151, 0xffff0000, v245
  v_pk_fma_f32 v[144:145], v[144:145], v[252:253], v[252:253] op_sel:[0,0,1] op_sel_hi:[1,0,1]
  v_pk_fma_f32 v[150:151], v[150:151], v[252:253], v[252:253] op_sel:[0,0,1] op_sel_hi:[1,0,1]
  v_pk_fma_f32 v[144:145], v[144:145], v[88:89], v[80:81]
  v_pk_fma_f32 v[150:151], v[150:151], v[90:91], v[82:83]
  v_cvt_pk_bf16_f32 v4, v144, v145
  v_cvt_pk_bf16_f32 v5, v150, v151
  v_lshlrev_b32 v144, 16, v246
  v_and_b32 v145, 0xffff0000, v246
  v_lshlrev_b32 v150, 16, v247
  v_and_b32 v151, 0xffff0000, v247
  v_pk_fma_f32 v[144:145], v[144:145], v[252:253], v[252:253] op_sel:[0,0,1] op_sel_hi:[1,0,1]
  v_pk_fma_f32 v[150:151], v[150:151], v[252:253], v[252:253] op_sel:[0,0,1] op_sel_hi:[1,0,1]
  v_pk_fma_f32 v[144:145], v[144:145], v[92:93], v[84:85]
  v_pk_fma_f32 v[150:151], v[150:151], v[94:95], v[86:87]
  v_cvt_pk_bf16_f32 v6, v144, v145
  v_cvt_pk_bf16_f32 v7, v150, v151
  buffer_store_dwordx4 v[4:7], v202, s[20:23], s9 offen sc1
  v_lshlrev_b32 v144, 16, v248
  v_and_b32 v145, 0xffff0000, v248
  v_lshlrev_b32 v150, 16, v249
  v_and_b32 v151, 0xffff0000, v249
  v_pk_fma_f32 v[144:145], v[144:145], v[252:253], v[252:253] op_sel:[0,0,1] op_sel_hi:[1,0,1]
  v_pk_fma_f32 v[150:151], v[150:151], v[252:253], v[252:253] op_sel:[0,0,1] op_sel_hi:[1,0,1]
  v_pk_fma_f32 v[144:145], v[144:145], v[128:129], v[120:121]
  v_pk_fma_f32 v[150:151], v[150:151], v[130:131], v[122:123]
  v_cvt_pk_bf16_f32 v8, v144, v145
  v_cvt_pk_bf16_f32 v9, v150, v151
  v_lshlrev_b32 v144, 16, v250
  v_and_b32 v145, 0xffff0000, v250
  v_lshlrev_b32 v150, 16, v251
  v_and_b32 v151, 0xffff0000, v251
  v_pk_fma_f32 v[144:145], v[144:145], v[252:253], v[252:253] op_sel:[0,0,1] op_sel_hi:[1,0,1]
  v_pk_fma_f32 v[150:151], v[150:151], v[252:253], v[252:253] op_sel:[0,0,1] op_sel_hi:[1,0,1]
  v_pk_fma_f32 v[144:145], v[144:145], v[132:133], v[124:125]
  v_pk_fma_f32 v[150:151], v[150:151], v[134:135], v[126:127]
  v_cvt_pk_bf16_f32 v10, v144, v145
  v_cvt_pk_bf16_f32 v11, v150, v151
  buffer_store_dwordx4 v[8:11], v202, s[20:23], s10 offen sc1
  v_accvgpr_write_b32 a208, v240
  v_accvgpr_write_b32 a209, v241
  v_accvgpr_write_b32 a210, v242
  v_accvgpr_write_b32 a211, v243
  v_accvgpr_write_b32 a212, v244
  v_accvgpr_write_b32 a213, v245
  v_accvgpr_write_b32 a214, v246
  v_accvgpr_write_b32 a215, v247
  v_accvgpr_write_b32 a216, v248
  v_accvgpr_write_b32 a217, v249
  v_accvgpr_write_b32 a218, v250
  v_accvgpr_write_b32 a219, v251
  s_lshl_b32 s4, s49, 4
  s_add_u32 s4, s4, s50
  s_waitcnt vmcnt(0)
  s_barrier
  s_cmp_lg_u32 s95, 0
  s_cbranch_scc1 L_sig14
  s_lshl_b32 s3, s4, 7
  s_add_u32 s3, s3, 65536
  v_mov_b32 v239, s94
  s_mov_b64 exec, 1
  buffer_store_dword v239, off, s[60:63], s3 sc1
  s_mov_b64 exec, -1
L_sig14:
  s_add_u32 m0, s29, 73728
  s_add_u32 s35, s31, 2654208
  buffer_load_dwordx4 v216, s[12:15], s35 offen lds
  buffer_load_dwordx4 v217, s[12:15], s35 offen offset:1024 lds
  buffer_load_dwordx4 v218, s[12:15], s35 offen offset:2048 lds
  buffer_load_dwordx4 v219, s[12:15], s35 offen offset:3072 lds
  s_add_u32 m0, s29, 77824
  s_add_u32 s35, s31, 2949120
  buffer_load_dwordx4 v216, s[12:15], s35 offen lds
  buffer_load_dwordx4 v217, s[12:15], s35 offen offset:1024 lds
  s_add_u32 m0, s29, 98304
  s_add_u32 s35, s31, 3538944
  buffer_load_dwordx4 v216, s[12:15], s35 offen lds
  buffer_load_dwordx4 v217, s[12:15], s35 offen offset:1024 lds
  buffer_load_dwordx4 v218, s[12:15], s35 offen offset:2048 lds
  buffer_load_dwordx4 v219, s[12:15], s35 offen offset:3072 lds
  s_add_u32 m0, s29, 102400
  s_add_u32 s35, s31, 3833856
  buffer_load_dwordx4 v216, s[12:15], s35 offen lds
  buffer_load_dwordx4 v217, s[12:15], s35 offen offset:1024 lds
  s_add_u32 m0, s29, 122880
  s_add_u32 s35, s31, 4423680
  buffer_load_dwordx4 v216, s[12:15], s35 offen lds
  buffer_load_dwordx4 v217, s[12:15], s35 offen offset:1024 lds
  buffer_load_dwordx4 v218, s[12:15], s35 offen offset:2048 lds
  buffer_load_dwordx4 v219, s[12:15], s35 offen offset:3072 lds
  s_add_u32 m0, s29, 126976
  s_add_u32 s35, s31, 4718592
  buffer_load_dwordx4 v216, s[12:15], s35 offen lds
  buffer_load_dwordx4 v217, s[12:15], s35 offen offset:1024 lds
  s_getpc_b64 s[4:5]
L_pc_3:
  s_sub_u32 s52, s4, L_pc_3-L_common
  s_subb_u32 s53, s5, 0
  s_mov_b32 s54, L_code_end-L_common
  s_mov_b32 s55, 0x20000
  v_mov_b32 v252, s94
  s_bfe_u32 s4, s2, 0x10003
  s_lshl_b32 s5, s49, 1
  s_add_u32 s4, s4, s5
  s_lshl_b32 s4, s4, 2
  s_add_u32 s4, s4, s95
  s_lshl_b32 s4, s4, 2
  s_cmp_ge_u32 s49, 7
  s_cselect_b32 s4, 0x800000, s4
  v_and_b32 v214, 3, v254
  v_add_u32 v214, s4, v214
  v_lshlrev_b32 v214, 7, v214
  s_lshl_b32 s3, s49, 4
  s_add_u32 s3, s3, s50
  s_lshl_b32 s3, s3, 3
  v_and_b32 v100, 7, v254
  v_add_u32 v100, s3, v100
  v_bfe_u32 v101, v254, 3, 1
  v_lshlrev_b32 v101, 2, v101
  v_bfe_u32 v102, v254, 5, 1
  v_lshl_add_u32 v101, v102, 1, v101
  v_bfe_u32 v102, v254, 4, 1
  v_add_u32 v101, v101, v102
  s_lshr_b32 s3, s95, 1
  s_mul_i32 s3, s3, 3
  s_add_u32 s3, s3, s95
  s_lshl_b32 s3, s3, 3
  v_add_u32 v101, s3, v101
  v_mul_u32_u24 v249, 1152, v100
  v_lshl_add_u32 v249, v101, 4, v249
  v_lshrrev_b32 v248, 5, v100
  v_mul_u32_u24 v248, 9, v248
  v_lshrrev_b32 v102, 3, v101
  v_add_u32 v248, v102, v248
  v_lshlrev_b32 v248, 12, v248
  v_bfe_u32 v102, v100, 4, 1
  v_lshl_add_u32 v248, v102, 10, v248
  v_bfe_u32 v102, v254, 3, 1
  v_lshl_add_u32 v248, v102, 11, v248
  v_bfe_u32 v102, v254, 4, 1
  v_lshl_add_u32 v248, v102, 9, v248
  v_bfe_u32 v102, v254, 5, 1
  v_lshl_add_u32 v248, v102, 8, v248
  v_and_b32 v102, 15, v100
  v_lshl_add_u32 v248, v102, 4, v248
  v_lshlrev_b32 v250, 5, v101
  v_add_u32 v250, 160000, v250
  s_lshl_b32 s3, s49, 2
  s_lshr_b32 s4, s50, 2
  s_add_u32 s4, s4, s3
  s_lshl_b32 s4, s4, 11
  v_and_b32 v251, 15, v254
  v_lshl_add_u32 v251, v251, 7, s4
  s_add_u32 s3, s3, s95
  s_lshl_b32 s3, s3, 4
  s_add_u32 s3, s3, s50
  s_lshl_b32 s3, s3, 7
  s_add_u32 s90, s3, 393216
  v_and_b32 v146, 15, v254
  v_lshlrev_b32 v146, 7, v146
  s_lshl_b32 s9, s49, 11
  s_add_u32 s9, s9, 65536
  s_mov_b32 s96, 0
L_poll15:
  buffer_load_dword v239, v146, s[60:63], s9 offen sc1
  s_add_u32 s96, s96, 1
  s_waitcnt vmcnt(0)
  v_cmp_ne_u32 vcc, s94, v239
  s_cbranch_vccz L_pd16
  s_cmp_lt_u32 s96, 200000
  s_cbranch_scc1 L_poll15
L_pd16:
  s_add_u32 s39, s38, 0
  buffer_load_dwordx4 a[0:3], v225, s[20:23], s39 offen sc1
  buffer_load_dwordx4 a[8:11], v225, s[20:23], s39 offen offset:1024 sc1
  buffer_load_dwordx4 a[16:19], v225, s[20:23], s39 offen offset:2048 sc1
  s_add_u32 s39, s38, 18432
  buffer_load_dwordx4 a[4:7], v225, s[20:23], s39 offen sc1
  buffer_load_dwordx4 a[12:15], v225, s[20:23], s39 offen offset:1024 sc1
  buffer_load_dwordx4 a[20:23], v225, s[20:23], s39 offen offset:2048 sc1
  s_add_u32 s39, s38, 3072
  buffer_load_dwordx4 a[24:27], v225, s[20:23], s39 offen sc1
  buffer_load_dwordx4 a[32:35], v225, s[20:23], s39 offen offset:1024 sc1
  buffer_load_dwordx4 a[40:43], v225, s[20:23], s39 offen offset:2048 sc1
  s_add_u32 s39, s38, 21504
  buffer_load_dwordx4 a[28:31], v225, s[20:23], s39 offen sc1
  buffer_load_dwordx4 a[36:39], v225, s[20:23], s39 offen offset:1024 sc1
  buffer_load_dwordx4 a[44:47], v225, s[20:23], s39 offen offset:2048 sc1
  ds_read_b64_tr_b16 a[144:145], v226 offset:0
  ds_read_b64_tr_b16 a[146:147], v226 offset:512
  ds_read_b64_tr_b16 a[148:149], v226 offset:4096
  ds_read_b64_tr_b16 a[150:151], v226 offset:4608
  ds_read_b64_tr_b16 a[152:153], v226 offset:8192
  ds_read_b64_tr_b16 a[154:155], v226 offset:8704
  ds_read_b64_tr_b16 a[156:157], v226 offset:12288
  ds_read_b64_tr_b16 a[158:159], v226 offset:12800
  ds_read_b64_tr_b16 a[160:161], v226 offset:16384
  ds_read_b64_tr_b16 a[162:163], v226 offset:16896
  ds_read_b64_tr_b16 a[164:165], v226 offset:20480
  ds_read_b64_tr_b16 a[166:167], v226 offset:20992
  s_waitcnt vmcnt(6)
  s_cmp_eq_u32 0, 1
  s_waitcnt lgkmcnt(10)
  v_mfma_f32_16x16x32_bf16 v[0:3], a[144:147], a[0:3], 0
  s_waitcnt lgkmcnt(8)
  ds_read_b64_tr_b16 a[168:169], v227 offset:0
  v_mfma_f32_16x16x32_bf16 v[0:3], a[148:151], a[8:11], v[0:3]
  s_waitcnt lgkmcnt(7)
  ds_read_b64_tr_b16 a[170:171], v227 offset:512
  v_mfma_f32_16x16x32_bf16 v[0:3], a[152:155], a[16:19], v[0:3]
  s_add_u32 s39, s38, 6144
  ds_read_b64_tr_b16 a[172:173], v227 offset:4096
  ds_read_b64_tr_b16 a[174:175], v227 offset:4608
  v_mfma_f32_16x16x32_bf16 v[4:7], a[144:147], a[4:7], 0
  ds_read_b64_tr_b16 a[176:177], v227 offset:8192
  v_mfma_f32_16x16x32_bf16 v[4:7], a[148:151], a[12:15], v[4:7]
  buffer_load_dwordx4 a[48:51], v225, s[20:23], s39 offen sc1
  v_mfma_f32_16x16x32_bf16 v[4:7], a[152:155], a[20:23], v[4:7]
  s_waitcnt lgkmcnt(9)
  ds_read_b64_tr_b16 a[178:179], v227 offset:8704
  ds_read_b64_tr_b16 a[180:181], v227 offset:12288
  v_mfma_f32_16x16x32_bf16 v[8:11], a[156:159], a[0:3], 0
  s_waitcnt lgkmcnt(9)
  ds_read_b64_tr_b16 a[182:183], v227 offset:12800
  ds_read_b64_tr_b16 a[184:185], v227 offset:16384
  v_mfma_f32_16x16x32_bf16 v[8:11], a[160:163], a[8:11], v[8:11]
  s_waitcnt lgkmcnt(9)
  ds_read_b64_tr_b16 a[186:187], v227 offset:16896
  v_mfma_f32_16x16x32_bf16 v[8:11], a[164:167], a[16:19], v[8:11]
  ds_read_b64_tr_b16 a[188:189], v227 offset:20480
  ds_read_b64_tr_b16 a[190:191], v227 offset:20992
  v_mfma_f32_16x16x32_bf16 v[12:15], a[156:159], a[4:7], 0
  buffer_load_dwordx4 a[56:59], v225, s[20:23], s39 offen offset:1024 sc1
  v_mfma_f32_16x16x32_bf16 v[12:15], a[160:163], a[12:15], v[12:15]
  ds_read_b64_tr_b16 a[192:193], v228 offset:0
  ds_read_b64_tr_b16 a[194:195], v228 offset:512
  v_mfma_f32_16x16x32_bf16 v[12:15], a[164:167], a[20:23], v[12:15]
  s_waitcnt lgkmcnt(10)
  ds_read_b64_tr_b16 a[196:197], v228 offset:4096
  ds_read_b64_tr_b16 a[198:199], v228 offset:4608
  v_mfma_f32_16x16x32_bf16 v[16:19], a[168:171], a[0:3], 0
  ds_read_b64_tr_b16 a[200:201], v228 offset:8192
  v_mfma_f32_16x16x32_bf16 v[16:19], a[172:175], a[8:11], v[16:19]
  s_waitcnt lgkmcnt(11)
  ds_read_b64_tr_b16 a[202:203], v228 offset:8704
  ds_read_b64_tr_b16 a[204:205], v228 offset:12288
  v_mfma_f32_16x16x32_bf16 v[16:19], a[176:179], a[16:19], v[16:19]
  buffer_load_dwordx4 a[64:67], v225, s[20:23], s39 offen offset:2048 sc1
  v_mfma_f32_16x16x32_bf16 v[20:23], a[168:171], a[4:7], 0
  s_add_u32 s39, s38, 24576
  ds_read_b64_tr_b16 a[206:207], v228 offset:12800
  ds_read_b64_tr_b16 a[144:145], v228 offset:16384
  v_mfma_f32_16x16x32_bf16 v[20:23], a[172:175], a[12:15], v[20:23]
  ds_read_b64_tr_b16 a[146:147], v228 offset:16896
  ds_read_b64_tr_b16 a[148:149], v228 offset:20480
  v_mfma_f32_16x16x32_bf16 v[20:23], a[176:179], a[20:23], v[20:23]
  s_waitcnt lgkmcnt(11)
  ds_read_b64_tr_b16 a[150:151], v228 offset:20992
  v_mfma_f32_16x16x32_bf16 v[24:27], a[180:183], a[0:3], 0
  ds_read_b64_tr_b16 a[152:153], v229 offset:0
  ds_read_b64_tr_b16 a[154:155], v229 offset:512
  v_mfma_f32_16x16x32_bf16 v[24:27], a[184:187], a[8:11], v[24:27]
  buffer_load_dwordx4 a[52:55], v225, s[20:23], s39 offen sc1
  v_mfma_f32_16x16x32_bf16 v[24:27], a[188:191], a[16:19], v[24:27]
  ds_read_b64_tr_b16 a[156:157], v229 offset:4096
  ds_read_b64_tr_b16 a[158:159], v229 offset:4608
  v_mfma_f32_16x16x32_bf16 v[28:31], a[180:183], a[4:7], 0
  ds_read_b64_tr_b16 a[160:161], v229 offset:8192
  ds_read_b64_tr_b16 a[162:163], v229 offset:8704
  v_mfma_f32_16x16x32_bf16 v[28:31], a[184:187], a[12:15], v[28:31]
  ds_read_b64_tr_b16 a[164:165], v229 offset:12288
  ds_read_b64_tr_b16 a[166:167], v229 offset:12800
  v_mfma_f32_16x16x32_bf16 v[28:31], a[188:191], a[20:23], v[28:31]
  s_waitcnt lgkmcnt(12)
  ds_read_b64_tr_b16 a[168:169], v229 offset:16384
  ds_read_b64_tr_b16 a[170:171], v229 offset:16896
  v_mfma_f32_16x16x32_bf16 v[32:35], a[192:195], a[0:3], 0
  buffer_load_dwordx4 a[60:63], v225, s[20:23], s39 offen offset:1024 sc1
  v_mfma_f32_16x16x32_bf16 v[32:35], a[196:199], a[8:11], v[32:35]
  ds_read_b64_tr_b16 a[172:173], v229 offset:20480
  ds_read_b64_tr_b16 a[174:175], v229 offset:20992
  v_mfma_f32_16x16x32_bf16 v[32:35], a[200:203], a[16:19], v[32:35]
  v_mfma_f32_16x16x32_bf16 v[36:39], a[192:195], a[4:7], 0
  v_mfma_f32_16x16x32_bf16 v[36:39], a[196:199], a[12:15], v[36:39]
  v_mfma_f32_16x16x32_bf16 v[36:39], a[200:203], a[20:23], v[36:39]
  buffer_load_dwordx4 a[68:71], v225, s[20:23], s39 offen offset:2048 sc1
  v_mfma_f32_16x16x32_bf16 v[40:43], a[204:207], a[0:3], 0
  s_waitcnt lgkmcnt(4)
  v_mfma_f32_16x16x32_bf16 v[40:43], a[144:147], a[8:11], v[40:43]
L_st0:
  s_waitcnt vmcnt(6) lgkmcnt(0)
  s_barrier
  ds_read_b64_tr_b16 a[176:177], v226 offset:24576
  v_mfma_f32_16x16x32_bf16 v[40:43], a[148:151], a[16:19], v[40:43]
  s_add_u32 s39, s38, 9216
  ds_read_b64_tr_b16 a[178:179], v226 offset:25088
  v_mfma_f32_16x16x32_bf16 v[44:47], a[204:207], a[4:7], 0
  s_mov_b32 s41, L_st5-L_common
  ds_read_b64_tr_b16 a[180:181], v226 offset:28672
  v_mfma_f32_16x16x32_bf16 v[44:47], a[144:147], a[12:15], v[44:47]
  buffer_load_dwordx4 a[72:75], v225, s[20:23], s39 offen sc1
  v_mfma_f32_16x16x32_bf16 v[44:47], a[148:151], a[20:23], v[44:47]
  buffer_load_dword v239, v214, s[52:55], s41 offen
  v_mfma_f32_16x16x32_bf16 v[48:51], a[152:155], a[0:3], 0
  ds_read_b64_tr_b16 a[182:183], v226 offset:29184
  ds_read_b64_tr_b16 a[184:185], v226 offset:32768
  v_mfma_f32_16x16x32_bf16 v[48:51], a[156:159], a[8:11], v[48:51]
  ds_read_b64_tr_b16 a[186:187], v226 offset:33280
  v_mfma_f32_16x16x32_bf16 v[48:51], a[160:163], a[16:19], v[48:51]
  ds_read_b64_tr_b16 a[188:189], v226 offset:36864
  v_mfma_f32_16x16x32_bf16 v[52:55], a[152:155], a[4:7], 0
  buffer_load_dwordx4 a[80:83], v225, s[20:23], s39 offen offset:1024 sc1
  v_mfma_f32_16x16x32_bf16 v[52:55], a[156:159], a[12:15], v[52:55]
  ds_read_b64_tr_b16 a[190:191], v226 offset:37376
  ds_read_b64_tr_b16 a[192:193], v226 offset:40960
  v_mfma_f32_16x16x32_bf16 v[52:55], a[160:163], a[20:23], v[52:55]
  ds_read_b64_tr_b16 a[194:195], v226 offset:41472
  v_mfma_f32_16x16x32_bf16 v[56:59], a[164:167], a[0:3], 0
  ds_read_b64_tr_b16 a[196:197], v226 offset:45056
  v_mfma_f32_16x16x32_bf16 v[56:59], a[168:171], a[8:11], v[56:59]
  ds_read_b64_tr_b16 a[198:199], v226 offset:45568
  ds_read_b64_tr_b16 a[200:201], v227 offset:24576
  v_mfma_f32_16x16x32_bf16 v[56:59], a[172:175], a[16:19], v[56:59]
  buffer_load_dwordx4 a[88:91], v225, s[20:23], s39 offen offset:2048 sc1
  v_mfma_f32_16x16x32_bf16 v[60:63], a[164:167], a[4:7], 0
  s_add_u32 s39, s38, 27648
  ds_read_b64_tr_b16 a[202:203], v227 offset:25088
  ds_read_b64_tr_b16 a[204:205], v227 offset:28672
  v_mfma_f32_16x16x32_bf16 v[60:63], a[168:171], a[12:15], v[60:63]
  ds_read_b64_tr_b16 a[206:207], v227 offset:29184
  v_mfma_f32_16x16x32_bf16 v[60:63], a[172:175], a[20:23], v[60:63]
  s_waitcnt lgkmcnt(10)
  ds_read_b64_tr_b16 a[144:145], v227 offset:32768
  v_mfma_f32_16x16x32_bf16 v[0:3], a[176:179], a[24:27], v[0:3]
  ds_read_b64_tr_b16 a[146:147], v227 offset:33280
  ds_read_b64_tr_b16 a[148:149], v227 offset:36864
  v_mfma_f32_16x16x32_bf16 v[0:3], a[180:183], a[32:35], v[0:3]
  buffer_load_dwordx4 a[76:79], v225, s[20:23], s39 offen sc1
  v_mfma_f32_16x16x32_bf16 v[0:3], a[184:187], a[40:43], v[0:3]
  ds_read_b64_tr_b16 a[150:151], v227 offset:37376
  ds_read_b64_tr_b16 a[152:153], v227 offset:40960
  v_mfma_f32_16x16x32_bf16 v[4:7], a[176:179], a[28:31], v[4:7]
  ds_read_b64_tr_b16 a[154:155], v227 offset:41472
  v_mfma_f32_16x16x32_bf16 v[4:7], a[180:183], a[36:39], v[4:7]
  ds_read_b64_tr_b16 a[156:157], v227 offset:45056
  v_mfma_f32_16x16x32_bf16 v[4:7], a[184:187], a[44:47], v[4:7]
  s_waitcnt lgkmcnt(9)
  ds_read_b64_tr_b16 a[158:159], v227 offset:45568
  ds_read_b64_tr_b16 a[160:161], v228 offset:24576
  v_mfma_f32_16x16x32_bf16 v[8:11], a[188:191], a[24:27], v[8:11]
  buffer_load_dwordx4 a[84:87], v225, s[20:23], s39 offen offset:1024 sc1
  v_mfma_f32_16x16x32_bf16 v[8:11], a[192:195], a[32:35], v[8:11]
  ds_read_b64_tr_b16 a[162:163], v228 offset:25088
  ds_read_b64_tr_b16 a[164:165], v228 offset:28672
  v_mfma_f32_16x16x32_bf16 v[8:11], a[196:199], a[40:43], v[8:11]
  ds_read_b64_tr_b16 a[166:167], v228 offset:29184
  v_mfma_f32_16x16x32_bf16 v[12:15], a[188:191], a[28:31], v[12:15]
  ds_read_b64_tr_b16 a[168:169], v228 offset:32768
  v_mfma_f32_16x16x32_bf16 v[12:15], a[192:195], a[36:39], v[12:15]
  ds_read_b64_tr_b16 a[170:171], v228 offset:33280
  ds_read_b64_tr_b16 a[172:173], v228 offset:36864
  v_mfma_f32_16x16x32_bf16 v[12:15], a[196:199], a[44:47], v[12:15]
  buffer_load_dwordx4 a[92:95], v225, s[20:23], s39 offen offset:2048 sc1
  v_mfma_f32_16x16x32_bf16 v[16:19], a[200:203], a[24:27], v[16:19]
  s_waitcnt lgkmcnt(9)
  ds_read_b64_tr_b16 a[174:175], v228 offset:37376
  ds_read_b64_tr_b16 a[176:177], v228 offset:40960
  v_mfma_f32_16x16x32_bf16 v[16:19], a[204:207], a[32:35], v[16:19]
  s_add_u32 s39, s38, 12288
  ds_read_b64_tr_b16 a[178:179], v228 offset:41472
  v_mfma_f32_16x16x32_bf16 v[16:19], a[144:147], a[40:43], v[16:19]
  ds_read_b64_tr_b16 a[180:181], v228 offset:45056
  ds_read_b64_tr_b16 a[182:183], v228 offset:45568
  v_mfma_f32_16x16x32_bf16 v[20:23], a[200:203], a[28:31], v[20:23]
  ds_read_b64_tr_b16 a[184:185], v229 offset:24576
  v_mfma_f32_16x16x32_bf16 v[20:23], a[204:207], a[36:39], v[20:23]
  buffer_load_dwordx4 a[96:99], v225, s[20:23], s39 offen sc1
  v_mfma_f32_16x16x32_bf16 v[20:23], a[144:147], a[44:47], v[20:23]
  ds_read_b64_tr_b16 a[186:187], v229 offset:25088
  ds_read_b64_tr_b16 a[188:189], v229 offset:28672
  v_mfma_f32_16x16x32_bf16 v[24:27], a[148:151], a[24:27], v[24:27]
  ds_read_b64_tr_b16 a[190:191], v229 offset:29184
  v_mfma_f32_16x16x32_bf16 v[24:27], a[152:155], a[32:35], v[24:27]
  s_waitcnt lgkmcnt(10)
  ds_read_b64_tr_b16 a[192:193], v229 offset:32768
  ds_read_b64_tr_b16 a[194:195], v229 offset:33280
  v_mfma_f32_16x16x32_bf16 v[24:27], a[156:159], a[40:43], v[24:27]
  ds_read_b64_tr_b16 a[196:197], v229 offset:36864
  v_mfma_f32_16x16x32_bf16 v[28:31], a[148:151], a[28:31], v[28:31]
  buffer_load_dwordx4 a[104:107], v225, s[20:23], s39 offen offset:1024 sc1
  v_mfma_f32_16x16x32_bf16 v[28:31], a[152:155], a[36:39], v[28:31]
  ds_read_b64_tr_b16 a[198:199], v229 offset:37376
  ds_read_b64_tr_b16 a[200:201], v229 offset:40960
  v_mfma_f32_16x16x32_bf16 v[28:31], a[156:159], a[44:47], v[28:31]
  ds_read_b64_tr_b16 a[202:203], v229 offset:41472
  ds_read_b64_tr_b16 a[204:205], v229 offset:45056
  v_mfma_f32_16x16x32_bf16 v[32:35], a[160:163], a[24:27], v[32:35]
  ds_read_b64_tr_b16 a[206:207], v229 offset:45568
  v_mfma_f32_16x16x32_bf16 v[32:35], a[164:167], a[32:35], v[32:35]
  v_mfma_f32_16x16x32_bf16 v[32:35], a[168:171], a[40:43], v[32:35]
  buffer_load_dwordx4 a[112:115], v225, s[20:23], s39 offen offset:2048 sc1
  v_mfma_f32_16x16x32_bf16 v[36:39], a[160:163], a[28:31], v[36:39]
  s_add_u32 s39, s38, 30720
  v_mfma_f32_16x16x32_bf16 v[36:39], a[164:167], a[36:39], v[36:39]
  v_mfma_f32_16x16x32_bf16 v[36:39], a[168:171], a[44:47], v[36:39]
  s_waitcnt lgkmcnt(6)
  v_mfma_f32_16x16x32_bf16 v[40:43], a[172:175], a[24:27], v[40:43]
  v_mfma_f32_16x16x32_bf16 v[40:43], a[176:179], a[32:35], v[40:43]
L_st1:
  s_waitcnt vmcnt(10) lgkmcnt(0)
  s_barrier
  ds_read_b64_tr_b16 a[144:145], v230 offset:0
  ds_read_b64_tr_b16 a[146:147], v230 offset:512
  v_mfma_f32_16x16x32_bf16 v[40:43], a[180:183], a[40:43], v[40:43]
  buffer_load_dwordx4 a[100:103], v225, s[20:23], s39 offen sc1
  v_mfma_f32_16x16x32_bf16 v[44:47], a[172:175], a[28:31], v[44:47]
  ds_read_b64_tr_b16 a[148:149], v230 offset:4096
  v_mfma_f32_16x16x32_bf16 v[44:47], a[176:179], a[36:39], v[44:47]
  ds_read_b64_tr_b16 a[150:151], v230 offset:4608
  v_mfma_f32_16x16x32_bf16 v[44:47], a[180:183], a[44:47], v[44:47]
  ds_read_b64_tr_b16 a[152:153], v230 offset:8192
  v_mfma_f32_16x16x32_bf16 v[48:51], a[184:187], a[24:27], v[48:51]
  buffer_load_dwordx4 a[108:111], v225, s[20:23], s39 offen offset:1024 sc1
  v_mfma_f32_16x16x32_bf16 v[48:51], a[188:191], a[32:35], v[48:51]
  ds_read_b64_tr_b16 a[154:155], v230 offset:8704
  ds_read_b64_tr_b16 a[156:157], v230 offset:12288
  v_mfma_f32_16x16x32_bf16 v[48:51], a[192:195], a[40:43], v[48:51]
  ds_read_b64_tr_b16 a[158:159], v230 offset:12800
  v_mfma_f32_16x16x32_bf16 v[52:55], a[184:187], a[28:31], v[52:55]
  ds_read_b64_tr_b16 a[160:161], v230 offset:16384
  v_mfma_f32_16x16x32_bf16 v[52:55], a[188:191], a[36:39], v[52:55]
  ds_read_b64_tr_b16 a[162:163], v230 offset:16896
  ds_read_b64_tr_b16 a[164:165], v230 offset:20480
  v_mfma_f32_16x16x32_bf16 v[52:55], a[192:195], a[44:47], v[52:55]
  buffer_load_dwordx4 a[116:119], v225, s[20:23], s39 offen offset:2048 sc1
  v_mfma_f32_16x16x32_bf16 v[56:59], a[196:199], a[24:27], v[56:59]
  s_add_u32 s39, s38, 15360
  ds_read_b64_tr_b16 a[166:167], v230 offset:20992
  ds_read_b64_tr_b16 a[168:169], v231 offset:0
  v_mfma_f32_16x16x32_bf16 v[56:59], a[200:203], a[32:35], v[56:59]
  ds_read_b64_tr_b16 a[170:171], v231 offset:512
  v_mfma_f32_16x16x32_bf16 v[56:59], a[204:207], a[40:43], v[56:59]
  ds_read_b64_tr_b16 a[172:173], v231 offset:4096
  v_mfma_f32_16x16x32_bf16 v[60:63], a[196:199], a[28:31], v[60:63]
  ds_read_b64_tr_b16 a[174:175], v231 offset:4608
  v_mfma_f32_16x16x32_bf16 v[60:63], a[200:203], a[36:39], v[60:63]
  buffer_load_dwordx4 a[120:123], v225, s[20:23], s39 offen sc1
  v_mfma_f32_16x16x32_bf16 v[60:63], a[204:207], a[44:47], v[60:63]
  s_waitcnt lgkmcnt(8)
  ds_read_b64_tr_b16 a[176:177], v231 offset:8192
  ds_read_b64_tr_b16 a[178:179], v231 offset:8704
  v_mfma_f32_16x16x32_bf16 v[0:3], a[144:147], a[48:51], v[0:3]
  ds_read_b64_tr_b16 a[180:181], v231 offset:12288
  v_mfma_f32_16x16x32_bf16 v[0:3], a[148:151], a[56:59], v[0:3]
  ds_read_b64_tr_b16 a[182:183], v231 offset:12800
  v_mfma_f32_16x16x32_bf16 v[0:3], a[152:155], a[64:67], v[0:3]
  ds_read_b64_tr_b16 a[184:185], v231 offset:16384
  ds_read_b64_tr_b16 a[186:187], v231 offset:16896
  v_mfma_f32_16x16x32_bf16 v[4:7], a[144:147], a[52:55], v[4:7]
  buffer_load_dwordx4 a[128:131], v225, s[20:23], s39 offen offset:1024 sc1
  v_mfma_f32_16x16x32_bf16 v[4:7], a[148:151], a[60:63], v[4:7]
  ds_read_b64_tr_b16 a[188:189], v231 offset:20480
  ds_read_b64_tr_b16 a[190:191], v231 offset:20992
  v_mfma_f32_16x16x32_bf16 v[4:7], a[152:155], a[68:71], v[4:7]
  ds_read_b64_tr_b16 a[192:193], v232 offset:0
  v_mfma_f32_16x16x32_bf16 v[8:11], a[156:159], a[48:51], v[8:11]
  s_waitcnt lgkmcnt(9)
  ds_read_b64_tr_b16 a[194:195], v232 offset:512
  v_mfma_f32_16x16x32_bf16 v[8:11], a[160:163], a[56:59], v[8:11]
  ds_read_b64_tr_b16 a[196:197], v232 offset:4096
  ds_read_b64_tr_b16 a[198:199], v232 offset:4608
  v_mfma_f32_16x16x32_bf16 v[8:11], a[164:167], a[64:67], v[8:11]
  buffer_load_dwordx4 a[136:139], v225, s[20:23], s39 offen offset:2048 sc1
  v_mfma_f32_16x16x32_bf16 v[12:15], a[156:159], a[52:55], v[12:15]
  s_add_u32 s39, s38, 33792
  ds_read_b64_tr_b16 a[200:201], v232 offset:8192
  ds_read_b64_tr_b16 a[202:203], v232 offset:8704
  v_mfma_f32_16x16x32_bf16 v[12:15], a[160:163], a[60:63], v[12:15]
  ds_read_b64_tr_b16 a[204:205], v232 offset:12288
  v_mfma_f32_16x16x32_bf16 v[12:15], a[164:167], a[68:71], v[12:15]
  ds_read_b64_tr_b16 a[206:207], v232 offset:12800
  v_mfma_f32_16x16x32_bf16 v[16:19], a[168:171], a[48:51], v[16:19]
  ds_read_b64_tr_b16 a[144:145], v232 offset:16384
  ds_read_b64_tr_b16 a[146:147], v232 offset:16896
  v_mfma_f32_16x16x32_bf16 v[16:19], a[172:175], a[56:59], v[16:19]
  s_waitcnt lgkmcnt(10)
  ds_read_b64_tr_b16 a[148:149], v232 offset:20480
  ds_read_b64_tr_b16 a[150:151], v232 offset:20992
  v_mfma_f32_16x16x32_bf16 v[16:19], a[176:179], a[64:67], v[16:19]
  buffer_load_dwordx4 a[124:127], v225, s[20:23], s39 offen sc1
  v_mfma_f32_16x16x32_bf16 v[20:23], a[168:171], a[52:55], v[20:23]
  ds_read_b64_tr_b16 a[152:153], v233 offset:0
  v_mfma_f32_16x16x32_bf16 v[20:23], a[172:175], a[60:63], v[20:23]
  ds_read_b64_tr_b16 a[154:155], v233 offset:512
  v_mfma_f32_16x16x32_bf16 v[20:23], a[176:179], a[68:71], v[20:23]
  ds_read_b64_tr_b16 a[156:157], v233 offset:4096
  ds_read_b64_tr_b16 a[158:159], v233 offset:4608
  v_mfma_f32_16x16x32_bf16 v[24:27], a[180:183], a[48:51], v[24:27]
  buffer_load_dwordx4 a[132:135], v225, s[20:23], s39 offen offset:1024 sc1
  v_mfma_f32_16x16x32_bf16 v[24:27], a[184:187], a[56:59], v[24:27]
  ds_read_b64_tr_b16 a[160:161], v233 offset:8192
  ds_read_b64_tr_b16 a[162:163], v233 offset:8704
  v_mfma_f32_16x16x32_bf16 v[24:27], a[188:191], a[64:67], v[24:27]
  ds_read_b64_tr_b16 a[164:165], v233 offset:12288
  v_mfma_f32_16x16x32_bf16 v[28:31], a[180:183], a[52:55], v[28:31]
  ds_read_b64_tr_b16 a[166:167], v233 offset:12800
  v_mfma_f32_16x16x32_bf16 v[28:31], a[184:187], a[60:63], v[28:31]
  ds_read_b64_tr_b16 a[168:169], v233 offset:16384
  ds_read_b64_tr_b16 a[170:171], v233 offset:16896
  v_mfma_f32_16x16x32_bf16 v[28:31], a[188:191], a[68:71], v[28:31]
  s_waitcnt lgkmcnt(10)
  ds_read_b64_tr_b16 a[172:173], v233 offset:20480
  ds_read_b64_tr_b16 a[174:175], v233 offset:20992
  v_mfma_f32_16x16x32_bf16 v[32:35], a[192:195], a[48:51], v[32:35]
  buffer_load_dwordx4 a[140:143], v225, s[20:23], s39 offen offset:2048 sc1
  v_mfma_f32_16x16x32_bf16 v[32:35], a[196:199], a[56:59], v[32:35]
  s_add_u32 m0, s29, 0
  v_mfma_f32_16x16x32_bf16 v[32:35], a[200:203], a[64:67], v[32:35]
  s_add_u32 s35, s31, 128
  v_mfma_f32_16x16x32_bf16 v[36:39], a[192:195], a[52:55], v[36:39]
  v_mfma_f32_16x16x32_bf16 v[36:39], a[196:199], a[60:63], v[36:39]
  buffer_load_dwordx4 v216, s[12:15], s35 offen sc1 lds
  v_mfma_f32_16x16x32_bf16 v[36:39], a[200:203], a[68:71], v[36:39]
  v_mfma_f32_16x16x32_bf16 v[40:43], a[204:207], a[48:51], v[40:43]
  v_mfma_f32_16x16x32_bf16 v[40:43], a[144:147], a[56:59], v[40:43]
L_st2:
  s_waitcnt vmcnt(13) lgkmcnt(0)
  s_barrier
  ds_read_b64_tr_b16 a[176:177], v230 offset:24576
  v_mfma_f32_16x16x32_bf16 v[40:43], a[148:151], a[64:67], v[40:43]
  ds_read_b64_tr_b16 a[178:179], v230 offset:25088
  v_mfma_f32_16x16x32_bf16 v[44:47], a[204:207], a[52:55], v[44:47]
  buffer_load_dwordx4 v217, s[12:15], s35 offen offset:1024 sc1 lds
  v_mfma_f32_16x16x32_bf16 v[44:47], a[144:147], a[60:63], v[44:47]
  ds_read_b64_tr_b16 a[180:181], v230 offset:28672
  v_mfma_f32_16x16x32_bf16 v[44:47], a[148:151], a[68:71], v[44:47]
  ds_read_b64_tr_b16 a[182:183], v230 offset:29184
  ds_read_b64_tr_b16 a[184:185], v230 offset:32768
  v_mfma_f32_16x16x32_bf16 v[48:51], a[152:155], a[48:51], v[48:51]
  ds_read_b64_tr_b16 a[186:187], v230 offset:33280
  v_mfma_f32_16x16x32_bf16 v[48:51], a[156:159], a[56:59], v[48:51]
  ds_read_b64_tr_b16 a[188:189], v230 offset:36864
  v_mfma_f32_16x16x32_bf16 v[48:51], a[160:163], a[64:67], v[48:51]
  buffer_load_dwordx4 v218, s[12:15], s35 offen offset:2048 sc1 lds
  v_mfma_f32_16x16x32_bf16 v[52:55], a[152:155], a[52:55], v[52:55]
  ds_read_b64_tr_b16 a[190:191], v230 offset:37376
  ds_read_b64_tr_b16 a[192:193], v230 offset:40960
  v_mfma_f32_16x16x32_bf16 v[52:55], a[156:159], a[60:63], v[52:55]
  ds_read_b64_tr_b16 a[194:195], v230 offset:41472
  v_mfma_f32_16x16x32_bf16 v[52:55], a[160:163], a[68:71], v[52:55]
  ds_read_b64_tr_b16 a[196:197], v230 offset:45056
  v_mfma_f32_16x16x32_bf16 v[56:59], a[164:167], a[48:51], v[56:59]
  ds_read_b64_tr_b16 a[198:199], v230 offset:45568
  ds_read_b64_tr_b16 a[200:201], v231 offset:24576
  v_mfma_f32_16x16x32_bf16 v[56:59], a[168:171], a[56:59], v[56:59]
  buffer_load_dwordx4 v219, s[12:15], s35 offen offset:3072 sc1 lds
  v_mfma_f32_16x16x32_bf16 v[56:59], a[172:175], a[64:67], v[56:59]
  s_add_u32 m0, s29, 4096
  ds_read_b64_tr_b16 a[202:203], v231 offset:25088
  ds_read_b64_tr_b16 a[204:205], v231 offset:28672
  v_mfma_f32_16x16x32_bf16 v[60:63], a[164:167], a[52:55], v[60:63]
  s_add_u32 s35, s31, 295040
  ds_read_b64_tr_b16 a[206:207], v231 offset:29184
  v_mfma_f32_16x16x32_bf16 v[60:63], a[168:171], a[60:63], v[60:63]
  ds_read_b64_tr_b16 a[144:145], v231 offset:32768
  v_mfma_f32_16x16x32_bf16 v[60:63], a[172:175], a[68:71], v[60:63]
  s_waitcnt lgkmcnt(9)
  ds_read_b64_tr_b16 a[146:147], v231 offset:33280
  v_mfma_f32_16x16x32_bf16 v[0:3], a[176:179], a[72:75], v[0:3]
  buffer_load_dwordx4 v216, s[12:15], s35 offen sc1 lds
  v_mfma_f32_16x16x32_bf16 v[0:3], a[180:183], a[80:83], v[0:3]
  ds_read_b64_tr_b16 a[148:149], v231 offset:36864
  ds_read_b64_tr_b16 a[150:151], v231 offset:37376
  v_mfma_f32_16x16x32_bf16 v[0:3], a[184:187], a[88:91], v[0:3]
  ds_read_b64_tr_b16 a[152:153], v231 offset:40960
  v_mfma_f32_16x16x32_bf16 v[4:7], a[176:179], a[76:79], v[4:7]
  ds_read_b64_tr_b16 a[154:155], v231 offset:41472
  v_mfma_f32_16x16x32_bf16 v[4:7], a[180:183], a[84:87], v[4:7]
  ds_read_b64_tr_b16 a[156:157], v231 offset:45056
  ds_read_b64_tr_b16 a[158:159], v231 offset:45568
  v_mfma_f32_16x16x32_bf16 v[4:7], a[184:187], a[92:95], v[4:7]
  buffer_load_dwordx4 v217, s[12:15], s35 offen offset:1024 sc1 lds
  v_mfma_f32_16x16x32_bf16 v[8:11], a[188:191], a[72:75], v[8:11]
  s_waitcnt lgkmcnt(8)
  ds_read_b64_tr_b16 a[160:161], v232 offset:24576
  ds_read_b64_tr_b16 a[162:163], v232 offset:25088
  v_mfma_f32_16x16x32_bf16 v[8:11], a[192:195], a[80:83], v[8:11]
  s_add_u32 m0, s29, 24576
  ds_read_b64_tr_b16 a[164:165], v232 offset:28672
  v_mfma_f32_16x16x32_bf16 v[8:11], a[196:199], a[88:91], v[8:11]
  s_add_u32 s35, s31, 884864
  ds_read_b64_tr_b16 a[166:167], v232 offset:29184
  v_mfma_f32_16x16x32_bf16 v[12:15], a[188:191], a[76:79], v[12:15]
  ds_read_b64_tr_b16 a[168:169], v232 offset:32768
  ds_read_b64_tr_b16 a[170:171], v232 offset:33280
  v_mfma_f32_16x16x32_bf16 v[12:15], a[192:195], a[84:87], v[12:15]
  buffer_load_dwordx4 v216, s[12:15], s35 offen sc1 lds
  v_mfma_f32_16x16x32_bf16 v[12:15], a[196:199], a[92:95], v[12:15]
  ds_read_b64_tr_b16 a[172:173], v232 offset:36864
  ds_read_b64_tr_b16 a[174:175], v232 offset:37376
  v_mfma_f32_16x16x32_bf16 v[16:19], a[200:203], a[72:75], v[16:19]
  ds_read_b64_tr_b16 a[176:177], v232 offset:40960
  v_mfma_f32_16x16x32_bf16 v[16:19], a[204:207], a[80:83], v[16:19]
  s_waitcnt lgkmcnt(9)
  ds_read_b64_tr_b16 a[178:179], v232 offset:41472
  v_mfma_f32_16x16x32_bf16 v[16:19], a[144:147], a[88:91], v[16:19]
  ds_read_b64_tr_b16 a[180:181], v232 offset:45056
  ds_read_b64_tr_b16 a[182:183], v232 offset:45568
  v_mfma_f32_16x16x32_bf16 v[20:23], a[200:203], a[76:79], v[20:23]
  buffer_load_dwordx4 v217, s[12:15], s35 offen offset:1024 sc1 lds
  v_mfma_f32_16x16x32_bf16 v[20:23], a[204:207], a[84:87], v[20:23]
  ds_read_b64_tr_b16 a[184:185], v233 offset:24576
  ds_read_b64_tr_b16 a[186:187], v233 offset:25088
  v_mfma_f32_16x16x32_bf16 v[20:23], a[144:147], a[92:95], v[20:23]
  ds_read_b64_tr_b16 a[188:189], v233 offset:28672
  v_mfma_f32_16x16x32_bf16 v[24:27], a[148:151], a[72:75], v[24:27]
  ds_read_b64_tr_b16 a[190:191], v233 offset:29184
  ds_read_b64_tr_b16 a[192:193], v233 offset:32768
  v_mfma_f32_16x16x32_bf16 v[24:27], a[152:155], a[80:83], v[24:27]
  ds_read_b64_tr_b16 a[194:195], v233 offset:33280
  v_mfma_f32_16x16x32_bf16 v[24:27], a[156:159], a[88:91], v[24:27]
  buffer_load_dwordx4 v218, s[12:15], s35 offen offset:2048 sc1 lds
  v_mfma_f32_16x16x32_bf16 v[28:31], a[148:151], a[76:79], v[28:31]
  ds_read_b64_tr_b16 a[196:197], v233 offset:36864
  ds_read_b64_tr_b16 a[198:199], v233 offset:37376
  v_mfma_f32_16x16x32_bf16 v[28:31], a[152:155], a[84:87], v[28:31]
  ds_read_b64_tr_b16 a[200:201], v233 offset:40960
  v_mfma_f32_16x16x32_bf16 v[28:31], a[156:159], a[92:95], v[28:31]
  s_waitcnt lgkmcnt(9)
  ds_read_b64_tr_b16 a[202:203], v233 offset:41472
  ds_read_b64_tr_b16 a[204:205], v233 offset:45056
  v_mfma_f32_16x16x32_bf16 v[32:35], a[160:163], a[72:75], v[32:35]
  ds_read_b64_tr_b16 a[206:207], v233 offset:45568
  v_mfma_f32_16x16x32_bf16 v[32:35], a[164:167], a[80:83], v[32:35]
  buffer_load_dwordx4 v219, s[12:15], s35 offen offset:3072 sc1 lds
  v_mfma_f32_16x16x32_bf16 v[32:35], a[168:171], a[88:91], v[32:35]
  s_add_u32 m0, s29, 28672
  v_mfma_f32_16x16x32_bf16 v[36:39], a[160:163], a[76:79], v[36:39]
  s_add_u32 s35, s31, 1179776
  v_mfma_f32_16x16x32_bf16 v[36:39], a[164:167], a[84:87], v[36:39]
  v_mfma_f32_16x16x32_bf16 v[36:39], a[168:171], a[92:95], v[36:39]
  v_mfma_f32_16x16x32_bf16 v[40:43], a[172:175], a[72:75], v[40:43]
  buffer_load_dwordx4 v216, s[12:15], s35 offen sc1 lds
  v_mfma_f32_16x16x32_bf16 v[40:43], a[176:179], a[80:83], v[40:43]
L_st3:
  s_waitcnt vmcnt(17) lgkmcnt(0)
  s_barrier
  ds_read_b64_tr_b16 a[144:145], v234 offset:0
  v_mfma_f32_16x16x32_bf16 v[40:43], a[180:183], a[88:91], v[40:43]
  ds_read_b64_tr_b16 a[146:147], v234 offset:512
  v_mfma_f32_16x16x32_bf16 v[44:47], a[172:175], a[76:79], v[44:47]
  ds_read_b64_tr_b16 a[148:149], v234 offset:4096
  v_mfma_f32_16x16x32_bf16 v[44:47], a[176:179], a[84:87], v[44:47]
  ds_read_b64_tr_b16 a[150:151], v234 offset:4608
  v_mfma_f32_16x16x32_bf16 v[44:47], a[180:183], a[92:95], v[44:47]
  buffer_load_dwordx4 v217, s[12:15], s35 offen offset:1024 sc1 lds
  v_mfma_f32_16x16x32_bf16 v[48:51], a[184:187], a[72:75], v[48:51]
  s_add_u32 m0, s29, 49152
  ds_read_b64_tr_b16 a[152:153], v234 offset:8192
  ds_read_b64_tr_b16 a[154:155], v234 offset:8704
  v_mfma_f32_16x16x32_bf16 v[48:51], a[188:191], a[80:83], v[48:51]
  s_add_u32 s35, s31, 1769600
  ds_read_b64_tr_b16 a[156:157], v234 offset:12288
  v_mfma_f32_16x16x32_bf16 v[48:51], a[192:195], a[88:91], v[48:51]
  ds_read_b64_tr_b16 a[158:159], v234 offset:12800
  v_mfma_f32_16x16x32_bf16 v[52:55], a[184:187], a[76:79], v[52:55]
  ds_read_b64_tr_b16 a[160:161], v234 offset:16384
  ds_read_b64_tr_b16 a[162:163], v234 offset:16896
  v_mfma_f32_16x16x32_bf16 v[52:55], a[188:191], a[84:87], v[52:55]
  buffer_load_dwordx4 v216, s[12:15], s35 offen sc1 lds
  v_mfma_f32_16x16x32_bf16 v[52:55], a[192:195], a[92:95], v[52:55]
  ds_read_b64_tr_b16 a[164:165], v234 offset:20480
  ds_read_b64_tr_b16 a[166:167], v234 offset:20992
  v_mfma_f32_16x16x32_bf16 v[56:59], a[196:199], a[72:75], v[56:59]
  ds_read_b64_tr_b16 a[168:169], v235 offset:0
  v_mfma_f32_16x16x32_bf16 v[56:59], a[200:203], a[80:83], v[56:59]
  ds_read_b64_tr_b16 a[170:171], v235 offset:512
  v_mfma_f32_16x16x32_bf16 v[56:59], a[204:207], a[88:91], v[56:59]
  ds_read_b64_tr_b16 a[172:173], v235 offset:4096
  v_mfma_f32_16x16x32_bf16 v[60:63], a[196:199], a[76:79], v[60:63]
  buffer_load_dwordx4 v217, s[12:15], s35 offen offset:1024 sc1 lds
  v_mfma_f32_16x16x32_bf16 v[60:63], a[200:203], a[84:87], v[60:63]
  ds_read_b64_tr_b16 a[174:175], v235 offset:4608
  ds_read_b64_tr_b16 a[176:177], v235 offset:8192
  v_mfma_f32_16x16x32_bf16 v[60:63], a[204:207], a[92:95], v[60:63]
  s_waitcnt lgkmcnt(7)
  ds_read_b64_tr_b16 a[178:179], v235 offset:8704
  v_mfma_f32_16x16x32_bf16 v[0:3], a[144:147], a[96:99], v[0:3]
  ds_read_b64_tr_b16 a[180:181], v235 offset:12288
  v_mfma_f32_16x16x32_bf16 v[0:3], a[148:151], a[104:107], v[0:3]
  buffer_load_dwordx4 v218, s[12:15], s35 offen offset:2048 sc1 lds
  v_mfma_f32_16x16x32_bf16 v[0:3], a[152:155], a[112:115], v[0:3]
  ds_read_b64_tr_b16 a[182:183], v235 offset:12800
  ds_read_b64_tr_b16 a[184:185], v235 offset:16384
  v_mfma_f32_16x16x32_bf16 v[4:7], a[144:147], a[100:103], v[4:7]
  ds_read_b64_tr_b16 a[186:187], v235 offset:16896
  v_mfma_f32_16x16x32_bf16 v[4:7], a[148:151], a[108:111], v[4:7]
  buffer_load_dwordx4 v219, s[12:15], s35 offen offset:3072 sc1 lds
  v_mfma_f32_16x16x32_bf16 v[4:7], a[152:155], a[116:119], v[4:7]
  s_add_u32 m0, s29, 53248
  ds_read_b64_tr_b16 a[188:189], v235 offset:20480
  ds_read_b64_tr_b16 a[190:191], v235 offset:20992
  v_mfma_f32_16x16x32_bf16 v[8:11], a[156:159], a[96:99], v[8:11]
  s_add_u32 s35, s31, 2064512
  ds_read_b64_tr_b16 a[192:193], v236 offset:0
  v_mfma_f32_16x16x32_bf16 v[8:11], a[160:163], a[104:107], v[8:11]
  s_waitcnt lgkmcnt(7)
  ds_read_b64_tr_b16 a[194:195], v236 offset:512
  ds_read_b64_tr_b16 a[196:197], v236 offset:4096
  v_mfma_f32_16x16x32_bf16 v[8:11], a[164:167], a[112:115], v[8:11]
  buffer_load_dwordx4 v216, s[12:15], s35 offen sc1 lds
  v_mfma_f32_16x16x32_bf16 v[12:15], a[156:159], a[100:103], v[12:15]
  ds_read_b64_tr_b16 a[198:199], v236 offset:4608
  ds_read_b64_tr_b16 a[200:201], v236 offset:8192
  v_mfma_f32_16x16x32_bf16 v[12:15], a[160:163], a[108:111], v[12:15]
  ds_read_b64_tr_b16 a[202:203], v236 offset:8704
  v_mfma_f32_16x16x32_bf16 v[12:15], a[164:167], a[116:119], v[12:15]
  buffer_load_dwordx4 v217, s[12:15], s35 offen offset:1024 sc1 lds
  v_mfma_f32_16x16x32_bf16 v[16:19], a[168:171], a[96:99], v[16:19]
  s_add_u32 m0, s29, 73728
  ds_read_b64_tr_b16 a[204:205], v236 offset:12288
  ds_read_b64_tr_b16 a[206:207], v236 offset:12800
  v_mfma_f32_16x16x32_bf16 v[16:19], a[172:175], a[104:107], v[16:19]
  s_add_u32 s35, s31, 2654336
  ds_read_b64_tr_b16 a[144:145], v236 offset:16384
  v_mfma_f32_16x16x32_bf16 v[16:19], a[176:179], a[112:115], v[16:19]
  buffer_load_dwordx4 v216, s[12:15], s35 offen sc1 lds
  v_mfma_f32_16x16x32_bf16 v[20:23], a[168:171], a[100:103], v[20:23]
  ds_read_b64_tr_b16 a[146:147], v236 offset:16896
  ds_read_b64_tr_b16 a[148:149], v236 offset:20480
  v_mfma_f32_16x16x32_bf16 v[20:23], a[172:175], a[108:111], v[20:23]
  ds_read_b64_tr_b16 a[150:151], v236 offset:20992
  v_mfma_f32_16x16x32_bf16 v[20:23], a[176:179], a[116:119], v[20:23]
  s_waitcnt lgkmcnt(8)
  ds_read_b64_tr_b16 a[152:153], v237 offset:0
  ds_read_b64_tr_b16 a[154:155], v237 offset:512
  v_mfma_f32_16x16x32_bf16 v[24:27], a[180:183], a[96:99], v[24:27]
  buffer_load_dwordx4 v217, s[12:15], s35 offen offset:1024 sc1 lds
  v_mfma_f32_16x16x32_bf16 v[24:27], a[184:187], a[104:107], v[24:27]
  ds_read_b64_tr_b16 a[156:157], v237 offset:4096
  ds_read_b64_tr_b16 a[158:159], v237 offset:4608
  v_mfma_f32_16x16x32_bf16 v[24:27], a[188:191], a[112:115], v[24:27]
  buffer_load_dwordx4 v218, s[12:15], s35 offen offset:2048 sc1 lds
  v_mfma_f32_16x16x32_bf16 v[28:31], a[180:183], a[100:103], v[28:31]
  ds_read_b64_tr_b16 a[160:161], v237 offset:8192
  ds_read_b64_tr_b16 a[162:163], v237 offset:8704
  v_mfma_f32_16x16x32_bf16 v[28:31], a[184:187], a[108:111], v[28:31]
  ds_read_b64_tr_b16 a[164:165], v237 offset:12288
  ds_read_b64_tr_b16 a[166:167], v237 offset:12800
  v_mfma_f32_16x16x32_bf16 v[28:31], a[188:191], a[116:119], v[28:31]
  buffer_load_dwordx4 v219, s[12:15], s35 offen offset:3072 sc1 lds
  v_mfma_f32_16x16x32_bf16 v[32:35], a[192:195], a[96:99], v[32:35]
  s_add_u32 m0, s29, 77824
  ds_read_b64_tr_b16 a[168:169], v237 offset:16384
  ds_read_b64_tr_b16 a[170:171], v237 offset:16896
  v_mfma_f32_16x16x32_bf16 v[32:35], a[196:199], a[104:107], v[32:35]
  s_waitcnt lgkmcnt(8)
  ds_read_b64_tr_b16 a[172:173], v237 offset:20480
  ds_read_b64_tr_b16 a[174:175], v237 offset:20992
  v_mfma_f32_16x16x32_bf16 v[32:35], a[200:203], a[112:115], v[32:35]
  s_add_u32 s35, s31, 2949248
  v_mfma_f32_16x16x32_bf16 v[36:39], a[192:195], a[100:103], v[36:39]
  buffer_load_dwordx4 v216, s[12:15], s35 offen sc1 lds
  v_mfma_f32_16x16x32_bf16 v[36:39], a[196:199], a[108:111], v[36:39]
  v_mfma_f32_16x16x32_bf16 v[36:39], a[200:203], a[116:119], v[36:39]
  buffer_load_dwordx4 v217, s[12:15], s35 offen offset:1024 sc1 lds
  v_mfma_f32_16x16x32_bf16 v[40:43], a[204:207], a[96:99], v[40:43]
  v_mfma_f32_16x16x32_bf16 v[40:43], a[144:147], a[104:107], v[40:43]
L_st4:
  s_waitcnt vmcnt(24) lgkmcnt(0)
  s_barrier
  ds_read_b64_tr_b16 a[176:177], v234 offset:24576
  v_mfma_f32_16x16x32_bf16 v[40:43], a[148:151], a[112:115], v[40:43]
  s_add_u32 m0, s29, 98304
  ds_read_b64_tr_b16 a[178:179], v234 offset:25088
  v_mfma_f32_16x16x32_bf16 v[44:47], a[204:207], a[100:103], v[44:47]
  s_add_u32 s35, s31, 3539072
  ds_read_b64_tr_b16 a[180:181], v234 offset:28672
  v_mfma_f32_16x16x32_bf16 v[44:47], a[144:147], a[108:111], v[44:47]
  ds_read_b64_tr_b16 a[182:183], v234 offset:29184
  ds_read_b64_tr_b16 a[184:185], v234 offset:32768
  v_mfma_f32_16x16x32_bf16 v[44:47], a[148:151], a[116:119], v[44:47]
  ds_read_b64_tr_b16 a[186:187], v234 offset:33280
  v_mfma_f32_16x16x32_bf16 v[48:51], a[152:155], a[96:99], v[48:51]
  ds_read_b64_tr_b16 a[188:189], v234 offset:36864
  v_mfma_f32_16x16x32_bf16 v[48:51], a[156:159], a[104:107], v[48:51]
  buffer_load_dwordx4 v216, s[12:15], s35 offen sc1 lds
  v_mfma_f32_16x16x32_bf16 v[48:51], a[160:163], a[112:115], v[48:51]
  ds_read_b64_tr_b16 a[190:191], v234 offset:37376
  ds_read_b64_tr_b16 a[192:193], v234 offset:40960
  v_mfma_f32_16x16x32_bf16 v[52:55], a[152:155], a[100:103], v[52:55]
  ds_read_b64_tr_b16 a[194:195], v234 offset:41472
  v_mfma_f32_16x16x32_bf16 v[52:55], a[156:159], a[108:111], v[52:55]
  ds_read_b64_tr_b16 a[196:197], v234 offset:45056
  v_mfma_f32_16x16x32_bf16 v[52:55], a[160:163], a[116:119], v[52:55]
  ds_read_b64_tr_b16 a[198:199], v234 offset:45568
  v_mfma_f32_16x16x32_bf16 v[56:59], a[164:167], a[96:99], v[56:59]
  ds_read_b64_tr_b16 a[200:201], v235 offset:24576
  ds_read_b64_tr_b16 a[202:203], v235 offset:25088
  v_mfma_f32_16x16x32_bf16 v[56:59], a[168:171], a[104:107], v[56:59]
  buffer_load_dwordx4 v217, s[12:15], s35 offen offset:1024 sc1 lds
  v_mfma_f32_16x16x32_bf16 v[56:59], a[172:175], a[112:115], v[56:59]
  ds_read_b64_tr_b16 a[204:205], v235 offset:28672
  ds_read_b64_tr_b16 a[206:207], v235 offset:29184
  v_mfma_f32_16x16x32_bf16 v[60:63], a[164:167], a[100:103], v[60:63]
  ds_read_b64_tr_b16 a[144:145], v235 offset:32768
  v_mfma_f32_16x16x32_bf16 v[60:63], a[168:171], a[108:111], v[60:63]
  ds_read_b64_tr_b16 a[146:147], v235 offset:33280
  v_mfma_f32_16x16x32_bf16 v[60:63], a[172:175], a[116:119], v[60:63]
  s_waitcnt lgkmcnt(8)
  ds_read_b64_tr_b16 a[148:149], v235 offset:36864
  v_mfma_f32_16x16x32_bf16 v[0:3], a[176:179], a[120:123], v[0:3]
  ds_read_b64_tr_b16 a[150:151], v235 offset:37376
  ds_read_b64_tr_b16 a[152:153], v235 offset:40960
  v_mfma_f32_16x16x32_bf16 v[0:3], a[180:183], a[128:131], v[0:3]
  ds_read_b64_tr_b16 a[154:155], v235 offset:41472
  v_mfma_f32_16x16x32_bf16 v[64:67], a[184:187], a[136:139], v[0:3]
  buffer_load_dwordx4 v218, s[12:15], s35 offen offset:2048 sc1 lds
  v_mfma_f32_16x16x32_bf16 v[4:7], a[176:179], a[124:127], v[4:7]
  ds_read_b64_tr_b16 a[156:157], v235 offset:45056
  ds_read_b64_tr_b16 a[158:159], v235 offset:45568
  v_mfma_f32_16x16x32_bf16 v[4:7], a[180:183], a[132:135], v[4:7]
  ds_read_b64_tr_b16 a[160:161], v236 offset:24576
  v_mfma_f32_16x16x32_bf16 v[68:71], a[184:187], a[140:143], v[4:7]
  ds_read_b64_tr_b16 a[162:163], v236 offset:25088
  v_mfma_f32_16x16x32_bf16 v[8:11], a[188:191], a[120:123], v[8:11]
  ds_read_b64_tr_b16 a[164:165], v236 offset:28672
  v_mfma_f32_16x16x32_bf16 v[8:11], a[192:195], a[128:131], v[8:11]
  s_waitcnt lgkmcnt(9)
  ds_read_b64_tr_b16 a[166:167], v236 offset:29184
  ds_read_b64_tr_b16 a[168:169], v236 offset:32768
  v_mfma_f32_16x16x32_bf16 v[72:75], a[196:199], a[136:139], v[8:11]
  ds_read_b64_tr_b16 a[170:171], v236 offset:33280
  v_mfma_f32_16x16x32_bf16 v[12:15], a[188:191], a[124:127], v[12:15]
  buffer_load_dwordx4 v219, s[12:15], s35 offen offset:3072 sc1 lds
  v_mfma_f32_16x16x32_bf16 v[12:15], a[192:195], a[132:135], v[12:15]
  s_add_u32 m0, s29, 102400
  ds_read_b64_tr_b16 a[172:173], v236 offset:36864
  ds_read_b64_tr_b16 a[174:175], v236 offset:37376
  v_mfma_f32_16x16x32_bf16 v[76:79], a[196:199], a[140:143], v[12:15]
  s_add_u32 s35, s31, 3833984
  ds_read_b64_tr_b16 a[176:177], v236 offset:40960
  v_fma_f32 v200, -v64, v64, s37
  v_mfma_f32_16x16x32_bf16 v[16:19], a[200:203], a[120:123], v[16:19]
  ds_read_b64_tr_b16 a[178:179], v236 offset:41472
  v_fma_f32 v201, -v65, v65, s37
  v_mfma_f32_16x16x32_bf16 v[16:19], a[204:207], a[128:131], v[16:19]
  ds_read_b64_tr_b16 a[180:181], v236 offset:45056
  v_fma_f32 v202, -v66, v66, s37
  v_mfma_f32_16x16x32_bf16 v[80:83], a[144:147], a[136:139], v[16:19]
  ds_read_b64_tr_b16 a[182:183], v236 offset:45568
  ds_read_b64_tr_b16 a[184:185], v237 offset:24576
  v_mfma_f32_16x16x32_bf16 v[20:23], a[200:203], a[124:127], v[20:23]
  buffer_load_dwordx4 v216, s[12:15], s35 offen sc1 lds
  v_mfma_f32_16x16x32_bf16 v[20:23], a[204:207], a[132:135], v[20:23]
  ds_read_b64_tr_b16 a[186:187], v237 offset:25088
  ds_read_b64_tr_b16 a[188:189], v237 offset:28672
  v_mfma_f32_16x16x32_bf16 v[84:87], a[144:147], a[140:143], v[20:23]
  s_waitcnt lgkmcnt(9)
  ds_read_b64_tr_b16 a[190:191], v237 offset:29184
  v_fma_f32 v203, -v67, v67, s37
  v_mfma_f32_16x16x32_bf16 v[24:27], a[148:151], a[120:123], v[24:27]
  ds_read_b64_tr_b16 a[192:193], v237 offset:32768
  v_mul_f32 v200, v64, v200
  v_mfma_f32_16x16x32_bf16 v[24:27], a[152:155], a[128:131], v[24:27]
  ds_read_b64_tr_b16 a[194:195], v237 offset:33280
  v_mul_f32 v201, v65, v201
  v_mfma_f32_16x16x32_bf16 v[88:91], a[156:159], a[136:139], v[24:27]
  ds_read_b64_tr_b16 a[196:197], v237 offset:36864
  ds_read_b64_tr_b16 a[198:199], v237 offset:37376
  v_mfma_f32_16x16x32_bf16 v[28:31], a[148:151], a[124:127], v[28:31]
  ds_read_b64_tr_b16 a[200:201], v237 offset:40960
  v_mul_f32 v202, v66, v202
  v_mfma_f32_16x16x32_bf16 v[28:31], a[152:155], a[132:135], v[28:31]
  buffer_load_dwordx4 v217, s[12:15], s35 offen offset:1024 sc1 lds
  v_mfma_f32_16x16x32_bf16 v[92:95], a[156:159], a[140:143], v[28:31]
  ds_read_b64_tr_b16 a[202:203], v237 offset:41472
  ds_read_b64_tr_b16 a[204:205], v237 offset:45056
  v_mfma_f32_16x16x32_bf16 v[32:35], a[160:163], a[120:123], v[32:35]
  ds_read_b64_tr_b16 a[206:207], v237 offset:45568
  v_mul_f32 v203, v67, v203
  v_mfma_f32_16x16x32_bf16 v[32:35], a[164:167], a[128:131], v[32:35]
  v_exp_f32 v200, v200
  v_mfma_f32_16x16x32_bf16 v[96:99], a[168:171], a[136:139], v[32:35]
  v_exp_f32 v201, v201
  v_mfma_f32_16x16x32_bf16 v[36:39], a[160:163], a[124:127], v[36:39]
  v_exp_f32 v202, v202
  v_mfma_f32_16x16x32_bf16 v[36:39], a[164:167], a[132:135], v[36:39]
  v_exp_f32 v203, v203
  v_mfma_f32_16x16x32_bf16 v[100:103], a[168:171], a[140:143], v[36:39]
  s_waitcnt lgkmcnt(6)
  v_mul_f32 v72, v64, v72
  v_mul_f32 v73, v65, v73
  v_mfma_f32_16x16x32_bf16 v[40:43], a[172:175], a[120:123], v[40:43]
  v_mul_f32 v74, v66, v74
  v_mul_f32 v75, v67, v75
  v_mfma_f32_16x16x32_bf16 v[40:43], a[176:179], a[128:131], v[40:43]
L_st5:
  s_waitcnt vmcnt(18) lgkmcnt(0)
  s_barrier
  ds_read_b64_tr_b16 a[144:145], v226 offset:0
  v_add_f32 v200, 1.0, v200
  v_mfma_f32_16x16x32_bf16 v[104:107], a[180:183], a[136:139], v[40:43]
  s_add_u32 m0, s29, 122880
  ds_read_b64_tr_b16 a[146:147], v226 offset:512
  v_add_f32 v201, 1.0, v201
  v_mfma_f32_16x16x32_bf16 v[44:47], a[172:175], a[124:127], v[44:47]
  s_add_u32 s35, s31, 4423808
  ds_read_b64_tr_b16 a[148:149], v226 offset:4096
  v_add_f32 v202, 1.0, v202
  v_mfma_f32_16x16x32_bf16 v[44:47], a[176:179], a[132:135], v[44:47]
  s_add_u32 s41, s31, 384
  ds_read_b64_tr_b16 a[150:151], v226 offset:4608
  v_add_f32 v203, 1.0, v203
  v_mfma_f32_16x16x32_bf16 v[108:111], a[180:183], a[140:143], v[44:47]
  buffer_load_dword v239, v215, s[12:15], s41 offen
  v_mfma_f32_16x16x32_bf16 v[48:51], a[184:187], a[120:123], v[48:51]
  ds_read_b64_tr_b16 a[152:153], v226 offset:8192
  ds_read_b64_tr_b16 a[154:155], v226 offset:8704
  v_mfma_f32_16x16x32_bf16 v[48:51], a[188:191], a[128:131], v[48:51]
  buffer_load_dwordx4 v216, s[12:15], s35 offen sc1 lds
  v_mfma_f32_16x16x32_bf16 v[112:115], a[192:195], a[136:139], v[48:51]
  ds_read_b64_tr_b16 a[156:157], v226 offset:24576
  ds_read_b64_tr_b16 a[158:159], v226 offset:25088
  v_mfma_f32_16x16x32_bf16 v[52:55], a[184:187], a[124:127], v[52:55]
  ds_read_b64_tr_b16 a[160:161], v226 offset:28672
  ds_read_b64_tr_b16 a[162:163], v226 offset:29184
  v_mfma_f32_16x16x32_bf16 v[52:55], a[188:191], a[132:135], v[52:55]
  v_rcp_f32 v200, v200
  v_mfma_f32_16x16x32_bf16 v[116:119], a[192:195], a[140:143], v[52:55]
  ds_read_b64_tr_b16 a[164:165], v226 offset:32768
  ds_read_b64_tr_b16 a[166:167], v226 offset:33280
  v_mfma_f32_16x16x32_bf16 v[56:59], a[196:199], a[120:123], v[56:59]
  v_rcp_f32 v201, v201
  v_mfma_f32_16x16x32_bf16 v[56:59], a[200:203], a[128:131], v[56:59]
  buffer_load_dwordx4 v217, s[12:15], s35 offen offset:1024 sc1 lds
  v_mfma_f32_16x16x32_bf16 v[120:123], a[204:207], a[136:139], v[56:59]
  ds_read_b64_tr_b16 a[168:169], v226 offset:12288
  ds_read_b64_tr_b16 a[170:171], v226 offset:12800
  v_mfma_f32_16x16x32_bf16 v[60:63], a[196:199], a[124:127], v[60:63]
  ds_read_b64_tr_b16 a[172:173], v226 offset:16384
  ds_read_b64_tr_b16 a[174:175], v226 offset:16896
  v_mfma_f32_16x16x32_bf16 v[60:63], a[200:203], a[132:135], v[60:63]
  v_rcp_f32 v202, v202
  v_mfma_f32_16x16x32_bf16 v[124:127], a[204:207], a[140:143], v[60:63]
  s_waitcnt lgkmcnt(6)
  ds_read_b64_tr_b16 a[176:177], v226 offset:20480
  ds_read_b64_tr_b16 a[178:179], v226 offset:20992
  v_mfma_f32_16x16x32_bf16 v[0:3], a[144:147], a[0:3], 0
  v_rcp_f32 v203, v203
  v_mfma_f32_16x16x32_bf16 v[0:3], a[148:151], a[8:11], v[0:3]
  ds_read_b64_tr_b16 a[180:181], v226 offset:36864
  v_mul_f32 v72, v72, v200
  v_mfma_f32_16x16x32_bf16 v[0:3], a[152:155], a[16:19], v[0:3]
  buffer_load_dwordx4 v218, s[12:15], s35 offen offset:2048 sc1 lds
  v_mfma_f32_16x16x32_bf16 v[0:3], a[156:159], a[24:27], v[0:3]
  ds_read_b64_tr_b16 a[182:183], v226 offset:37376
  ds_read_b64_tr_b16 a[184:185], v226 offset:40960
  v_mfma_f32_16x16x32_bf16 v[0:3], a[160:163], a[32:35], v[0:3]
  s_waitcnt lgkmcnt(7)
  ds_read_b64_tr_b16 a[186:187], v226 offset:41472
  v_mul_f32 v73, v73, v201
  v_mfma_f32_16x16x32_bf16 v[0:3], a[164:167], a[40:43], v[0:3]
  ds_read_b64_tr_b16 a[188:189], v226 offset:45056
  v_mul_f32 v74, v74, v202
  v_mfma_f32_16x16x32_bf16 v[4:7], a[144:147], a[4:7], 0
  ds_read_b64_tr_b16 a[190:191], v226 offset:45568
  v_mul_f32 v75, v75, v203
  v_mfma_f32_16x16x32_bf16 v[4:7], a[148:151], a[12:15], v[4:7]
  ds_read_b64_tr_b16 a[192:193], v227 offset:0
  v_cvt_pk_bf16_f32 v128, v72, v73
  v_mfma_f32_16x16x32_bf16 v[4:7], a[152:155], a[20:23], v[4:7]
  ds_read_b64_tr_b16 a[194:195], v227 offset:512
  v_cvt_pk_bf16_f32 v129, v74, v75
  v_mfma_f32_16x16x32_bf16 v[4:7], a[156:159], a[28:31], v[4:7]
  buffer_load_dwordx4 v219, s[12:15], s35 offen offset:3072 sc1 lds
  v_mfma_f32_16x16x32_bf16 v[4:7], a[160:163], a[36:39], v[4:7]
  s_add_u32 m0, s29, 126976
  ds_read_b64_tr_b16 a[196:197], v227 offset:4096
  ds_read_b64_tr_b16 a[198:199], v227 offset:4608
  v_mfma_f32_16x16x32_bf16 v[4:7], a[164:167], a[44:47], v[4:7]
  s_add_u32 s35, s31, 4718720
  ds_read_b64_tr_b16 a[200:201], v227 offset:8192
  v_fma_f32 v200, -v68, v68, s37
  v_mfma_f32_16x16x32_bf16 v[8:11], a[168:171], a[0:3], 0
  s_waitcnt lgkmcnt(7)
  ds_read_b64_tr_b16 a[202:203], v227 offset:8704
  v_fma_f32 v201, -v69, v69, s37
  v_mfma_f32_16x16x32_bf16 v[8:11], a[172:175], a[8:11], v[8:11]
  ds_read_b64_tr_b16 a[204:205], v227 offset:24576
  v_fma_f32 v202, -v70, v70, s37
  v_mfma_f32_16x16x32_bf16 v[8:11], a[176:179], a[16:19], v[8:11]
  ds_read_b64_tr_b16 a[206:207], v227 offset:25088
  v_fma_f32 v203, -v71, v71, s37
  v_mfma_f32_16x16x32_bf16 v[8:11], a[180:183], a[24:27], v[8:11]
  buffer_load_dwordx4 v216, s[12:15], s35 offen sc1 lds
  v_mfma_f32_16x16x32_bf16 v[8:11], a[184:187], a[32:35], v[8:11]
  s_waitcnt lgkmcnt(6)
  ds_read_b64_tr_b16 a[144:145], v227 offset:28672
  ds_read_b64_tr_b16 a[146:147], v227 offset:29184
  v_mfma_f32_16x16x32_bf16 v[8:11], a[188:191], a[40:43], v[8:11]
  ds_read_b64_tr_b16 a[148:149], v227 offset:32768
  v_mul_f32 v200, v68, v200
  v_mfma_f32_16x16x32_bf16 v[12:15], a[168:171], a[4:7], 0
  ds_read_b64_tr_b16 a[150:151], v227 offset:33280
  v_mul_f32 v201, v69, v201
  v_mfma_f32_16x16x32_bf16 v[12:15], a[172:175], a[12:15], v[12:15]
  ds_read_b64_tr_b16 a[152:153], v227 offset:12288
  v_mul_f32 v202, v70, v202
  v_mfma_f32_16x16x32_bf16 v[12:15], a[176:179], a[20:23], v[12:15]
  ds_read_b64_tr_b16 a[154:155], v227 offset:12800
  v_mul_f32 v203, v71, v203
  v_mfma_f32_16x16x32_bf16 v[12:15], a[180:183], a[28:31], v[12:15]
  ds_read_b64_tr_b16 a[156:157], v227 offset:16384
  ds_read_b64_tr_b16 a[158:159], v227 offset:16896
  v_mfma_f32_16x16x32_bf16 v[12:15], a[184:187], a[36:39], v[12:15]
  buffer_load_dwordx4 v217, s[12:15], s35 offen offset:1024 sc1 lds
  v_mfma_f32_16x16x32_bf16 v[12:15], a[188:191], a[44:47], v[12:15]
  ds_read_b64_tr_b16 a[160:161], v227 offset:20480
  ds_read_b64_tr_b16 a[162:163], v227 offset:20992
  v_mfma_f32_16x16x32_bf16 v[16:19], a[192:195], a[0:3], 0
  s_waitcnt lgkmcnt(8)
  ds_read_b64_tr_b16 a[164:165], v227 offset:36864
  ds_read_b64_tr_b16 a[166:167], v227 offset:37376
  v_mfma_f32_16x16x32_bf16 v[16:19], a[196:199], a[8:11], v[16:19]
  v_exp_f32 v200, v200
  v_mfma_f32_16x16x32_bf16 v[16:19], a[200:203], a[16:19], v[16:19]
  ds_read_b64_tr_b16 a[168:169], v227 offset:40960
  ds_read_b64_tr_b16 a[170:171], v227 offset:41472
  v_mfma_f32_16x16x32_bf16 v[16:19], a[204:207], a[24:27], v[16:19]
  v_exp_f32 v201, v201
  v_mfma_f32_16x16x32_bf16 v[16:19], a[144:147], a[32:35], v[16:19]
  s_waitcnt lgkmcnt(8)
  ds_read_b64_tr_b16 a[172:173], v227 offset:45056
  ds_read_b64_tr_b16 a[174:175], v227 offset:45568
  v_mfma_f32_16x16x32_bf16 v[16:19], a[148:151], a[40:43], v[16:19]
  v_exp_f32 v202, v202
  v_mfma_f32_16x16x32_bf16 v[20:23], a[192:195], a[4:7], 0
  ds_read_b64_tr_b16 a[176:177], v228 offset:0
  ds_read_b64_tr_b16 a[178:179], v228 offset:512
  v_mfma_f32_16x16x32_bf16 v[20:23], a[196:199], a[12:15], v[20:23]
  ds_read_b64_tr_b16 a[180:181], v228 offset:4096
  ds_read_b64_tr_b16 a[182:183], v228 offset:4608
  v_mfma_f32_16x16x32_bf16 v[20:23], a[200:203], a[20:23], v[20:23]
  v_exp_f32 v203, v203
  v_mfma_f32_16x16x32_bf16 v[20:23], a[204:207], a[28:31], v[20:23]
  ds_read_b64_tr_b16 a[184:185], v228 offset:8192
  v_mul_f32 v76, v68, v76
  v_mul_f32 v77, v69, v77
  v_mfma_f32_16x16x32_bf16 v[20:23], a[144:147], a[36:39], v[20:23]
  ds_read_b64_tr_b16 a[186:187], v228 offset:8704
  v_mul_f32 v78, v70, v78
  v_mfma_f32_16x16x32_bf16 v[20:23], a[148:151], a[44:47], v[20:23]
  ds_read_b64_tr_b16 a[188:189], v228 offset:24576
  v_mul_f32 v79, v71, v79
  v_mfma_f32_16x16x32_bf16 v[24:27], a[152:155], a[0:3], 0
  s_waitcnt lgkmcnt(7)
  ds_read_b64_tr_b16 a[190:191], v228 offset:25088
  v_add_f32 v200, 1.0, v200
  v_mfma_f32_16x16x32_bf16 v[24:27], a[156:159], a[8:11], v[24:27]
  ds_read_b64_tr_b16 a[192:193], v228 offset:28672
  v_add_f32 v201, 1.0, v201
  v_mfma_f32_16x16x32_bf16 v[24:27], a[160:163], a[16:19], v[24:27]
  ds_read_b64_tr_b16 a[194:195], v228 offset:29184
  v_add_f32 v202, 1.0, v202
  v_mfma_f32_16x16x32_bf16 v[24:27], a[164:167], a[24:27], v[24:27]
  ds_read_b64_tr_b16 a[196:197], v228 offset:32768
  v_add_f32 v203, 1.0, v203
  v_mfma_f32_16x16x32_bf16 v[24:27], a[168:171], a[32:35], v[24:27]
  ds_read_b64_tr_b16 a[198:199], v228 offset:33280
  ds_read_b64_tr_b16 a[200:201], v228 offset:12288
  v_mfma_f32_16x16x32_bf16 v[24:27], a[172:175], a[40:43], v[24:27]
  ds_read_b64_tr_b16 a[202:203], v228 offset:12800
  ds_read_b64_tr_b16 a[204:205], v228 offset:16384
  v_rcp_f32 v200, v200
  v_mfma_f32_16x16x32_bf16 v[28:31], a[152:155], a[4:7], 0
  v_rcp_f32 v201, v201
  v_mfma_f32_16x16x32_bf16 v[28:31], a[156:159], a[12:15], v[28:31]
  ds_read_b64_tr_b16 a[206:207], v228 offset:16896
  ds_read_b64_tr_b16 a[144:145], v228 offset:20480
  v_mfma_f32_16x16x32_bf16 v[28:31], a[160:163], a[20:23], v[28:31]
  v_rcp_f32 v202, v202
  v_mfma_f32_16x16x32_bf16 v[28:31], a[164:167], a[28:31], v[28:31]
  ds_read_b64_tr_b16 a[146:147], v228 offset:20992
  ds_read_b64_tr_b16 a[148:149], v228 offset:36864
  v_mfma_f32_16x16x32_bf16 v[28:31], a[168:171], a[36:39], v[28:31]
  v_rcp_f32 v203, v203
  v_mfma_f32_16x16x32_bf16 v[28:31], a[172:175], a[44:47], v[28:31]
  s_waitcnt lgkmcnt(9)
  ds_read_b64_tr_b16 a[150:151], v228 offset:37376
  v_mul_f32 v76, v76, v200
  v_mfma_f32_16x16x32_bf16 v[32:35], a[176:179], a[0:3], 0
  ds_read_b64_tr_b16 a[152:153], v228 offset:40960
  v_mul_f32 v77, v77, v201
  v_mfma_f32_16x16x32_bf16 v[32:35], a[180:183], a[8:11], v[32:35]
  ds_read_b64_tr_b16 a[154:155], v228 offset:41472
  v_mul_f32 v78, v78, v202
  v_mfma_f32_16x16x32_bf16 v[32:35], a[184:187], a[16:19], v[32:35]
  ds_read_b64_tr_b16 a[156:157], v228 offset:45056
  ds_read_b64_tr_b16 a[158:159], v228 offset:45568
  v_mul_f32 v79, v79, v203
  v_mfma_f32_16x16x32_bf16 v[32:35], a[188:191], a[24:27], v[32:35]
  ds_read_b64_tr_b16 a[160:161], v229 offset:0
  v_cvt_pk_bf16_f32 v132, v76, v77
  v_mfma_f32_16x16x32_bf16 v[32:35], a[192:195], a[32:35], v[32:35]
  s_waitcnt lgkmcnt(9)
  ds_read_b64_tr_b16 a[162:163], v229 offset:512
  v_cvt_pk_bf16_f32 v133, v78, v79
  v_mfma_f32_16x16x32_bf16 v[32:35], a[196:199], a[40:43], v[32:35]
  ds_read_b64_tr_b16 a[164:165], v229 offset:4096
  v_fma_f32 v200, -v80, v80, s37
  v_mfma_f32_16x16x32_bf16 v[36:39], a[176:179], a[4:7], 0
  ds_read_b64_tr_b16 a[166:167], v229 offset:4608
  v_fma_f32 v201, -v81, v81, s37
  v_mfma_f32_16x16x32_bf16 v[36:39], a[180:183], a[12:15], v[36:39]
  ds_read_b64_tr_b16 a[168:169], v229 offset:8192
  v_fma_f32 v202, -v82, v82, s37
  v_mfma_f32_16x16x32_bf16 v[36:39], a[184:187], a[20:23], v[36:39]
  ds_read_b64_tr_b16 a[170:171], v229 offset:8704
  v_fma_f32 v203, -v83, v83, s37
  v_mfma_f32_16x16x32_bf16 v[36:39], a[188:191], a[28:31], v[36:39]
  ds_read_b64_tr_b16 a[172:173], v229 offset:24576
  v_mul_f32 v200, v80, v200
  v_mfma_f32_16x16x32_bf16 v[36:39], a[192:195], a[36:39], v[36:39]
  ds_read_b64_tr_b16 a[174:175], v229 offset:25088
  v_mul_f32 v201, v81, v201
  v_mfma_f32_16x16x32_bf16 v[36:39], a[196:199], a[44:47], v[36:39]
  ds_read_b64_tr_b16 a[176:177], v229 offset:28672
  ds_read_b64_tr_b16 a[178:179], v229 offset:29184
  v_mul_f32 v202, v82, v202
  v_mfma_f32_16x16x32_bf16 v[40:43], a[200:203], a[0:3], 0
  ds_read_b64_tr_b16 a[180:181], v229 offset:32768
  v_mul_f32 v203, v83, v203
  v_mfma_f32_16x16x32_bf16 v[40:43], a[204:207], a[8:11], v[40:43]
  s_waitcnt lgkmcnt(9)
  ds_read_b64_tr_b16 a[182:183], v229 offset:33280
  ds_read_b64_tr_b16 a[184:185], v229 offset:12288
  v_mfma_f32_16x16x32_bf16 v[40:43], a[144:147], a[16:19], v[40:43]
  v_exp_f32 v200, v200
  v_mfma_f32_16x16x32_bf16 v[40:43], a[148:151], a[24:27], v[40:43]
  ds_read_b64_tr_b16 a[186:187], v229 offset:12800
  ds_read_b64_tr_b16 a[188:189], v229 offset:16384
  v_mfma_f32_16x16x32_bf16 v[40:43], a[152:155], a[32:35], v[40:43]
  v_exp_f32 v201, v201
  v_mfma_f32_16x16x32_bf16 v[40:43], a[156:159], a[40:43], v[40:43]
  ds_read_b64_tr_b16 a[190:191], v229 offset:16896
  ds_read_b64_tr_b16 a[192:193], v229 offset:20480
  v_mfma_f32_16x16x32_bf16 v[44:47], a[200:203], a[4:7], 0
  v_exp_f32 v202, v202
  v_mfma_f32_16x16x32_bf16 v[44:47], a[204:207], a[12:15], v[44:47]
  ds_read_b64_tr_b16 a[194:195], v229 offset:20992
  ds_read_b64_tr_b16 a[196:197], v229 offset:36864
  v_exp_f32 v203, v203
  v_mfma_f32_16x16x32_bf16 v[44:47], a[144:147], a[20:23], v[44:47]
  v_mul_f32 v88, v80, v88
  v_mul_f32 v89, v81, v89
  v_mfma_f32_16x16x32_bf16 v[44:47], a[148:151], a[28:31], v[44:47]
  ds_read_b64_tr_b16 a[198:199], v229 offset:37376
  v_mul_f32 v90, v82, v90
  v_mfma_f32_16x16x32_bf16 v[44:47], a[152:155], a[36:39], v[44:47]
  ds_read_b64_tr_b16 a[200:201], v229 offset:40960
  ds_read_b64_tr_b16 a[202:203], v229 offset:41472
  v_mfma_f32_16x16x32_bf16 v[44:47], a[156:159], a[44:47], v[44:47]
  ds_read_b64_tr_b16 a[204:205], v229 offset:45056
  v_mul_f32 v91, v83, v91
  v_mfma_f32_16x16x32_bf16 v[48:51], a[160:163], a[0:3], 0
  s_waitcnt lgkmcnt(9)
  ds_read_b64_tr_b16 a[206:207], v229 offset:45568
  v_add_f32 v200, 1.0, v200
  v_mfma_f32_16x16x32_bf16 v[48:51], a[164:167], a[8:11], v[48:51]
  v_add_f32 v201, 1.0, v201
  v_add_f32 v202, 1.0, v202
  v_mfma_f32_16x16x32_bf16 v[48:51], a[168:171], a[16:19], v[48:51]
  v_add_f32 v203, 1.0, v203
  v_mfma_f32_16x16x32_bf16 v[48:51], a[172:175], a[24:27], v[48:51]
  v_rcp_f32 v200, v200
  v_mfma_f32_16x16x32_bf16 v[48:51], a[176:179], a[32:35], v[48:51]
  v_rcp_f32 v201, v201
  v_mfma_f32_16x16x32_bf16 v[48:51], a[180:183], a[40:43], v[48:51]
  v_rcp_f32 v202, v202
  v_mfma_f32_16x16x32_bf16 v[52:55], a[160:163], a[4:7], 0
  v_rcp_f32 v203, v203
  v_mfma_f32_16x16x32_bf16 v[52:55], a[164:167], a[12:15], v[52:55]
L_st7:
  s_waitcnt vmcnt(13) lgkmcnt(0)
  s_barrier
  ds_read_b64_tr_b16 a[144:145], v230 offset:0
  v_mul_f32 v88, v88, v200
  v_mfma_f32_16x16x32_bf16 v[52:55], a[168:171], a[20:23], v[52:55]
  s_add_u32 m0, s29, 0
  ds_read_b64_tr_b16 a[146:147], v230 offset:512
  v_mul_f32 v89, v89, v201
  v_mfma_f32_16x16x32_bf16 v[52:55], a[172:175], a[28:31], v[52:55]
  s_add_u32 s35, s31, 256
  ds_read_b64_tr_b16 a[148:149], v230 offset:4096
  v_mul_f32 v90, v90, v202
  v_mfma_f32_16x16x32_bf16 v[52:55], a[176:179], a[36:39], v[52:55]
  ds_read_b64_tr_b16 a[150:151], v230 offset:4608
  v_mul_f32 v91, v91, v203
  v_mfma_f32_16x16x32_bf16 v[52:55], a[180:183], a[44:47], v[52:55]
  ds_read_b64_tr_b16 a[152:153], v230 offset:8192
  v_cvt_pk_bf16_f32 v130, v88, v89
  v_mfma_f32_16x16x32_bf16 v[56:59], a[184:187], a[0:3], 0
  ds_read_b64_tr_b16 a[154:155], v230 offset:8704
  v_cvt_pk_bf16_f32 v131, v90, v91
  v_mfma_f32_16x16x32_bf16 v[56:59], a[188:191], a[8:11], v[56:59]
  s_add_u32 s28, s76, 0
  ds_read_b64_tr_b16 a[156:157], v230 offset:24576
  ds_read_b64_tr_b16 a[158:159], v230 offset:25088
  v_mfma_f32_16x16x32_bf16 v[56:59], a[192:195], a[16:19], v[56:59]
  buffer_load_dwordx4 v216, s[12:15], s35 offen sc1 lds
  v_mfma_f32_16x16x32_bf16 v[56:59], a[196:199], a[24:27], v[56:59]
  ds_read_b64_tr_b16 a[160:161], v230 offset:28672
  ds_read_b64_tr_b16 a[162:163], v230 offset:29184
  v_mfma_f32_16x16x32_bf16 v[56:59], a[200:203], a[32:35], v[56:59]
  buffer_store_dwordx4 v[128:131], v225, s[56:59], s28 offen sc1
  v_mfma_f32_16x16x32_bf16 v[56:59], a[204:207], a[40:43], v[56:59]
  ds_read_b64_tr_b16 a[164:165], v230 offset:32768
  v_fma_f32 v200, -v84, v84, s37
  v_mfma_f32_16x16x32_bf16 v[60:63], a[184:187], a[4:7], 0
  ds_read_b64_tr_b16 a[166:167], v230 offset:33280
  ds_read_b64_tr_b16 a[168:169], v230 offset:12288
  v_mfma_f32_16x16x32_bf16 v[60:63], a[188:191], a[12:15], v[60:63]
  buffer_load_dwordx4 v217, s[12:15], s35 offen offset:1024 sc1 lds
  v_mfma_f32_16x16x32_bf16 v[60:63], a[192:195], a[20:23], v[60:63]
  ds_read_b64_tr_b16 a[170:171], v230 offset:12800
  ds_read_b64_tr_b16 a[172:173], v230 offset:16384
  v_fma_f32 v201, -v85, v85, s37
  v_mfma_f32_16x16x32_bf16 v[60:63], a[196:199], a[28:31], v[60:63]
  ds_read_b64_tr_b16 a[174:175], v230 offset:16896
  v_fma_f32 v202, -v86, v86, s37
  v_mfma_f32_16x16x32_bf16 v[60:63], a[200:203], a[36:39], v[60:63]
  ds_read_b64_tr_b16 a[176:177], v230 offset:20480
  v_fma_f32 v203, -v87, v87, s37
  v_mfma_f32_16x16x32_bf16 v[60:63], a[204:207], a[44:47], v[60:63]
  s_waitcnt lgkmcnt(7)
  ds_read_b64_tr_b16 a[178:179], v230 offset:20992
  v_mul_f32 v200, v84, v200
  v_mfma_f32_16x16x32_bf16 v[0:3], a[144:147], a[48:51], v[0:3]
  ds_read_b64_tr_b16 a[180:181], v230 offset:36864
  v_mul_f32 v201, v85, v201
  v_mfma_f32_16x16x32_bf16 v[0:3], a[148:151], a[56:59], v[0:3]
  ds_read_b64_tr_b16 a[182:183], v230 offset:37376
  v_mul_f32 v202, v86, v202
  v_mfma_f32_16x16x32_bf16 v[0:3], a[152:155], a[64:67], v[0:3]
  buffer_load_dwordx4 v218, s[12:15], s35 offen offset:2048 sc1 lds
  v_mul_f32 v203, v87, v203
  v_mfma_f32_16x16x32_bf16 v[0:3], a[156:159], a[72:75], v[0:3]
  ds_read_b64_tr_b16 a[184:185], v230 offset:40960
  ds_read_b64_tr_b16 a[186:187], v230 offset:41472
  v_mfma_f32_16x16x32_bf16 v[0:3], a[160:163], a[80:83], v[0:3]
  s_waitcnt lgkmcnt(8)
  ds_read_b64_tr_b16 a[188:189], v230 offset:45056
  ds_read_b64_tr_b16 a[190:191], v230 offset:45568
  v_exp_f32 v200, v200
  v_mfma_f32_16x16x32_bf16 v[0:3], a[164:167], a[88:91], v[0:3]
  v_exp_f32 v201, v201
  v_mfma_f32_16x16x32_bf16 v[4:7], a[144:147], a[52:55], v[4:7]
  ds_read_b64_tr_b16 a[192:193], v231 offset:0
  ds_read_b64_tr_b16 a[194:195], v231 offset:512
  v_mfma_f32_16x16x32_bf16 v[4:7], a[148:151], a[60:63], v[4:7]
  v_exp_f32 v202, v202
  v_mfma_f32_16x16x32_bf16 v[4:7], a[152:155], a[68:71], v[4:7]
  ds_read_b64_tr_b16 a[196:197], v231 offset:4096
  ds_read_b64_tr_b16 a[198:199], v231 offset:4608
  v_mfma_f32_16x16x32_bf16 v[4:7], a[156:159], a[76:79], v[4:7]
  buffer_load_dwordx4 v219, s[12:15], s35 offen offset:3072 sc1 lds
  v_exp_f32 v203, v203
  v_mfma_f32_16x16x32_bf16 v[4:7], a[160:163], a[84:87], v[4:7]
  s_add_u32 m0, s29, 4096
  ds_read_b64_tr_b16 a[200:201], v231 offset:8192
  v_mul_f32 v92, v84, v92
  v_mfma_f32_16x16x32_bf16 v[4:7], a[164:167], a[92:95], v[4:7]
  s_add_u32 s35, s31, 295168
  ds_read_b64_tr_b16 a[202:203], v231 offset:8704
  ds_read_b64_tr_b16 a[204:205], v231 offset:24576
  v_mul_f32 v93, v85, v93
  v_mfma_f32_16x16x32_bf16 v[8:11], a[168:171], a[48:51], v[8:11]
  s_waitcnt lgkmcnt(7)
  ds_read_b64_tr_b16 a[206:207], v231 offset:25088
  v_mul_f32 v94, v86, v94
  v_mfma_f32_16x16x32_bf16 v[8:11], a[172:175], a[56:59], v[8:11]
  ds_read_b64_tr_b16 a[144:145], v231 offset:28672
  v_mul_f32 v95, v87, v95
  v_mfma_f32_16x16x32_bf16 v[8:11], a[176:179], a[64:67], v[8:11]
  ds_read_b64_tr_b16 a[146:147], v231 offset:29184
  v_add_f32 v200, 1.0, v200
  v_mfma_f32_16x16x32_bf16 v[8:11], a[180:183], a[72:75], v[8:11]
  buffer_load_dwordx4 v216, s[12:15], s35 offen sc1 lds
  v_add_f32 v201, 1.0, v201
  v_mfma_f32_16x16x32_bf16 v[8:11], a[184:187], a[80:83], v[8:11]
  ds_read_b64_tr_b16 a[148:149], v231 offset:32768
  ds_read_b64_tr_b16 a[150:151], v231 offset:33280
  v_add_f32 v202, 1.0, v202
  v_mfma_f32_16x16x32_bf16 v[8:11], a[188:191], a[88:91], v[8:11]
  ds_read_b64_tr_b16 a[152:153], v231 offset:12288
  v_add_f32 v203, 1.0, v203
  v_mfma_f32_16x16x32_bf16 v[12:15], a[168:171], a[52:55], v[12:15]
  ds_read_b64_tr_b16 a[154:155], v231 offset:12800
  ds_read_b64_tr_b16 a[156:157], v231 offset:16384
  v_mfma_f32_16x16x32_bf16 v[12:15], a[172:175], a[60:63], v[12:15]
  v_rcp_f32 v200, v200
  v_mfma_f32_16x16x32_bf16 v[12:15], a[176:179], a[68:71], v[12:15]
  ds_read_b64_tr_b16 a[158:159], v231 offset:16896
  ds_read_b64_tr_b16 a[160:161], v231 offset:20480
  v_mfma_f32_16x16x32_bf16 v[12:15], a[180:183], a[76:79], v[12:15]
  v_rcp_f32 v201, v201
  v_mfma_f32_16x16x32_bf16 v[12:15], a[184:187], a[84:87], v[12:15]
  buffer_load_dwordx4 v217, s[12:15], s35 offen offset:1024 sc1 lds
  v_mfma_f32_16x16x32_bf16 v[12:15], a[188:191], a[92:95], v[12:15]
  s_waitcnt lgkmcnt(7)
  ds_read_b64_tr_b16 a[162:163], v231 offset:20992
  ds_read_b64_tr_b16 a[164:165], v231 offset:36864
  v_rcp_f32 v202, v202
  v_mfma_f32_16x16x32_bf16 v[16:19], a[192:195], a[48:51], v[16:19]
  s_add_u32 m0, s29, 24576
  ds_read_b64_tr_b16 a[166:167], v231 offset:37376
  ds_read_b64_tr_b16 a[168:169], v231 offset:40960
  v_rcp_f32 v203, v203
  v_mfma_f32_16x16x32_bf16 v[16:19], a[196:199], a[56:59], v[16:19]
  s_add_u32 s35, s31, 884992
  v_mul_f32 v92, v92, v200
  v_mul_f32 v93, v93, v201
  v_mfma_f32_16x16x32_bf16 v[16:19], a[200:203], a[64:67], v[16:19]
  ds_read_b64_tr_b16 a[170:171], v231 offset:41472
  v_mul_f32 v94, v94, v202
  v_mfma_f32_16x16x32_bf16 v[16:19], a[204:207], a[72:75], v[16:19]
  ds_read_b64_tr_b16 a[172:173], v231 offset:45056
  v_mul_f32 v95, v95, v203
  v_mfma_f32_16x16x32_bf16 v[16:19], a[144:147], a[80:83], v[16:19]
  s_waitcnt lgkmcnt(7)
  ds_read_b64_tr_b16 a[174:175], v231 offset:45568
  v_cvt_pk_bf16_f32 v134, v92, v93
  v_mfma_f32_16x16x32_bf16 v[16:19], a[148:151], a[88:91], v[16:19]
  buffer_load_dwordx4 v216, s[12:15], s35 offen sc1 lds
  v_mfma_f32_16x16x32_bf16 v[20:23], a[192:195], a[52:55], v[20:23]
  ds_read_b64_tr_b16 a[176:177], v232 offset:0
  ds_read_b64_tr_b16 a[178:179], v232 offset:512
  v_cvt_pk_bf16_f32 v135, v94, v95
  v_mfma_f32_16x16x32_bf16 v[20:23], a[196:199], a[60:63], v[20:23]
  ds_read_b64_tr_b16 a[180:181], v232 offset:4096
  ds_read_b64_tr_b16 a[182:183], v232 offset:4608
  v_mfma_f32_16x16x32_bf16 v[20:23], a[200:203], a[68:71], v[20:23]
  buffer_store_dwordx4 v[132:135], v225, s[56:59], s28 offen offset:1024 sc1
  v_mfma_f32_16x16x32_bf16 v[20:23], a[204:207], a[76:79], v[20:23]
  ds_read_b64_tr_b16 a[184:185], v232 offset:8192
  v_fma_f32 v200, -v96, v96, s37
  v_mfma_f32_16x16x32_bf16 v[20:23], a[144:147], a[84:87], v[20:23]
  ds_read_b64_tr_b16 a[186:187], v232 offset:8704
  v_fma_f32 v201, -v97, v97, s37
  v_mfma_f32_16x16x32_bf16 v[20:23], a[148:151], a[92:95], v[20:23]
  buffer_load_dwordx4 v217, s[12:15], s35 offen offset:1024 sc1 lds
  v_fma_f32 v202, -v98, v98, s37
  v_mfma_f32_16x16x32_bf16 v[24:27], a[152:155], a[48:51], v[24:27]
  ds_read_b64_tr_b16 a[188:189], v232 offset:24576
  ds_read_b64_tr_b16 a[190:191], v232 offset:25088
  v_fma_f32 v203, -v99, v99, s37
  v_mfma_f32_16x16x32_bf16 v[24:27], a[156:159], a[56:59], v[24:27]
  s_waitcnt lgkmcnt(8)
  ds_read_b64_tr_b16 a[192:193], v232 offset:28672
  v_mul_f32 v200, v96, v200
  v_mfma_f32_16x16x32_bf16 v[24:27], a[160:163], a[64:67], v[24:27]
  ds_read_b64_tr_b16 a[194:195], v232 offset:29184
  v_mul_f32 v201, v97, v201
  v_mfma_f32_16x16x32_bf16 v[24:27], a[164:167], a[72:75], v[24:27]
  ds_read_b64_tr_b16 a[196:197], v232 offset:32768
  v_mul_f32 v202, v98, v202
  v_mfma_f32_16x16x32_bf16 v[24:27], a[168:171], a[80:83], v[24:27]
  ds_read_b64_tr_b16 a[198:199], v232 offset:33280
  v_mul_f32 v203, v99, v203
  v_mfma_f32_16x16x32_bf16 v[24:27], a[172:175], a[88:91], v[24:27]
  ds_read_b64_tr_b16 a[200:201], v232 offset:12288
  ds_read_b64_tr_b16 a[202:203], v232 offset:12800
  v_exp_f32 v200, v200
  v_mfma_f32_16x16x32_bf16 v[28:31], a[152:155], a[52:55], v[28:31]
  buffer_load_dwordx4 v218, s[12:15], s35 offen offset:2048 sc1 lds
  v_mfma_f32_16x16x32_bf16 v[28:31], a[156:159], a[60:63], v[28:31]
  ds_read_b64_tr_b16 a[204:205], v232 offset:16384
  ds_read_b64_tr_b16 a[206:207], v232 offset:16896
  v_exp_f32 v201, v201
  v_mfma_f32_16x16x32_bf16 v[28:31], a[160:163], a[68:71], v[28:31]
  ds_read_b64_tr_b16 a[144:145], v232 offset:20480
  ds_read_b64_tr_b16 a[146:147], v232 offset:20992
  v_mfma_f32_16x16x32_bf16 v[28:31], a[164:167], a[76:79], v[28:31]
  v_exp_f32 v202, v202
  v_mfma_f32_16x16x32_bf16 v[28:31], a[168:171], a[84:87], v[28:31]
  ds_read_b64_tr_b16 a[148:149], v232 offset:36864
  ds_read_b64_tr_b16 a[150:151], v232 offset:37376
  v_mfma_f32_16x16x32_bf16 v[28:31], a[172:175], a[92:95], v[28:31]
  s_waitcnt lgkmcnt(10)
  v_exp_f32 v203, v203
  v_mfma_f32_16x16x32_bf16 v[32:35], a[176:179], a[48:51], v[32:35]
  ds_read_b64_tr_b16 a[152:153], v232 offset:40960
  v_mul_f32 v104, v96, v104
  v_mfma_f32_16x16x32_bf16 v[32:35], a[180:183], a[56:59], v[32:35]
  buffer_load_dwordx4 v219, s[12:15], s35 offen offset:3072 sc1 lds
  v_mul_f32 v105, v97, v105
  v_mfma_f32_16x16x32_bf16 v[32:35], a[184:187], a[64:67], v[32:35]
  s_add_u32 m0, s29, 28672
  ds_read_b64_tr_b16 a[154:155], v232 offset:41472
  ds_read_b64_tr_b16 a[156:157], v232 offset:45056
  v_mul_f32 v106, v98, v106
  v_mfma_f32_16x16x32_bf16 v[32:35], a[188:191], a[72:75], v[32:35]
  s_add_u32 s35, s31, 1179904
  ds_read_b64_tr_b16 a[158:159], v232 offset:45568
  v_mul_f32 v107, v99, v107
  v_mfma_f32_16x16x32_bf16 v[32:35], a[192:195], a[80:83], v[32:35]
  s_waitcnt lgkmcnt(6)
  ds_read_b64_tr_b16 a[160:161], v233 offset:0
  v_add_f32 v200, 1.0, v200
  v_mfma_f32_16x16x32_bf16 v[32:35], a[196:199], a[88:91], v[32:35]
  ds_read_b64_tr_b16 a[162:163], v233 offset:512
  v_add_f32 v201, 1.0, v201
  v_mfma_f32_16x16x32_bf16 v[36:39], a[176:179], a[52:55], v[36:39]
  ds_read_b64_tr_b16 a[164:165], v233 offset:4096
  ds_read_b64_tr_b16 a[166:167], v233 offset:4608
  v_add_f32 v202, 1.0, v202
  v_mfma_f32_16x16x32_bf16 v[36:39], a[180:183], a[60:63], v[36:39]
  buffer_load_dwordx4 v216, s[12:15], s35 offen sc1 lds
  v_add_f32 v203, 1.0, v203
  v_mfma_f32_16x16x32_bf16 v[36:39], a[184:187], a[68:71], v[36:39]
  ds_read_b64_tr_b16 a[168:169], v233 offset:8192
  ds_read_b64_tr_b16 a[170:171], v233 offset:8704
  v_rcp_f32 v200, v200
  v_mfma_f32_16x16x32_bf16 v[36:39], a[188:191], a[76:79], v[36:39]
  ds_read_b64_tr_b16 a[172:173], v233 offset:24576
  ds_read_b64_tr_b16 a[174:175], v233 offset:25088
  v_mfma_f32_16x16x32_bf16 v[36:39], a[192:195], a[84:87], v[36:39]
  v_rcp_f32 v201, v201
  v_mfma_f32_16x16x32_bf16 v[36:39], a[196:199], a[92:95], v[36:39]
  ds_read_b64_tr_b16 a[176:177], v233 offset:28672
  ds_read_b64_tr_b16 a[178:179], v233 offset:29184
  v_mfma_f32_16x16x32_bf16 v[40:43], a[200:203], a[48:51], v[40:43]
  v_rcp_f32 v202, v202
  v_mfma_f32_16x16x32_bf16 v[40:43], a[204:207], a[56:59], v[40:43]
  ds_read_b64_tr_b16 a[180:181], v233 offset:32768
  ds_read_b64_tr_b16 a[182:183], v233 offset:33280
  v_mfma_f32_16x16x32_bf16 v[40:43], a[144:147], a[64:67], v[40:43]
  s_waitcnt lgkmcnt(8)
  ds_read_b64_tr_b16 a[184:185], v233 offset:12288
  ds_read_b64_tr_b16 a[186:187], v233 offset:12800
  v_rcp_f32 v203, v203
  v_mfma_f32_16x16x32_bf16 v[40:43], a[148:151], a[72:75], v[40:43]
  buffer_load_dwordx4 v217, s[12:15], s35 offen offset:1024 sc1 lds
  v_mul_f32 v104, v104, v200
  v_mfma_f32_16x16x32_bf16 v[40:43], a[152:155], a[80:83], v[40:43]
  ds_read_b64_tr_b16 a[188:189], v233 offset:16384
  v_mul_f32 v105, v105, v201
  v_mfma_f32_16x16x32_bf16 v[40:43], a[156:159], a[88:91], v[40:43]
  ds_read_b64_tr_b16 a[190:191], v233 offset:16896
  v_mul_f32 v106, v106, v202
  v_mfma_f32_16x16x32_bf16 v[44:47], a[200:203], a[52:55], v[44:47]
  ds_read_b64_tr_b16 a[192:193], v233 offset:20480
  v_mul_f32 v107, v107, v203
  v_mfma_f32_16x16x32_bf16 v[44:47], a[204:207], a[60:63], v[44:47]
  ds_read_b64_tr_b16 a[194:195], v233 offset:20992
  v_cvt_pk_bf16_f32 v136, v104, v105
  v_mfma_f32_16x16x32_bf16 v[44:47], a[144:147], a[68:71], v[44:47]
  ds_read_b64_tr_b16 a[196:197], v233 offset:36864
  v_cvt_pk_bf16_f32 v137, v106, v107
  v_mfma_f32_16x16x32_bf16 v[44:47], a[148:151], a[76:79], v[44:47]
  ds_read_b64_tr_b16 a[198:199], v233 offset:37376
  ds_read_b64_tr_b16 a[200:201], v233 offset:40960
  v_fma_f32 v200, -v100, v100, s37
  v_mfma_f32_16x16x32_bf16 v[44:47], a[152:155], a[84:87], v[44:47]
  ds_read_b64_tr_b16 a[202:203], v233 offset:41472
  v_fma_f32 v201, -v101, v101, s37
  v_mfma_f32_16x16x32_bf16 v[44:47], a[156:159], a[92:95], v[44:47]
  ds_read_b64_tr_b16 a[204:205], v233 offset:45056
  v_fma_f32 v202, -v102, v102, s37
  v_mfma_f32_16x16x32_bf16 v[48:51], a[160:163], a[48:51], v[48:51]
  ds_read_b64_tr_b16 a[206:207], v233 offset:45568
  v_fma_f32 v203, -v103, v103, s37
  v_mul_f32 v200, v100, v200
  v_mfma_f32_16x16x32_bf16 v[48:51], a[164:167], a[56:59], v[48:51]
  s_waitcnt lgkmcnt(8)
  v_mul_f32 v201, v101, v201
  v_mul_f32 v202, v102, v202
  v_mfma_f32_16x16x32_bf16 v[48:51], a[168:171], a[64:67], v[48:51]
  v_mul_f32 v203, v103, v203
  v_mfma_f32_16x16x32_bf16 v[48:51], a[172:175], a[72:75], v[48:51]
  v_exp_f32 v200, v200
  v_mfma_f32_16x16x32_bf16 v[48:51], a[176:179], a[80:83], v[48:51]
  v_exp_f32 v201, v201
  v_mfma_f32_16x16x32_bf16 v[48:51], a[180:183], a[88:91], v[48:51]
  v_exp_f32 v202, v202
  v_mfma_f32_16x16x32_bf16 v[52:55], a[160:163], a[52:55], v[52:55]
  v_exp_f32 v203, v203
  v_mfma_f32_16x16x32_bf16 v[52:55], a[164:167], a[60:63], v[52:55]
L_st9:
  s_waitcnt vmcnt(14) lgkmcnt(0)
  s_barrier
  ds_read_b64_tr_b16 a[144:145], v234 offset:0
  v_mul_f32 v108, v100, v108
  v_mfma_f32_16x16x32_bf16 v[52:55], a[168:171], a[68:71], v[52:55]
  s_add_u32 m0, s29, 49152
  ds_read_b64_tr_b16 a[146:147], v234 offset:512
  v_mul_f32 v109, v101, v109
  v_mfma_f32_16x16x32_bf16 v[52:55], a[172:175], a[76:79], v[52:55]
  s_add_u32 s35, s31, 1769728
  ds_read_b64_tr_b16 a[148:149], v234 offset:4096
  v_mul_f32 v110, v102, v110
  v_mfma_f32_16x16x32_bf16 v[52:55], a[176:179], a[84:87], v[52:55]
  ds_read_b64_tr_b16 a[150:151], v234 offset:4608
  v_mul_f32 v111, v103, v111
  v_mfma_f32_16x16x32_bf16 v[52:55], a[180:183], a[92:95], v[52:55]
  ds_read_b64_tr_b16 a[152:153], v234 offset:8192
  v_add_f32 v200, 1.0, v200
  v_mfma_f32_16x16x32_bf16 v[56:59], a[184:187], a[48:51], v[56:59]
  buffer_load_dwordx4 v216, s[12:15], s35 offen sc1 lds
  v_mfma_f32_16x16x32_bf16 v[56:59], a[188:191], a[56:59], v[56:59]
  ds_read_b64_tr_b16 a[154:155], v234 offset:8704
  ds_read_b64_tr_b16 a[156:157], v234 offset:24576
  v_mfma_f32_16x16x32_bf16 v[56:59], a[192:195], a[64:67], v[56:59]
  ds_read_b64_tr_b16 a[158:159], v234 offset:25088
  v_add_f32 v201, 1.0, v201
  v_mfma_f32_16x16x32_bf16 v[56:59], a[196:199], a[72:75], v[56:59]
  ds_read_b64_tr_b16 a[160:161], v234 offset:28672
  v_add_f32 v202, 1.0, v202
  v_mfma_f32_16x16x32_bf16 v[56:59], a[200:203], a[80:83], v[56:59]
  ds_read_b64_tr_b16 a[162:163], v234 offset:29184
  v_add_f32 v203, 1.0, v203
  v_mfma_f32_16x16x32_bf16 v[56:59], a[204:207], a[88:91], v[56:59]
  ds_read_b64_tr_b16 a[164:165], v234 offset:32768
  ds_read_b64_tr_b16 a[166:167], v234 offset:33280
  v_mfma_f32_16x16x32_bf16 v[60:63], a[184:187], a[52:55], v[60:63]
  buffer_load_dwordx4 v217, s[12:15], s35 offen offset:1024 sc1 lds
  v_mfma_f32_16x16x32_bf16 v[60:63], a[188:191], a[60:63], v[60:63]
  ds_read_b64_tr_b16 a[168:169], v234 offset:12288
  ds_read_b64_tr_b16 a[170:171], v234 offset:12800
  v_mfma_f32_16x16x32_bf16 v[60:63], a[192:195], a[68:71], v[60:63]
  v_rcp_f32 v200, v200
  v_mfma_f32_16x16x32_bf16 v[60:63], a[196:199], a[76:79], v[60:63]
  ds_read_b64_tr_b16 a[172:173], v234 offset:16384
  ds_read_b64_tr_b16 a[174:175], v234 offset:16896
  v_mfma_f32_16x16x32_bf16 v[60:63], a[200:203], a[84:87], v[60:63]
  ds_read_b64_tr_b16 a[176:177], v234 offset:20480
  ds_read_b64_tr_b16 a[178:179], v234 offset:20992
  v_mfma_f32_16x16x32_bf16 v[60:63], a[204:207], a[92:95], v[60:63]
  s_waitcnt lgkmcnt(10)
  v_rcp_f32 v201, v201
  v_mfma_f32_16x16x32_bf16 v[0:3], a[144:147], a[96:99], v[0:3]
  ds_read_b64_tr_b16 a[180:181], v234 offset:36864
  ds_read_b64_tr_b16 a[182:183], v234 offset:37376
  v_mfma_f32_16x16x32_bf16 v[0:3], a[148:151], a[104:107], v[0:3]
  buffer_load_dwordx4 v218, s[12:15], s35 offen offset:2048 sc1 lds
  v_rcp_f32 v202, v202
  v_mfma_f32_16x16x32_bf16 v[0:3], a[152:155], a[112:115], v[0:3]
  ds_read_b64_tr_b16 a[184:185], v234 offset:40960
  ds_read_b64_tr_b16 a[186:187], v234 offset:41472
  v_rcp_f32 v203, v203
  v_mfma_f32_16x16x32_bf16 v[0:3], a[156:159], a[120:123], v[0:3]
  s_waitcnt lgkmcnt(8)
  v_mul_f32 v108, v108, v200
  v_mul_f32 v109, v109, v201
  v_mfma_f32_16x16x32_bf16 v[0:3], a[160:163], a[128:131], v[0:3]
  ds_read_b64_tr_b16 a[188:189], v234 offset:45056
  v_mul_f32 v110, v110, v202
  v_mfma_f32_16x16x32_bf16 v[64:67], a[164:167], a[136:139], v[0:3]
  ds_read_b64_tr_b16 a[190:191], v234 offset:45568
  v_mul_f32 v111, v111, v203
  v_mfma_f32_16x16x32_bf16 v[4:7], a[144:147], a[100:103], v[4:7]
  ds_read_b64_tr_b16 a[192:193], v235 offset:0
  v_cvt_pk_bf16_f32 v140, v108, v109
  v_mfma_f32_16x16x32_bf16 v[4:7], a[148:151], a[108:111], v[4:7]
  ds_read_b64_tr_b16 a[194:195], v235 offset:512
  v_cvt_pk_bf16_f32 v141, v110, v111
  v_mfma_f32_16x16x32_bf16 v[4:7], a[152:155], a[116:119], v[4:7]
  buffer_load_dwordx4 v219, s[12:15], s35 offen offset:3072 sc1 lds
  v_mfma_f32_16x16x32_bf16 v[4:7], a[156:159], a[124:127], v[4:7]
  s_add_u32 m0, s29, 53248
  ds_read_b64_tr_b16 a[196:197], v235 offset:4096
  ds_read_b64_tr_b16 a[198:199], v235 offset:4608
  v_fma_f32 v200, -v112, v112, s37
  v_mfma_f32_16x16x32_bf16 v[4:7], a[160:163], a[132:135], v[4:7]
  s_add_u32 s35, s31, 2064640
  ds_read_b64_tr_b16 a[200:201], v235 offset:8192
  v_fma_f32 v201, -v113, v113, s37
  v_mfma_f32_16x16x32_bf16 v[68:71], a[164:167], a[140:143], v[4:7]
  ds_read_b64_tr_b16 a[202:203], v235 offset:8704
  v_fma_f32 v202, -v114, v114, s37
  v_mfma_f32_16x16x32_bf16 v[8:11], a[168:171], a[96:99], v[8:11]
  s_waitcnt lgkmcnt(8)
  ds_read_b64_tr_b16 a[204:205], v235 offset:24576
  v_fma_f32 v203, -v115, v115, s37
  v_mfma_f32_16x16x32_bf16 v[8:11], a[172:175], a[104:107], v[8:11]
  ds_read_b64_tr_b16 a[206:207], v235 offset:25088
  v_mul_f32 v200, v112, v200
  v_mfma_f32_16x16x32_bf16 v[8:11], a[176:179], a[112:115], v[8:11]
  buffer_load_dwordx4 v216, s[12:15], s35 offen sc1 lds
  v_mul_f32 v201, v113, v201
  v_mfma_f32_16x16x32_bf16 v[8:11], a[180:183], a[120:123], v[8:11]
  ds_read_b64_tr_b16 a[144:145], v235 offset:28672
  ds_read_b64_tr_b16 a[146:147], v235 offset:29184
  v_mul_f32 v202, v114, v202
  v_mfma_f32_16x16x32_bf16 v[8:11], a[184:187], a[128:131], v[8:11]
  s_waitcnt lgkmcnt(8)
  ds_read_b64_tr_b16 a[148:149], v235 offset:32768
  v_mul_f32 v203, v115, v203
  v_mfma_f32_16x16x32_bf16 v[72:75], a[188:191], a[136:139], v[8:11]
  ds_read_b64_tr_b16 a[150:151], v235 offset:33280
  ds_read_b64_tr_b16 a[152:153], v235 offset:12288
  v_exp_f32 v200, v200
  v_mfma_f32_16x16x32_bf16 v[12:15], a[168:171], a[100:103], v[12:15]
  v_exp_f32 v201, v201
  v_mfma_f32_16x16x32_bf16 v[12:15], a[172:175], a[108:111], v[12:15]
  ds_read_b64_tr_b16 a[154:155], v235 offset:12800
  ds_read_b64_tr_b16 a[156:157], v235 offset:16384
  v_mfma_f32_16x16x32_bf16 v[12:15], a[176:179], a[116:119], v[12:15]
  v_exp_f32 v202, v202
  v_mfma_f32_16x16x32_bf16 v[12:15], a[180:183], a[124:127], v[12:15]
  buffer_load_dwordx4 v217, s[12:15], s35 offen offset:1024 sc1 lds
  v_mfma_f32_16x16x32_bf16 v[12:15], a[184:187], a[132:135], v[12:15]
  s_add_u32 m0, s29, 73728
  ds_read_b64_tr_b16 a[158:159], v235 offset:16896
  ds_read_b64_tr_b16 a[160:161], v235 offset:20480
  v_mfma_f32_16x16x32_bf16 v[76:79], a[188:191], a[140:143], v[12:15]
  s_add_u32 s35, s31, 2654464
  ds_read_b64_tr_b16 a[162:163], v235 offset:20992
  ds_read_b64_tr_b16 a[164:165], v235 offset:36864
  v_exp_f32 v203, v203
  v_mfma_f32_16x16x32_bf16 v[16:19], a[192:195], a[96:99], v[16:19]
  s_waitcnt lgkmcnt(9)
  v_mul_f32 v120, v112, v120
  v_mul_f32 v121, v113, v121
  v_mfma_f32_16x16x32_bf16 v[16:19], a[196:199], a[104:107], v[16:19]
  ds_read_b64_tr_b16 a[166:167], v235 offset:37376
  v_mul_f32 v122, v114, v122
  v_mfma_f32_16x16x32_bf16 v[16:19], a[200:203], a[112:115], v[16:19]
  ds_read_b64_tr_b16 a[168:169], v235 offset:40960
  v_mul_f32 v123, v115, v123
  v_mfma_f32_16x16x32_bf16 v[16:19], a[204:207], a[120:123], v[16:19]
  ds_read_b64_tr_b16 a[170:171], v235 offset:41472
  ds_read_b64_tr_b16 a[172:173], v235 offset:45056
  v_mfma_f32_16x16x32_bf16 v[16:19], a[144:147], a[128:131], v[16:19]
  s_waitcnt lgkmcnt(9)
  ds_read_b64_tr_b16 a[174:175], v235 offset:45568
  ds_read_b64_tr_b16 a[176:177], v236 offset:0
  v_add_f32 v200, 1.0, v200
  v_mfma_f32_16x16x32_bf16 v[80:83], a[148:151], a[136:139], v[16:19]
  buffer_load_dwordx4 v216, s[12:15], s35 offen sc1 lds
  v_add_f32 v201, 1.0, v201
  v_mfma_f32_16x16x32_bf16 v[20:23], a[192:195], a[100:103], v[20:23]
  ds_read_b64_tr_b16 a[178:179], v236 offset:512
  v_add_f32 v202, 1.0, v202
  v_mfma_f32_16x16x32_bf16 v[20:23], a[196:199], a[108:111], v[20:23]
  ds_read_b64_tr_b16 a[180:181], v236 offset:4096
  v_add_f32 v203, 1.0, v203
  v_mfma_f32_16x16x32_bf16 v[20:23], a[200:203], a[116:119], v[20:23]
  ds_read_b64_tr_b16 a[182:183], v236 offset:4608
  ds_read_b64_tr_b16 a[184:185], v236 offset:8192
  v_rcp_f32 v200, v200
  v_mfma_f32_16x16x32_bf16 v[20:23], a[204:207], a[124:127], v[20:23]
  v_rcp_f32 v201, v201
  v_mfma_f32_16x16x32_bf16 v[20:23], a[144:147], a[132:135], v[20:23]
  buffer_load_dwordx4 v217, s[12:15], s35 offen offset:1024 sc1 lds
  v_mfma_f32_16x16x32_bf16 v[84:87], a[148:151], a[140:143], v[20:23]
  ds_read_b64_tr_b16 a[186:187], v236 offset:8704
  ds_read_b64_tr_b16 a[188:189], v236 offset:24576
  v_mfma_f32_16x16x32_bf16 v[24:27], a[152:155], a[96:99], v[24:27]
  s_waitcnt lgkmcnt(7)
  ds_read_b64_tr_b16 a[190:191], v236 offset:25088
  ds_read_b64_tr_b16 a[192:193], v236 offset:28672
  v_rcp_f32 v202, v202
  v_mfma_f32_16x16x32_bf16 v[24:27], a[156:159], a[104:107], v[24:27]
  v_rcp_f32 v203, v203
  v_mfma_f32_16x16x32_bf16 v[24:27], a[160:163], a[112:115], v[24:27]
  ds_read_b64_tr_b16 a[194:195], v236 offset:29184
  v_mul_f32 v120, v120, v200
  v_mfma_f32_16x16x32_bf16 v[24:27], a[164:167], a[120:123], v[24:27]
  ds_read_b64_tr_b16 a[196:197], v236 offset:32768
  v_mul_f32 v121, v121, v201
  v_mfma_f32_16x16x32_bf16 v[24:27], a[168:171], a[128:131], v[24:27]
  ds_read_b64_tr_b16 a[198:199], v236 offset:33280
  ds_read_b64_tr_b16 a[200:201], v236 offset:12288
  v_mfma_f32_16x16x32_bf16 v[88:91], a[172:175], a[136:139], v[24:27]
  buffer_load_dwordx4 v218, s[12:15], s35 offen offset:2048 sc1 lds
  v_mul_f32 v122, v122, v202
  v_mfma_f32_16x16x32_bf16 v[28:31], a[152:155], a[100:103], v[28:31]
  ds_read_b64_tr_b16 a[202:203], v236 offset:12800
  ds_read_b64_tr_b16 a[204:205], v236 offset:16384
  v_mul_f32 v123, v123, v203
  v_mfma_f32_16x16x32_bf16 v[28:31], a[156:159], a[108:111], v[28:31]
  ds_read_b64_tr_b16 a[206:207], v236 offset:16896
  v_cvt_pk_bf16_f32 v138, v120, v121
  v_mfma_f32_16x16x32_bf16 v[28:31], a[160:163], a[116:119], v[28:31]
  ds_read_b64_tr_b16 a[144:145], v236 offset:20480
  v_cvt_pk_bf16_f32 v139, v122, v123
  v_mfma_f32_16x16x32_bf16 v[28:31], a[164:167], a[124:127], v[28:31]
  ds_read_b64_tr_b16 a[146:147], v236 offset:20992
  ds_read_b64_tr_b16 a[148:149], v236 offset:36864
  v_mfma_f32_16x16x32_bf16 v[28:31], a[168:171], a[132:135], v[28:31]
  buffer_store_dwordx4 v[136:139], v225, s[56:59], s28 offen offset:2048 sc1
  v_fma_f32 v200, -v116, v116, s37
  v_mfma_f32_16x16x32_bf16 v[92:95], a[172:175], a[140:143], v[28:31]
  s_waitcnt lgkmcnt(9)
  ds_read_b64_tr_b16 a[150:151], v236 offset:37376
  v_fma_f32 v201, -v117, v117, s37
  v_mfma_f32_16x16x32_bf16 v[32:35], a[176:179], a[96:99], v[32:35]
  buffer_load_dwordx4 v219, s[12:15], s35 offen offset:3072 sc1 lds
  v_fma_f32 v202, -v118, v118, s37
  v_mfma_f32_16x16x32_bf16 v[32:35], a[180:183], a[104:107], v[32:35]
  s_add_u32 m0, s29, 77824
  ds_read_b64_tr_b16 a[152:153], v236 offset:40960
  ds_read_b64_tr_b16 a[154:155], v236 offset:41472
  v_fma_f32 v203, -v119, v119, s37
  v_mfma_f32_16x16x32_bf16 v[32:35], a[184:187], a[112:115], v[32:35]
  s_add_u32 s35, s31, 2949376
  ds_read_b64_tr_b16 a[156:157], v236 offset:45056
  v_mul_f32 v200, v116, v200
  v_mfma_f32_16x16x32_bf16 v[32:35], a[188:191], a[120:123], v[32:35]
  ds_read_b64_tr_b16 a[158:159], v236 offset:45568
  v_mul_f32 v201, v117, v201
  v_mfma_f32_16x16x32_bf16 v[32:35], a[192:195], a[128:131], v[32:35]
  s_waitcnt lgkmcnt(8)
  ds_read_b64_tr_b16 a[160:161], v237 offset:0
  v_mul_f32 v202, v118, v202
  v_mfma_f32_16x16x32_bf16 v[96:99], a[196:199], a[136:139], v[32:35]
  ds_read_b64_tr_b16 a[162:163], v237 offset:512
  ds_read_b64_tr_b16 a[164:165], v237 offset:4096
  v_mul_f32 v203, v119, v203
  v_mfma_f32_16x16x32_bf16 v[36:39], a[176:179], a[100:103], v[36:39]
  buffer_load_dwordx4 v216, s[12:15], s35 offen sc1 lds
  v_mfma_f32_16x16x32_bf16 v[36:39], a[180:183], a[108:111], v[36:39]
  ds_read_b64_tr_b16 a[166:167], v237 offset:4608
  ds_read_b64_tr_b16 a[168:169], v237 offset:8192
  v_exp_f32 v200, v200
  v_mfma_f32_16x16x32_bf16 v[36:39], a[184:187], a[116:119], v[36:39]
  ds_read_b64_tr_b16 a[170:171], v237 offset:8704
  ds_read_b64_tr_b16 a[172:173], v237 offset:24576
  v_mfma_f32_16x16x32_bf16 v[36:39], a[188:191], a[124:127], v[36:39]
  v_exp_f32 v201, v201
  v_mfma_f32_16x16x32_bf16 v[36:39], a[192:195], a[132:135], v[36:39]
  ds_read_b64_tr_b16 a[174:175], v237 offset:25088
  ds_read_b64_tr_b16 a[176:177], v237 offset:28672
  v_mfma_f32_16x16x32_bf16 v[100:103], a[196:199], a[140:143], v[36:39]
  v_exp_f32 v202, v202
  v_mfma_f32_16x16x32_bf16 v[40:43], a[200:203], a[96:99], v[40:43]
  ds_read_b64_tr_b16 a[178:179], v237 offset:29184
  ds_read_b64_tr_b16 a[180:181], v237 offset:32768
  v_exp_f32 v203, v203
  v_mfma_f32_16x16x32_bf16 v[40:43], a[204:207], a[104:107], v[40:43]
  s_waitcnt lgkmcnt(9)
  v_mul_f32 v124, v116, v124
  v_mul_f32 v125, v117, v125
  v_mfma_f32_16x16x32_bf16 v[40:43], a[144:147], a[112:115], v[40:43]
  buffer_load_dwordx4 v217, s[12:15], s35 offen offset:1024 sc1 lds
  v_mfma_f32_16x16x32_bf16 v[40:43], a[148:151], a[120:123], v[40:43]
  ds_read_b64_tr_b16 a[182:183], v237 offset:33280
  ds_read_b64_tr_b16 a[184:185], v237 offset:12288
  v_mul_f32 v126, v118, v126
  v_mfma_f32_16x16x32_bf16 v[40:43], a[152:155], a[128:131], v[40:43]
  ds_read_b64_tr_b16 a[186:187], v237 offset:12800
  v_mul_f32 v127, v119, v127
  v_mfma_f32_16x16x32_bf16 v[104:107], a[156:159], a[136:139], v[40:43]
  ds_read_b64_tr_b16 a[188:189], v237 offset:16384
  v_add_f32 v200, 1.0, v200
  v_mfma_f32_16x16x32_bf16 v[44:47], a[200:203], a[100:103], v[44:47]
  ds_read_b64_tr_b16 a[190:191], v237 offset:16896
  ds_read_b64_tr_b16 a[192:193], v237 offset:20480
  v_add_f32 v201, 1.0, v201
  v_mfma_f32_16x16x32_bf16 v[44:47], a[204:207], a[108:111], v[44:47]
  ds_read_b64_tr_b16 a[194:195], v237 offset:20992
  v_add_f32 v202, 1.0, v202
  v_mfma_f32_16x16x32_bf16 v[44:47], a[144:147], a[116:119], v[44:47]
  ds_read_b64_tr_b16 a[196:197], v237 offset:36864
  v_add_f32 v203, 1.0, v203
  v_mfma_f32_16x16x32_bf16 v[44:47], a[148:151], a[124:127], v[44:47]
  ds_read_b64_tr_b16 a[198:199], v237 offset:37376
  ds_read_b64_tr_b16 a[200:201], v237 offset:40960
  v_mfma_f32_16x16x32_bf16 v[44:47], a[152:155], a[132:135], v[44:47]
  v_rcp_f32 v200, v200
  v_mfma_f32_16x16x32_bf16 v[108:111], a[156:159], a[140:143], v[44:47]
  ds_read_b64_tr_b16 a[202:203], v237 offset:41472
  ds_read_b64_tr_b16 a[204:205], v237 offset:45056
  v_mfma_f32_16x16x32_bf16 v[48:51], a[160:163], a[96:99], v[48:51]
  s_waitcnt lgkmcnt(9)
  ds_read_b64_tr_b16 a[206:207], v237 offset:45568
  v_rcp_f32 v201, v201
  v_mfma_f32_16x16x32_bf16 v[48:51], a[164:167], a[104:107], v[48:51]
  v_rcp_f32 v202, v202
  v_mfma_f32_16x16x32_bf16 v[48:51], a[168:171], a[112:115], v[48:51]
  v_rcp_f32 v203, v203
  v_mfma_f32_16x16x32_bf16 v[48:51], a[172:175], a[120:123], v[48:51]
  v_mul_f32 v124, v124, v200
  v_mul_f32 v125, v125, v201
  v_mfma_f32_16x16x32_bf16 v[48:51], a[176:179], a[128:131], v[48:51]
  v_mul_f32 v126, v126, v202
  v_mul_f32 v127, v127, v203
  v_mfma_f32_16x16x32_bf16 v[112:115], a[180:183], a[136:139], v[48:51]
  v_cvt_pk_bf16_f32 v142, v124, v125
  v_cvt_pk_bf16_f32 v143, v126, v127
  v_mfma_f32_16x16x32_bf16 v[52:55], a[160:163], a[100:103], v[52:55]
  buffer_store_dwordx4 v[140:143], v225, s[56:59], s28 offen offset:3072 sc1
  v_mfma_f32_16x16x32_bf16 v[52:55], a[164:167], a[108:111], v[52:55]
L_st11:
  s_waitcnt vmcnt(14) lgkmcnt(0)
  s_barrier
  ds_read_b64_tr_b16 a[144:145], v226 offset:0
  v_fma_f32 v200, -v64, v64, s37
  v_mfma_f32_16x16x32_bf16 v[52:55], a[168:171], a[116:119], v[52:55]
  s_add_u32 m0, s29, 98304
  ds_read_b64_tr_b16 a[146:147], v226 offset:512
  v_fma_f32 v201, -v65, v65, s37
  v_mfma_f32_16x16x32_bf16 v[52:55], a[172:175], a[124:127], v[52:55]
  s_add_u32 s35, s31, 3539200
  ds_read_b64_tr_b16 a[148:149], v226 offset:4096
  v_fma_f32 v202, -v66, v66, s37
  v_mfma_f32_16x16x32_bf16 v[52:55], a[176:179], a[132:135], v[52:55]
  s_add_u32 s41, s32, 0
  ds_read_b64_tr_b16 a[150:151], v226 offset:4608
  v_fma_f32 v203, -v67, v67, s37
  v_mfma_f32_16x16x32_bf16 v[116:119], a[180:183], a[140:143], v[52:55]
  buffer_load_dword v239, v215, s[12:15], s41 offen
  v_mfma_f32_16x16x32_bf16 v[56:59], a[184:187], a[96:99], v[56:59]
  buffer_load_dwordx4 v216, s[12:15], s35 offen sc1 lds
  v_mfma_f32_16x16x32_bf16 v[56:59], a[188:191], a[104:107], v[56:59]
  ds_read_b64_tr_b16 a[152:153], v226 offset:8192
  ds_read_b64_tr_b16 a[154:155], v226 offset:8704
  v_mfma_f32_16x16x32_bf16 v[56:59], a[192:195], a[112:115], v[56:59]
  ds_read_b64_tr_b16 a[156:157], v226 offset:24576
  v_mul_f32 v200, v64, v200
  v_mfma_f32_16x16x32_bf16 v[56:59], a[196:199], a[120:123], v[56:59]
  ds_read_b64_tr_b16 a[158:159], v226 offset:25088
  v_mul_f32 v201, v65, v201
  v_mfma_f32_16x16x32_bf16 v[56:59], a[200:203], a[128:131], v[56:59]
  ds_read_b64_tr_b16 a[160:161], v226 offset:28672
  v_mul_f32 v202, v66, v202
  v_mfma_f32_16x16x32_bf16 v[120:123], a[204:207], a[136:139], v[56:59]
  ds_read_b64_tr_b16 a[162:163], v226 offset:29184
  v_mul_f32 v203, v67, v203
  v_mfma_f32_16x16x32_bf16 v[60:63], a[184:187], a[100:103], v[60:63]
  buffer_load_dwordx4 v217, s[12:15], s35 offen offset:1024 sc1 lds
  v_mfma_f32_16x16x32_bf16 v[60:63], a[188:191], a[108:111], v[60:63]
  ds_read_b64_tr_b16 a[164:165], v226 offset:32768
  ds_read_b64_tr_b16 a[166:167], v226 offset:33280
  v_mfma_f32_16x16x32_bf16 v[60:63], a[192:195], a[116:119], v[60:63]
  ds_read_b64_tr_b16 a[168:169], v226 offset:12288
  ds_read_b64_tr_b16 a[170:171], v226 offset:12800
  v_mfma_f32_16x16x32_bf16 v[60:63], a[196:199], a[124:127], v[60:63]
  v_exp_f32 v200, v200
  v_mfma_f32_16x16x32_bf16 v[60:63], a[200:203], a[132:135], v[60:63]
  ds_read_b64_tr_b16 a[172:173], v226 offset:16384
  ds_read_b64_tr_b16 a[174:175], v226 offset:16896
  v_mfma_f32_16x16x32_bf16 v[124:127], a[204:207], a[140:143], v[60:63]
  s_waitcnt lgkmcnt(8)
  v_exp_f32 v201, v201
  v_mfma_f32_16x16x32_bf16 v[0:3], a[144:147], a[0:3], 0
  ds_read_b64_tr_b16 a[176:177], v226 offset:20480
  ds_read_b64_tr_b16 a[178:179], v226 offset:20992
  v_mfma_f32_16x16x32_bf16 v[0:3], a[148:151], a[8:11], v[0:3]
  buffer_load_dwordx4 v218, s[12:15], s35 offen offset:2048 sc1 lds
  v_mfma_f32_16x16x32_bf16 v[0:3], a[152:155], a[16:19], v[0:3]
  ds_read_b64_tr_b16 a[180:181], v226 offset:36864
  ds_read_b64_tr_b16 a[182:183], v226 offset:37376
  v_mfma_f32_16x16x32_bf16 v[0:3], a[156:159], a[24:27], v[0:3]
  s_waitcnt lgkmcnt(8)
  ds_read_b64_tr_b16 a[184:185], v226 offset:40960
  ds_read_b64_tr_b16 a[186:187], v226 offset:41472
  v_exp_f32 v202, v202
  v_mfma_f32_16x16x32_bf16 v[0:3], a[160:163], a[32:35], v[0:3]
  v_exp_f32 v203, v203
  v_mfma_f32_16x16x32_bf16 v[0:3], a[164:167], a[40:43], v[0:3]
  ds_read_b64_tr_b16 a[188:189], v226 offset:45056
  v_mul_f32 v72, v64, v72
  v_mfma_f32_16x16x32_bf16 v[4:7], a[144:147], a[4:7], 0
  ds_read_b64_tr_b16 a[190:191], v226 offset:45568
  v_mul_f32 v73, v65, v73
  v_mfma_f32_16x16x32_bf16 v[4:7], a[148:151], a[12:15], v[4:7]
  ds_read_b64_tr_b16 a[192:193], v227 offset:0
  v_mul_f32 v74, v66, v74
  v_mfma_f32_16x16x32_bf16 v[4:7], a[152:155], a[20:23], v[4:7]
  buffer_load_dwordx4 v219, s[12:15], s35 offen offset:3072 sc1 lds
  v_mul_f32 v75, v67, v75
  v_mfma_f32_16x16x32_bf16 v[4:7], a[156:159], a[28:31], v[4:7]
  s_add_u32 m0, s29, 102400
  ds_read_b64_tr_b16 a[194:195], v227 offset:512
  ds_read_b64_tr_b16 a[196:197], v227 offset:4096
  v_add_f32 v200, 1.0, v200
  v_mfma_f32_16x16x32_bf16 v[4:7], a[160:163], a[36:39], v[4:7]
  s_add_u32 s35, s31, 3834112
  ds_read_b64_tr_b16 a[198:199], v227 offset:4608
  v_add_f32 v201, 1.0, v201
  v_mfma_f32_16x16x32_bf16 v[4:7], a[164:167], a[44:47], v[4:7]
  s_waitcnt lgkmcnt(6)
  ds_read_b64_tr_b16 a[200:201], v227 offset:8192
  v_add_f32 v202, 1.0, v202
  v_mfma_f32_16x16x32_bf16 v[8:11], a[168:171], a[0:3], 0
  ds_read_b64_tr_b16 a[202:203], v227 offset:8704
  v_add_f32 v203, 1.0, v203
  v_mfma_f32_16x16x32_bf16 v[8:11], a[172:175], a[8:11], v[8:11]
  ds_read_b64_tr_b16 a[204:205], v227 offset:24576
  ds_read_b64_tr_b16 a[206:207], v227 offset:25088
  v_mfma_f32_16x16x32_bf16 v[8:11], a[176:179], a[16:19], v[8:11]
  buffer_load_dwordx4 v216, s[12:15], s35 offen sc1 lds
  v_rcp_f32 v200, v200
  v_mfma_f32_16x16x32_bf16 v[8:11], a[180:183], a[24:27], v[8:11]
  ds_read_b64_tr_b16 a[144:145], v227 offset:28672
  ds_read_b64_tr_b16 a[146:147], v227 offset:29184
  v_mfma_f32_16x16x32_bf16 v[8:11], a[184:187], a[32:35], v[8:11]
  s_waitcnt lgkmcnt(10)
  ds_read_b64_tr_b16 a[148:149], v227 offset:32768
  ds_read_b64_tr_b16 a[150:151], v227 offset:33280
  v_rcp_f32 v201, v201
  v_mfma_f32_16x16x32_bf16 v[8:11], a[188:191], a[40:43], v[8:11]
  v_rcp_f32 v202, v202
  v_mfma_f32_16x16x32_bf16 v[12:15], a[168:171], a[4:7], 0
  ds_read_b64_tr_b16 a[152:153], v227 offset:12288
  ds_read_b64_tr_b16 a[154:155], v227 offset:12800
  v_mfma_f32_16x16x32_bf16 v[12:15], a[172:175], a[12:15], v[12:15]
  v_rcp_f32 v203, v203
  v_mfma_f32_16x16x32_bf16 v[12:15], a[176:179], a[20:23], v[12:15]
  ds_read_b64_tr_b16 a[156:157], v227 offset:16384
  v_mul_f32 v72, v72, v200
  v_mfma_f32_16x16x32_bf16 v[12:15], a[180:183], a[28:31], v[12:15]
  buffer_load_dwordx4 v217, s[12:15], s35 offen offset:1024 sc1 lds
  v_mul_f32 v73, v73, v201
  v_mfma_f32_16x16x32_bf16 v[12:15], a[184:187], a[36:39], v[12:15]
  s_add_u32 m0, s29, 122880
  ds_read_b64_tr_b16 a[158:159], v227 offset:16896
  ds_read_b64_tr_b16 a[160:161], v227 offset:20480
  v_mul_f32 v74, v74, v202
  v_mfma_f32_16x16x32_bf16 v[12:15], a[188:191], a[44:47], v[12:15]
  s_waitcnt lgkmcnt(7)
  ds_read_b64_tr_b16 a[162:163], v227 offset:20992
  v_mul_f32 v75, v75, v203
  v_mfma_f32_16x16x32_bf16 v[16:19], a[192:195], a[0:3], 0
  s_add_u32 s35, s31, 4423936
  ds_read_b64_tr_b16 a[164:165], v227 offset:36864
  v_cvt_pk_bf16_f32 v144, v72, v73
  v_mfma_f32_16x16x32_bf16 v[16:19], a[196:199], a[8:11], v[16:19]
  ds_read_b64_tr_b16 a[166:167], v227 offset:37376
  v_cvt_pk_bf16_f32 v145, v74, v75
  v_mfma_f32_16x16x32_bf16 v[16:19], a[200:203], a[16:19], v[16:19]
  ds_read_b64_tr_b16 a[168:169], v227 offset:40960
  v_fma_f32 v200, -v68, v68, s37
  v_mfma_f32_16x16x32_bf16 v[16:19], a[204:207], a[24:27], v[16:19]
  ds_read_b64_tr_b16 a[170:171], v227 offset:41472
  ds_read_b64_tr_b16 a[172:173], v227 offset:45056
  v_fma_f32 v201, -v69, v69, s37
  v_mfma_f32_16x16x32_bf16 v[16:19], a[144:147], a[32:35], v[16:19]
  s_waitcnt lgkmcnt(9)
  ds_read_b64_tr_b16 a[174:175], v227 offset:45568
  ds_read_b64_tr_b16 a[176:177], v228 offset:0
  v_fma_f32 v202, -v70, v70, s37
  v_mfma_f32_16x16x32_bf16 v[16:19], a[148:151], a[40:43], v[16:19]
  buffer_load_dwordx4 v216, s[12:15], s35 offen sc1 lds
  v_fma_f32 v203, -v71, v71, s37
  v_mfma_f32_16x16x32_bf16 v[20:23], a[192:195], a[4:7], 0
  ds_read_b64_tr_b16 a[178:179], v228 offset:512
  v_mul_f32 v200, v68, v200
  v_mul_f32 v201, v69, v201
  v_mfma_f32_16x16x32_bf16 v[20:23], a[196:199], a[12:15], v[20:23]
  ds_read_b64_tr_b16 a[180:181], v228 offset:4096
  v_mul_f32 v202, v70, v202
  v_mfma_f32_16x16x32_bf16 v[20:23], a[200:203], a[20:23], v[20:23]
  ds_read_b64_tr_b16 a[182:183], v228 offset:4608
  v_mul_f32 v203, v71, v203
  v_mfma_f32_16x16x32_bf16 v[20:23], a[204:207], a[28:31], v[20:23]
  ds_read_b64_tr_b16 a[184:185], v228 offset:8192
  ds_read_b64_tr_b16 a[186:187], v228 offset:8704
  v_mfma_f32_16x16x32_bf16 v[20:23], a[144:147], a[36:39], v[20:23]
  buffer_load_dwordx4 v217, s[12:15], s35 offen offset:1024 sc1 lds
  v_exp_f32 v200, v200
  v_mfma_f32_16x16x32_bf16 v[20:23], a[148:151], a[44:47], v[20:23]
  ds_read_b64_tr_b16 a[188:189], v228 offset:24576
  ds_read_b64_tr_b16 a[190:191], v228 offset:25088
  v_mfma_f32_16x16x32_bf16 v[24:27], a[152:155], a[0:3], 0
  s_waitcnt lgkmcnt(8)
  v_exp_f32 v201, v201
  v_mfma_f32_16x16x32_bf16 v[24:27], a[156:159], a[8:11], v[24:27]
  ds_read_b64_tr_b16 a[192:193], v228 offset:28672
  ds_read_b64_tr_b16 a[194:195], v228 offset:29184
  v_mfma_f32_16x16x32_bf16 v[24:27], a[160:163], a[16:19], v[24:27]
  ds_read_b64_tr_b16 a[196:197], v228 offset:32768
  ds_read_b64_tr_b16 a[198:199], v228 offset:33280
  v_exp_f32 v202, v202
  v_mfma_f32_16x16x32_bf16 v[24:27], a[164:167], a[24:27], v[24:27]
  v_exp_f32 v203, v203
  v_mfma_f32_16x16x32_bf16 v[24:27], a[168:171], a[32:35], v[24:27]
  ds_read_b64_tr_b16 a[200:201], v228 offset:12288
  v_mul_f32 v76, v68, v76
  v_mfma_f32_16x16x32_bf16 v[24:27], a[172:175], a[40:43], v[24:27]
  buffer_load_dwordx4 v218, s[12:15], s35 offen offset:2048 sc1 lds
  v_mul_f32 v77, v69, v77
  v_mfma_f32_16x16x32_bf16 v[28:31], a[152:155], a[4:7], 0
  ds_read_b64_tr_b16 a[202:203], v228 offset:12800
  ds_read_b64_tr_b16 a[204:205], v228 offset:16384
  v_mul_f32 v78, v70, v78
  v_mfma_f32_16x16x32_bf16 v[28:31], a[156:159], a[12:15], v[28:31]
  ds_read_b64_tr_b16 a[206:207], v228 offset:16896
  v_mul_f32 v79, v71, v79
  v_mfma_f32_16x16x32_bf16 v[28:31], a[160:163], a[20:23], v[28:31]
  ds_read_b64_tr_b16 a[144:145], v228 offset:20480
  v_add_f32 v200, 1.0, v200
  v_mfma_f32_16x16x32_bf16 v[28:31], a[164:167], a[28:31], v[28:31]
  ds_read_b64_tr_b16 a[146:147], v228 offset:20992
  v_add_f32 v201, 1.0, v201
  v_mfma_f32_16x16x32_bf16 v[28:31], a[168:171], a[36:39], v[28:31]
  ds_read_b64_tr_b16 a[148:149], v228 offset:36864
  v_add_f32 v202, 1.0, v202
  v_mfma_f32_16x16x32_bf16 v[28:31], a[172:175], a[44:47], v[28:31]
  s_waitcnt lgkmcnt(7)
  ds_read_b64_tr_b16 a[150:151], v228 offset:37376
  v_add_f32 v203, 1.0, v203
  v_mfma_f32_16x16x32_bf16 v[32:35], a[176:179], a[0:3], 0
  buffer_load_dwordx4 v219, s[12:15], s35 offen offset:3072 sc1 lds
  v_rcp_f32 v200, v200
  v_mfma_f32_16x16x32_bf16 v[32:35], a[180:183], a[8:11], v[32:35]
  s_add_u32 m0, s29, 126976
  ds_read_b64_tr_b16 a[152:153], v228 offset:40960
  ds_read_b64_tr_b16 a[154:155], v228 offset:41472
  v_mfma_f32_16x16x32_bf16 v[32:35], a[184:187], a[16:19], v[32:35]
  s_add_u32 s35, s31, 4718848
  ds_read_b64_tr_b16 a[156:157], v228 offset:45056
  ds_read_b64_tr_b16 a[158:159], v228 offset:45568
  v_rcp_f32 v201, v201
  v_mfma_f32_16x16x32_bf16 v[32:35], a[188:191], a[24:27], v[32:35]
  v_rcp_f32 v202, v202
  v_mfma_f32_16x16x32_bf16 v[32:35], a[192:195], a[32:35], v[32:35]
  ds_read_b64_tr_b16 a[160:161], v229 offset:0
  ds_read_b64_tr_b16 a[162:163], v229 offset:512
  v_mfma_f32_16x16x32_bf16 v[32:35], a[196:199], a[40:43], v[32:35]
  v_rcp_f32 v203, v203
  v_mfma_f32_16x16x32_bf16 v[36:39], a[176:179], a[4:7], 0
  buffer_load_dwordx4 v216, s[12:15], s35 offen sc1 lds
  v_mfma_f32_16x16x32_bf16 v[36:39], a[180:183], a[12:15], v[36:39]
  ds_read_b64_tr_b16 a[164:165], v229 offset:4096
  ds_read_b64_tr_b16 a[166:167], v229 offset:4608
  v_mul_f32 v76, v76, v200
  v_mfma_f32_16x16x32_bf16 v[36:39], a[184:187], a[20:23], v[36:39]
  ds_read_b64_tr_b16 a[168:169], v229 offset:8192
  v_mul_f32 v77, v77, v201
  v_mfma_f32_16x16x32_bf16 v[36:39], a[188:191], a[28:31], v[36:39]
  ds_read_b64_tr_b16 a[170:171], v229 offset:8704
  v_mul_f32 v78, v78, v202
  v_mfma_f32_16x16x32_bf16 v[36:39], a[192:195], a[36:39], v[36:39]
  ds_read_b64_tr_b16 a[172:173], v229 offset:24576
  ds_read_b64_tr_b16 a[174:175], v229 offset:25088
  v_mul_f32 v79, v79, v203
  v_mfma_f32_16x16x32_bf16 v[36:39], a[196:199], a[44:47], v[36:39]
  s_waitcnt lgkmcnt(8)
  ds_read_b64_tr_b16 a[176:177], v229 offset:28672
  v_cvt_pk_bf16_f32 v148, v76, v77
  v_cvt_pk_bf16_f32 v149, v78, v79
  v_mfma_f32_16x16x32_bf16 v[40:43], a[200:203], a[0:3], 0
  ds_read_b64_tr_b16 a[178:179], v229 offset:29184
  v_fma_f32 v200, -v80, v80, s37
  v_mfma_f32_16x16x32_bf16 v[40:43], a[204:207], a[8:11], v[40:43]
  buffer_load_dwordx4 v217, s[12:15], s35 offen offset:1024 sc1 lds
  v_fma_f32 v201, -v81, v81, s37
  v_mfma_f32_16x16x32_bf16 v[40:43], a[144:147], a[16:19], v[40:43]
  ds_read_b64_tr_b16 a[180:181], v229 offset:32768
  ds_read_b64_tr_b16 a[182:183], v229 offset:33280
  v_fma_f32 v202, -v82, v82, s37
  v_mfma_f32_16x16x32_bf16 v[40:43], a[148:151], a[24:27], v[40:43]
  ds_read_b64_tr_b16 a[184:185], v229 offset:12288
  v_fma_f32 v203, -v83, v83, s37
  v_mfma_f32_16x16x32_bf16 v[40:43], a[152:155], a[32:35], v[40:43]
  ds_read_b64_tr_b16 a[186:187], v229 offset:12800
  v_mul_f32 v200, v80, v200
  v_mfma_f32_16x16x32_bf16 v[40:43], a[156:159], a[40:43], v[40:43]
  ds_read_b64_tr_b16 a[188:189], v229 offset:16384
  ds_read_b64_tr_b16 a[190:191], v229 offset:16896
  v_mul_f32 v201, v81, v201
  v_mfma_f32_16x16x32_bf16 v[44:47], a[200:203], a[4:7], 0
  ds_read_b64_tr_b16 a[192:193], v229 offset:20480
  v_mul_f32 v202, v82, v202
  v_mfma_f32_16x16x32_bf16 v[44:47], a[204:207], a[12:15], v[44:47]
  ds_read_b64_tr_b16 a[194:195], v229 offset:20992
  v_mul_f32 v203, v83, v203
  v_mfma_f32_16x16x32_bf16 v[44:47], a[144:147], a[20:23], v[44:47]
  ds_read_b64_tr_b16 a[196:197], v229 offset:36864
  ds_read_b64_tr_b16 a[198:199], v229 offset:37376
  v_mfma_f32_16x16x32_bf16 v[44:47], a[148:151], a[28:31], v[44:47]
  v_exp_f32 v200, v200
  v_mfma_f32_16x16x32_bf16 v[44:47], a[152:155], a[36:39], v[44:47]
  ds_read_b64_tr_b16 a[200:201], v229 offset:40960
  ds_read_b64_tr_b16 a[202:203], v229 offset:41472
  v_exp_f32 v201, v201
  v_mfma_f32_16x16x32_bf16 v[44:47], a[156:159], a[44:47], v[44:47]
  s_waitcnt lgkmcnt(10)
  ds_read_b64_tr_b16 a[204:205], v229 offset:45056
  ds_read_b64_tr_b16 a[206:207], v229 offset:45568
  v_mfma_f32_16x16x32_bf16 v[48:51], a[160:163], a[0:3], 0
  v_exp_f32 v202, v202
  v_mfma_f32_16x16x32_bf16 v[48:51], a[164:167], a[8:11], v[48:51]
  v_exp_f32 v203, v203
  v_mfma_f32_16x16x32_bf16 v[48:51], a[168:171], a[16:19], v[48:51]
  v_mul_f32 v88, v80, v88
  v_mul_f32 v89, v81, v89
  v_mfma_f32_16x16x32_bf16 v[48:51], a[172:175], a[24:27], v[48:51]
  v_mul_f32 v90, v82, v90
  v_mul_f32 v91, v83, v91
  v_mfma_f32_16x16x32_bf16 v[48:51], a[176:179], a[32:35], v[48:51]
  v_add_f32 v200, 1.0, v200
  v_add_f32 v201, 1.0, v201
  v_mfma_f32_16x16x32_bf16 v[48:51], a[180:183], a[40:43], v[48:51]
  v_add_f32 v202, 1.0, v202
  v_add_f32 v203, 1.0, v203
  v_mfma_f32_16x16x32_bf16 v[52:55], a[160:163], a[4:7], 0
  v_rcp_f32 v200, v200
  v_mfma_f32_16x16x32_bf16 v[52:55], a[164:167], a[12:15], v[52:55]
L_st13:
  s_waitcnt vmcnt(14) lgkmcnt(0)
  s_barrier
  v_rcp_f32 v201, v201
  v_mfma_f32_16x16x32_bf16 v[52:55], a[168:171], a[20:23], v[52:55]
  s_add_u32 m0, s29, 0
  ds_read_b64_tr_b16 a[144:145], v230 offset:0
  ds_read_b64_tr_b16 a[146:147], v230 offset:512
  v_mfma_f32_16x16x32_bf16 v[52:55], a[172:175], a[28:31], v[52:55]
  s_add_u32 s35, s31, 384
  v_rcp_f32 v202, v202
  v_mfma_f32_16x16x32_bf16 v[52:55], a[176:179], a[36:39], v[52:55]
  s_add_u32 s41, s40, 0
  ds_read_b64_tr_b16 a[148:149], v230 offset:4096
  ds_read_b64_tr_b16 a[150:151], v230 offset:4608
  v_mfma_f32_16x16x32_bf16 v[52:55], a[180:183], a[44:47], v[52:55]
  buffer_load_dword v239, v238, s[16:19], s41 offen
  v_mfma_f32_16x16x32_bf16 v[56:59], a[184:187], a[0:3], 0
  ds_read_b64_tr_b16 a[152:153], v230 offset:8192
  ds_read_b64_tr_b16 a[154:155], v230 offset:8704
  v_mfma_f32_16x16x32_bf16 v[56:59], a[188:191], a[8:11], v[56:59]
  buffer_load_dwordx4 v216, s[12:15], s35 offen sc1 lds
  v_mfma_f32_16x16x32_bf16 v[56:59], a[192:195], a[16:19], v[56:59]
  ds_read_b64_tr_b16 a[156:157], v230 offset:24576
  ds_read_b64_tr_b16 a[158:159], v230 offset:25088
  v_mfma_f32_16x16x32_bf16 v[56:59], a[196:199], a[24:27], v[56:59]
  v_rcp_f32 v203, v203
  v_mfma_f32_16x16x32_bf16 v[56:59], a[200:203], a[32:35], v[56:59]
  ds_read_b64_tr_b16 a[160:161], v230 offset:28672
  v_mul_f32 v88, v88, v200
  v_mfma_f32_16x16x32_bf16 v[56:59], a[204:207], a[40:43], v[56:59]
  ds_read_b64_tr_b16 a[162:163], v230 offset:29184
  v_mul_f32 v89, v89, v201
  v_mfma_f32_16x16x32_bf16 v[60:63], a[184:187], a[4:7], 0
  ds_read_b64_tr_b16 a[164:165], v230 offset:32768
  v_mul_f32 v90, v90, v202
  v_mfma_f32_16x16x32_bf16 v[60:63], a[188:191], a[12:15], v[60:63]
  buffer_load_dwordx4 v217, s[12:15], s35 offen offset:1024 sc1 lds
  v_mfma_f32_16x16x32_bf16 v[60:63], a[192:195], a[20:23], v[60:63]
  ds_read_b64_tr_b16 a[166:167], v230 offset:33280
  ds_read_b64_tr_b16 a[168:169], v230 offset:12288
  v_mfma_f32_16x16x32_bf16 v[60:63], a[196:199], a[28:31], v[60:63]
  ds_read_b64_tr_b16 a[170:171], v230 offset:12800
  v_mul_f32 v91, v91, v203
  v_cvt_pk_bf16_f32 v146, v88, v89
  v_mfma_f32_16x16x32_bf16 v[60:63], a[200:203], a[36:39], v[60:63]
  ds_read_b64_tr_b16 a[172:173], v230 offset:16384
  v_cvt_pk_bf16_f32 v147, v90, v91
  v_mfma_f32_16x16x32_bf16 v[60:63], a[204:207], a[44:47], v[60:63]
  s_waitcnt lgkmcnt(7)
  ds_read_b64_tr_b16 a[174:175], v230 offset:16896
  v_mfma_f32_16x16x32_bf16 v[0:3], a[144:147], a[48:51], v[0:3]
  s_add_u32 s28, s76, 4096
  ds_read_b64_tr_b16 a[176:177], v230 offset:20480
  ds_read_b64_tr_b16 a[178:179], v230 offset:20992
  buffer_store_dwordx4 v[144:147], v225, s[56:59], s28 offen sc1
  v_mfma_f32_16x16x32_bf16 v[0:3], a[148:151], a[56:59], v[0:3]
  v_fma_f32 v200, -v84, v84, s37
  v_fma_f32 v201, -v85, v85, s37
  v_mfma_f32_16x16x32_bf16 v[0:3], a[152:155], a[64:67], v[0:3]
  buffer_load_dwordx4 v218, s[12:15], s35 offen offset:2048 sc1 lds
  v_mfma_f32_16x16x32_bf16 v[0:3], a[156:159], a[72:75], v[0:3]
  s_waitcnt lgkmcnt(8)
  ds_read_b64_tr_b16 a[180:181], v230 offset:36864
  ds_read_b64_tr_b16 a[182:183], v230 offset:37376
  v_fma_f32 v202, -v86, v86, s37
  v_mfma_f32_16x16x32_bf16 v[0:3], a[160:163], a[80:83], v[0:3]
  s_waitcnt lgkmcnt(8)
  ds_read_b64_tr_b16 a[184:185], v230 offset:40960
  v_fma_f32 v203, -v87, v87, s37
  v_mfma_f32_16x16x32_bf16 v[0:3], a[164:167], a[88:91], v[0:3]
  ds_read_b64_tr_b16 a[186:187], v230 offset:41472
  v_mul_f32 v200, v84, v200
  v_mfma_f32_16x16x32_bf16 v[4:7], a[144:147], a[52:55], v[4:7]
  ds_read_b64_tr_b16 a[188:189], v230 offset:45056
  v_mul_f32 v201, v85, v201
  v_mfma_f32_16x16x32_bf16 v[4:7], a[148:151], a[60:63], v[4:7]
  ds_read_b64_tr_b16 a[190:191], v230 offset:45568
  v_mul_f32 v202, v86, v202
  v_mfma_f32_16x16x32_bf16 v[4:7], a[152:155], a[68:71], v[4:7]
  ds_read_b64_tr_b16 a[192:193], v231 offset:0
  ds_read_b64_tr_b16 a[194:195], v231 offset:512
  v_mul_f32 v203, v87, v203
  v_mfma_f32_16x16x32_bf16 v[4:7], a[156:159], a[76:79], v[4:7]
  buffer_load_dwordx4 v219, s[12:15], s35 offen offset:3072 sc1 lds
  v_exp_f32 v200, v200
  v_mfma_f32_16x16x32_bf16 v[4:7], a[160:163], a[84:87], v[4:7]
  s_add_u32 m0, s29, 4096
  ds_read_b64_tr_b16 a[196:197], v231 offset:4096
  ds_read_b64_tr_b16 a[198:199], v231 offset:4608
  v_mfma_f32_16x16x32_bf16 v[4:7], a[164:167], a[92:95], v[4:7]
  s_waitcnt lgkmcnt(8)
  ds_read_b64_tr_b16 a[200:201], v231 offset:8192
  ds_read_b64_tr_b16 a[202:203], v231 offset:8704
  v_exp_f32 v201, v201
  v_mfma_f32_16x16x32_bf16 v[8:11], a[168:171], a[48:51], v[8:11]
  s_add_u32 s35, s31, 295296
  v_exp_f32 v202, v202
  v_mfma_f32_16x16x32_bf16 v[8:11], a[172:175], a[56:59], v[8:11]
  ds_read_b64_tr_b16 a[204:205], v231 offset:24576
  ds_read_b64_tr_b16 a[206:207], v231 offset:25088
  v_mfma_f32_16x16x32_bf16 v[8:11], a[176:179], a[64:67], v[8:11]
  v_exp_f32 v203, v203
  v_mfma_f32_16x16x32_bf16 v[8:11], a[180:183], a[72:75], v[8:11]
  s_waitcnt lgkmcnt(8)
  ds_read_b64_tr_b16 a[144:145], v231 offset:28672
  ds_read_b64_tr_b16 a[146:147], v231 offset:29184
  v_mfma_f32_16x16x32_bf16 v[8:11], a[184:187], a[80:83], v[8:11]
  buffer_load_dwordx4 v216, s[12:15], s35 offen sc1 lds
  v_mul_f32 v92, v84, v92
  v_mfma_f32_16x16x32_bf16 v[8:11], a[188:191], a[88:91], v[8:11]
  ds_read_b64_tr_b16 a[148:149], v231 offset:32768
  v_mul_f32 v93, v85, v93
  v_mfma_f32_16x16x32_bf16 v[12:15], a[168:171], a[52:55], v[12:15]
  ds_read_b64_tr_b16 a[150:151], v231 offset:33280
  v_mul_f32 v94, v86, v94
  v_mul_f32 v95, v87, v95
  v_mfma_f32_16x16x32_bf16 v[12:15], a[172:175], a[60:63], v[12:15]
  ds_read_b64_tr_b16 a[152:153], v231 offset:12288
  ds_read_b64_tr_b16 a[154:155], v231 offset:12800
  v_add_f32 v200, 1.0, v200
  v_mfma_f32_16x16x32_bf16 v[12:15], a[176:179], a[68:71], v[12:15]
  ds_read_b64_tr_b16 a[156:157], v231 offset:16384
  v_add_f32 v201, 1.0, v201
  v_mfma_f32_16x16x32_bf16 v[12:15], a[180:183], a[76:79], v[12:15]
  ds_read_b64_tr_b16 a[158:159], v231 offset:16896
  v_add_f32 v202, 1.0, v202
  v_mfma_f32_16x16x32_bf16 v[12:15], a[184:187], a[84:87], v[12:15]
  buffer_load_dwordx4 v217, s[12:15], s35 offen offset:1024 sc1 lds
  v_add_f32 v203, 1.0, v203
  v_mfma_f32_16x16x32_bf16 v[12:15], a[188:191], a[92:95], v[12:15]
  s_waitcnt lgkmcnt(6)
  ds_read_b64_tr_b16 a[160:161], v231 offset:20480
  ds_read_b64_tr_b16 a[162:163], v231 offset:20992
  v_mfma_f32_16x16x32_bf16 v[16:19], a[192:195], a[48:51], v[16:19]
  s_add_u32 m0, s29, 24576
  ds_read_b64_tr_b16 a[164:165], v231 offset:36864
  ds_read_b64_tr_b16 a[166:167], v231 offset:37376
  v_rcp_f32 v200, v200
  v_mfma_f32_16x16x32_bf16 v[16:19], a[196:199], a[56:59], v[16:19]
  s_add_u32 s35, s31, 885120
  v_rcp_f32 v201, v201
  v_mfma_f32_16x16x32_bf16 v[16:19], a[200:203], a[64:67], v[16:19]
  ds_read_b64_tr_b16 a[168:169], v231 offset:40960
  ds_read_b64_tr_b16 a[170:171], v231 offset:41472
  v_mfma_f32_16x16x32_bf16 v[16:19], a[204:207], a[72:75], v[16:19]
  v_rcp_f32 v202, v202
  v_mfma_f32_16x16x32_bf16 v[16:19], a[144:147], a[80:83], v[16:19]
  s_waitcnt lgkmcnt(8)
  ds_read_b64_tr_b16 a[172:173], v231 offset:45056
  ds_read_b64_tr_b16 a[174:175], v231 offset:45568
  v_mfma_f32_16x16x32_bf16 v[16:19], a[148:151], a[88:91], v[16:19]
  buffer_load_dwordx4 v216, s[12:15], s35 offen sc1 lds
  v_rcp_f32 v203, v203
  v_mfma_f32_16x16x32_bf16 v[20:23], a[192:195], a[52:55], v[20:23]
  ds_read_b64_tr_b16 a[176:177], v232 offset:0
  ds_read_b64_tr_b16 a[178:179], v232 offset:512
  v_mul_f32 v92, v92, v200
  v_mfma_f32_16x16x32_bf16 v[20:23], a[196:199], a[60:63], v[20:23]
  ds_read_b64_tr_b16 a[180:181], v232 offset:4096
  v_mul_f32 v93, v93, v201
  v_mfma_f32_16x16x32_bf16 v[20:23], a[200:203], a[68:71], v[20:23]
  ds_read_b64_tr_b16 a[182:183], v232 offset:4608
  v_mul_f32 v94, v94, v202
  v_mfma_f32_16x16x32_bf16 v[20:23], a[204:207], a[76:79], v[20:23]
  ds_read_b64_tr_b16 a[184:185], v232 offset:8192
  v_mul_f32 v95, v95, v203
  v_mfma_f32_16x16x32_bf16 v[20:23], a[144:147], a[84:87], v[20:23]
  ds_read_b64_tr_b16 a[186:187], v232 offset:8704
  v_cvt_pk_bf16_f32 v150, v92, v93
  v_mfma_f32_16x16x32_bf16 v[20:23], a[148:151], a[92:95], v[20:23]
  buffer_load_dwordx4 v217, s[12:15], s35 offen offset:1024 sc1 lds
  v_cvt_pk_bf16_f32 v151, v94, v95
  v_mfma_f32_16x16x32_bf16 v[24:27], a[152:155], a[48:51], v[24:27]
  s_waitcnt lgkmcnt(6)
  ds_read_b64_tr_b16 a[188:189], v232 offset:24576
  ds_read_b64_tr_b16 a[190:191], v232 offset:25088
  v_mfma_f32_16x16x32_bf16 v[24:27], a[156:159], a[56:59], v[24:27]
  ds_read_b64_tr_b16 a[192:193], v232 offset:28672
  ds_read_b64_tr_b16 a[194:195], v232 offset:29184
  buffer_store_dwordx4 v[148:151], v225, s[56:59], s28 offen offset:1024 sc1
  v_mfma_f32_16x16x32_bf16 v[24:27], a[160:163], a[64:67], v[24:27]
  v_fma_f32 v200, -v96, v96, s37
  v_fma_f32 v201, -v97, v97, s37
  v_mfma_f32_16x16x32_bf16 v[24:27], a[164:167], a[72:75], v[24:27]
  ds_read_b64_tr_b16 a[196:197], v232 offset:32768
  v_fma_f32 v202, -v98, v98, s37
  v_mfma_f32_16x16x32_bf16 v[24:27], a[168:171], a[80:83], v[24:27]
  ds_read_b64_tr_b16 a[198:199], v232 offset:33280
  v_fma_f32 v203, -v99, v99, s37
  v_mfma_f32_16x16x32_bf16 v[24:27], a[172:175], a[88:91], v[24:27]
  ds_read_b64_tr_b16 a[200:201], v232 offset:12288
  ds_read_b64_tr_b16 a[202:203], v232 offset:12800
  v_mul_f32 v200, v96, v200
  v_mfma_f32_16x16x32_bf16 v[28:31], a[152:155], a[52:55], v[28:31]
  buffer_load_dwordx4 v218, s[12:15], s35 offen offset:2048 sc1 lds
  v_mul_f32 v201, v97, v201
  v_mfma_f32_16x16x32_bf16 v[28:31], a[156:159], a[60:63], v[28:31]
  ds_read_b64_tr_b16 a[204:205], v232 offset:16384
  ds_read_b64_tr_b16 a[206:207], v232 offset:16896
  v_mul_f32 v202, v98, v202
  v_mfma_f32_16x16x32_bf16 v[28:31], a[160:163], a[68:71], v[28:31]
  ds_read_b64_tr_b16 a[144:145], v232 offset:20480
  v_mul_f32 v203, v99, v203
  v_mfma_f32_16x16x32_bf16 v[28:31], a[164:167], a[76:79], v[28:31]
  ds_read_b64_tr_b16 a[146:147], v232 offset:20992
  ds_read_b64_tr_b16 a[148:149], v232 offset:36864
  v_mfma_f32_16x16x32_bf16 v[28:31], a[168:171], a[84:87], v[28:31]
  v_exp_f32 v200, v200
  v_mfma_f32_16x16x32_bf16 v[28:31], a[172:175], a[92:95], v[28:31]
  s_waitcnt lgkmcnt(9)
  ds_read_b64_tr_b16 a[150:151], v232 offset:37376
  ds_read_b64_tr_b16 a[152:153], v232 offset:40960
  v_mfma_f32_16x16x32_bf16 v[32:35], a[176:179], a[48:51], v[32:35]
  v_exp_f32 v201, v201
  v_mfma_f32_16x16x32_bf16 v[32:35], a[180:183], a[56:59], v[32:35]
  buffer_load_dwordx4 v219, s[12:15], s35 offen offset:3072 sc1 lds
  v_exp_f32 v202, v202
  v_mfma_f32_16x16x32_bf16 v[32:35], a[184:187], a[64:67], v[32:35]
  s_add_u32 m0, s29, 28672
  ds_read_b64_tr_b16 a[154:155], v232 offset:41472
  ds_read_b64_tr_b16 a[156:157], v232 offset:45056
  v_mfma_f32_16x16x32_bf16 v[32:35], a[188:191], a[72:75], v[32:35]
  s_add_u32 s35, s31, 1180032
  ds_read_b64_tr_b16 a[158:159], v232 offset:45568
  ds_read_b64_tr_b16 a[160:161], v233 offset:0
  v_exp_f32 v203, v203
  v_mfma_f32_16x16x32_bf16 v[32:35], a[192:195], a[80:83], v[32:35]
  s_waitcnt lgkmcnt(9)
  v_mul_f32 v104, v96, v104
  v_mul_f32 v105, v97, v105
  v_mfma_f32_16x16x32_bf16 v[32:35], a[196:199], a[88:91], v[32:35]
  ds_read_b64_tr_b16 a[162:163], v233 offset:512
  v_mul_f32 v106, v98, v106
  v_mfma_f32_16x16x32_bf16 v[36:39], a[176:179], a[52:55], v[36:39]
  ds_read_b64_tr_b16 a[164:165], v233 offset:4096
  ds_read_b64_tr_b16 a[166:167], v233 offset:4608
  v_mfma_f32_16x16x32_bf16 v[36:39], a[180:183], a[60:63], v[36:39]
  buffer_load_dwordx4 v216, s[12:15], s35 offen sc1 lds
  v_mul_f32 v107, v99, v107
  v_mfma_f32_16x16x32_bf16 v[36:39], a[184:187], a[68:71], v[36:39]
  ds_read_b64_tr_b16 a[168:169], v233 offset:8192
  ds_read_b64_tr_b16 a[170:171], v233 offset:8704
  v_add_f32 v200, 1.0, v200
  v_mfma_f32_16x16x32_bf16 v[36:39], a[188:191], a[76:79], v[36:39]
  ds_read_b64_tr_b16 a[172:173], v233 offset:24576
  v_add_f32 v201, 1.0, v201
  v_mfma_f32_16x16x32_bf16 v[36:39], a[192:195], a[84:87], v[36:39]
  ds_read_b64_tr_b16 a[174:175], v233 offset:25088
  v_add_f32 v202, 1.0, v202
  v_mfma_f32_16x16x32_bf16 v[36:39], a[196:199], a[92:95], v[36:39]
  ds_read_b64_tr_b16 a[176:177], v233 offset:28672
  v_add_f32 v203, 1.0, v203
  v_mfma_f32_16x16x32_bf16 v[40:43], a[200:203], a[48:51], v[40:43]
  ds_read_b64_tr_b16 a[178:179], v233 offset:29184
  ds_read_b64_tr_b16 a[180:181], v233 offset:32768
  v_rcp_f32 v200, v200
  v_mfma_f32_16x16x32_bf16 v[40:43], a[204:207], a[56:59], v[40:43]
  s_waitcnt lgkmcnt(9)
  v_rcp_f32 v201, v201
  v_mfma_f32_16x16x32_bf16 v[40:43], a[144:147], a[64:67], v[40:43]
  buffer_load_dwordx4 v217, s[12:15], s35 offen offset:1024 sc1 lds
  v_mfma_f32_16x16x32_bf16 v[40:43], a[148:151], a[72:75], v[40:43]
  ds_read_b64_tr_b16 a[182:183], v233 offset:33280
  ds_read_b64_tr_b16 a[184:185], v233 offset:12288
  v_mfma_f32_16x16x32_bf16 v[40:43], a[152:155], a[80:83], v[40:43]
  ds_read_b64_tr_b16 a[186:187], v233 offset:12800
  ds_read_b64_tr_b16 a[188:189], v233 offset:16384
  v_rcp_f32 v202, v202
  v_mfma_f32_16x16x32_bf16 v[40:43], a[156:159], a[88:91], v[40:43]
  v_rcp_f32 v203, v203
  v_mfma_f32_16x16x32_bf16 v[44:47], a[200:203], a[52:55], v[44:47]
  ds_read_b64_tr_b16 a[190:191], v233 offset:16896
  ds_read_b64_tr_b16 a[192:193], v233 offset:20480
  v_mfma_f32_16x16x32_bf16 v[44:47], a[204:207], a[60:63], v[44:47]
  ds_read_b64_tr_b16 a[194:195], v233 offset:20992
  v_mul_f32 v104, v104, v200
  v_mfma_f32_16x16x32_bf16 v[44:47], a[144:147], a[68:71], v[44:47]
  ds_read_b64_tr_b16 a[196:197], v233 offset:36864
  v_mul_f32 v105, v105, v201
  v_mfma_f32_16x16x32_bf16 v[44:47], a[148:151], a[76:79], v[44:47]
  ds_read_b64_tr_b16 a[198:199], v233 offset:37376
  v_mul_f32 v106, v106, v202
  v_mul_f32 v107, v107, v203
  v_mfma_f32_16x16x32_bf16 v[44:47], a[152:155], a[84:87], v[44:47]
  ds_read_b64_tr_b16 a[200:201], v233 offset:40960
  ds_read_b64_tr_b16 a[202:203], v233 offset:41472
  v_cvt_pk_bf16_f32 v152, v104, v105
  v_mfma_f32_16x16x32_bf16 v[44:47], a[156:159], a[92:95], v[44:47]
  ds_read_b64_tr_b16 a[204:205], v233 offset:45056
  v_cvt_pk_bf16_f32 v153, v106, v107
  v_mfma_f32_16x16x32_bf16 v[48:51], a[160:163], a[48:51], v[48:51]
  s_waitcnt lgkmcnt(9)
  ds_read_b64_tr_b16 a[206:207], v233 offset:45568
  v_fma_f32 v200, -v100, v100, s37
  v_mfma_f32_16x16x32_bf16 v[48:51], a[164:167], a[56:59], v[48:51]
  v_fma_f32 v201, -v101, v101, s37
  v_fma_f32 v202, -v102, v102, s37
  v_mfma_f32_16x16x32_bf16 v[48:51], a[168:171], a[64:67], v[48:51]
  v_fma_f32 v203, -v103, v103, s37
  v_mul_f32 v200, v100, v200
  v_mfma_f32_16x16x32_bf16 v[48:51], a[172:175], a[72:75], v[48:51]
  v_mul_f32 v201, v101, v201
  v_mul_f32 v202, v102, v202
  v_mfma_f32_16x16x32_bf16 v[48:51], a[176:179], a[80:83], v[48:51]
  v_mul_f32 v203, v103, v203
  v_mfma_f32_16x16x32_bf16 v[48:51], a[180:183], a[88:91], v[48:51]
  v_exp_f32 v200, v200
  v_mfma_f32_16x16x32_bf16 v[52:55], a[160:163], a[52:55], v[52:55]
  v_exp_f32 v201, v201
  v_mfma_f32_16x16x32_bf16 v[52:55], a[164:167], a[60:63], v[52:55]
L_st15:
  s_waitcnt vmcnt(15) lgkmcnt(0)
  s_barrier
  ds_read_b64_tr_b16 a[144:145], v234 offset:0
  ds_read_b64_tr_b16 a[146:147], v234 offset:512
  v_mfma_f32_16x16x32_bf16 v[52:55], a[168:171], a[68:71], v[52:55]
  s_add_u32 m0, s29, 49152
  v_exp_f32 v202, v202
  v_mfma_f32_16x16x32_bf16 v[52:55], a[172:175], a[76:79], v[52:55]
  s_add_u32 s35, s31, 1769856
  ds_read_b64_tr_b16 a[148:149], v234 offset:4096
  ds_read_b64_tr_b16 a[150:151], v234 offset:4608
  v_mfma_f32_16x16x32_bf16 v[52:55], a[176:179], a[84:87], v[52:55]
  s_add_u32 s41, s40, 6016
  v_exp_f32 v203, v203
  v_mfma_f32_16x16x32_bf16 v[52:55], a[180:183], a[92:95], v[52:55]
  buffer_load_dword v239, v238, s[16:19], s41 offen
  v_mfma_f32_16x16x32_bf16 v[56:59], a[184:187], a[48:51], v[56:59]
  ds_read_b64_tr_b16 a[152:153], v234 offset:8192
  ds_read_b64_tr_b16 a[154:155], v234 offset:8704
  v_mfma_f32_16x16x32_bf16 v[56:59], a[188:191], a[56:59], v[56:59]
  buffer_load_dwordx4 v216, s[12:15], s35 offen sc1 lds
  v_mfma_f32_16x16x32_bf16 v[56:59], a[192:195], a[64:67], v[56:59]
  ds_read_b64_tr_b16 a[156:157], v234 offset:24576
  ds_read_b64_tr_b16 a[158:159], v234 offset:25088
  v_mfma_f32_16x16x32_bf16 v[56:59], a[196:199], a[72:75], v[56:59]
  ds_read_b64_tr_b16 a[160:161], v234 offset:28672
  v_mul_f32 v108, v100, v108
  v_mfma_f32_16x16x32_bf16 v[56:59], a[200:203], a[80:83], v[56:59]
  ds_read_b64_tr_b16 a[162:163], v234 offset:29184
  v_mul_f32 v109, v101, v109
  v_mfma_f32_16x16x32_bf16 v[56:59], a[204:207], a[88:91], v[56:59]
  ds_read_b64_tr_b16 a[164:165], v234 offset:32768
  v_mul_f32 v110, v102, v110
  v_mfma_f32_16x16x32_bf16 v[60:63], a[184:187], a[52:55], v[60:63]
  ds_read_b64_tr_b16 a[166:167], v234 offset:33280
  v_mul_f32 v111, v103, v111
  v_mfma_f32_16x16x32_bf16 v[60:63], a[188:191], a[60:63], v[60:63]
  buffer_load_dwordx4 v217, s[12:15], s35 offen offset:1024 sc1 lds
  v_add_f32 v200, 1.0, v200
  v_mfma_f32_16x16x32_bf16 v[60:63], a[192:195], a[68:71], v[60:63]
  ds_read_b64_tr_b16 a[168:169], v234 offset:12288
  ds_read_b64_tr_b16 a[170:171], v234 offset:12800
  v_add_f32 v201, 1.0, v201
  v_mfma_f32_16x16x32_bf16 v[60:63], a[196:199], a[76:79], v[60:63]
  ds_read_b64_tr_b16 a[172:173], v234 offset:16384
  v_add_f32 v202, 1.0, v202
  v_mfma_f32_16x16x32_bf16 v[60:63], a[200:203], a[84:87], v[60:63]
  ds_read_b64_tr_b16 a[174:175], v234 offset:16896
  v_add_f32 v203, 1.0, v203
  v_mfma_f32_16x16x32_bf16 v[60:63], a[204:207], a[92:95], v[60:63]
  s_waitcnt lgkmcnt(8)
  ds_read_b64_tr_b16 a[176:177], v234 offset:20480
  ds_read_b64_tr_b16 a[178:179], v234 offset:20992
  v_rcp_f32 v200, v200
  v_mfma_f32_16x16x32_bf16 v[0:3], a[144:147], a[96:99], v[0:3]
  v_rcp_f32 v201, v201
  v_mfma_f32_16x16x32_bf16 v[0:3], a[148:151], a[104:107], v[0:3]
  ds_read_b64_tr_b16 a[180:181], v234 offset:36864
  ds_read_b64_tr_b16 a[182:183], v234 offset:37376
  v_mfma_f32_16x16x32_bf16 v[0:3], a[152:155], a[112:115], v[0:3]
  buffer_load_dwordx4 v218, s[12:15], s35 offen offset:2048 sc1 lds
  v_mfma_f32_16x16x32_bf16 v[0:3], a[156:159], a[120:123], v[0:3]
  s_waitcnt lgkmcnt(8)
  ds_read_b64_tr_b16 a[184:185], v234 offset:40960
  ds_read_b64_tr_b16 a[186:187], v234 offset:41472
  v_rcp_f32 v202, v202
  v_mfma_f32_16x16x32_bf16 v[0:3], a[160:163], a[128:131], v[0:3]
  ds_read_b64_tr_b16 a[188:189], v234 offset:45056
  ds_read_b64_tr_b16 a[190:191], v234 offset:45568
  v_mfma_f32_16x16x32_bf16 v[64:67], a[164:167], a[136:139], v[0:3]
  v_rcp_f32 v203, v203
  v_mfma_f32_16x16x32_bf16 v[4:7], a[144:147], a[100:103], v[4:7]
  ds_read_b64_tr_b16 a[192:193], v235 offset:0
  v_mul_f32 v108, v108, v200
  v_mfma_f32_16x16x32_bf16 v[4:7], a[148:151], a[108:111], v[4:7]
  ds_read_b64_tr_b16 a[194:195], v235 offset:512
  v_mul_f32 v109, v109, v201
  v_mul_f32 v110, v110, v202
  v_mfma_f32_16x16x32_bf16 v[4:7], a[152:155], a[116:119], v[4:7]
  ds_read_b64_tr_b16 a[196:197], v235 offset:4096
  v_mul_f32 v111, v111, v203
  v_mfma_f32_16x16x32_bf16 v[4:7], a[156:159], a[124:127], v[4:7]
  buffer_load_dwordx4 v219, s[12:15], s35 offen offset:3072 sc1 lds
  v_cvt_pk_bf16_f32 v156, v108, v109
  v_mfma_f32_16x16x32_bf16 v[4:7], a[160:163], a[132:135], v[4:7]
  s_add_u32 m0, s29, 53248
  ds_read_b64_tr_b16 a[198:199], v235 offset:4608
  ds_read_b64_tr_b16 a[200:201], v235 offset:8192
  v_cvt_pk_bf16_f32 v157, v110, v111
  v_mfma_f32_16x16x32_bf16 v[68:71], a[164:167], a[140:143], v[4:7]
  s_waitcnt lgkmcnt(7)
  ds_read_b64_tr_b16 a[202:203], v235 offset:8704
  v_fma_f32 v200, -v112, v112, s37
  v_mfma_f32_16x16x32_bf16 v[8:11], a[168:171], a[96:99], v[8:11]
  s_add_u32 s35, s31, 2064768
  ds_read_b64_tr_b16 a[204:205], v235 offset:24576
  v_fma_f32 v201, -v113, v113, s37
  v_mfma_f32_16x16x32_bf16 v[8:11], a[172:175], a[104:107], v[8:11]
  ds_read_b64_tr_b16 a[206:207], v235 offset:25088
  v_fma_f32 v202, -v114, v114, s37
  v_mfma_f32_16x16x32_bf16 v[8:11], a[176:179], a[112:115], v[8:11]
  ds_read_b64_tr_b16 a[144:145], v235 offset:28672
  v_fma_f32 v203, -v115, v115, s37
  v_mfma_f32_16x16x32_bf16 v[8:11], a[180:183], a[120:123], v[8:11]
  buffer_load_dwordx4 v216, s[12:15], s35 offen sc1 lds
  v_mul_f32 v200, v112, v200
  v_mfma_f32_16x16x32_bf16 v[8:11], a[184:187], a[128:131], v[8:11]
  s_waitcnt lgkmcnt(7)
  ds_read_b64_tr_b16 a[146:147], v235 offset:29184
  ds_read_b64_tr_b16 a[148:149], v235 offset:32768
  v_mul_f32 v201, v113, v201
  v_mfma_f32_16x16x32_bf16 v[72:75], a[188:191], a[136:139], v[8:11]
  ds_read_b64_tr_b16 a[150:151], v235 offset:33280
  v_mul_f32 v202, v114, v202
  v_mul_f32 v203, v115, v203
  v_mfma_f32_16x16x32_bf16 v[12:15], a[168:171], a[100:103], v[12:15]
  ds_read_b64_tr_b16 a[152:153], v235 offset:12288
  ds_read_b64_tr_b16 a[154:155], v235 offset:12800
  v_mfma_f32_16x16x32_bf16 v[12:15], a[172:175], a[108:111], v[12:15]
  v_exp_f32 v200, v200
  v_mfma_f32_16x16x32_bf16 v[12:15], a[176:179], a[116:119], v[12:15]
  ds_read_b64_tr_b16 a[156:157], v235 offset:16384
  ds_read_b64_tr_b16 a[158:159], v235 offset:16896
  v_mfma_f32_16x16x32_bf16 v[12:15], a[180:183], a[124:127], v[12:15]
  v_exp_f32 v201, v201
  v_mfma_f32_16x16x32_bf16 v[12:15], a[184:187], a[132:135], v[12:15]
  buffer_load_dwordx4 v217, s[12:15], s35 offen offset:1024 sc1 lds
  v_mfma_f32_16x16x32_bf16 v[76:79], a[188:191], a[140:143], v[12:15]
  s_add_u32 m0, s29, 73728
  ds_read_b64_tr_b16 a[160:161], v235 offset:20480
  ds_read_b64_tr_b16 a[162:163], v235 offset:20992
  v_exp_f32 v202, v202
  v_mfma_f32_16x16x32_bf16 v[16:19], a[192:195], a[96:99], v[16:19]
  s_waitcnt lgkmcnt(8)
  ds_read_b64_tr_b16 a[164:165], v235 offset:36864
  ds_read_b64_tr_b16 a[166:167], v235 offset:37376
  v_mfma_f32_16x16x32_bf16 v[16:19], a[196:199], a[104:107], v[16:19]
  s_add_u32 s35, s31, 2654592
  v_exp_f32 v203, v203
  v_mfma_f32_16x16x32_bf16 v[16:19], a[200:203], a[112:115], v[16:19]
  ds_read_b64_tr_b16 a[168:169], v235 offset:40960
  v_mul_f32 v120, v112, v120
  v_mul_f32 v121, v113, v121
  v_mfma_f32_16x16x32_bf16 v[16:19], a[204:207], a[120:123], v[16:19]
  ds_read_b64_tr_b16 a[170:171], v235 offset:41472
  v_mul_f32 v122, v114, v122
  v_mfma_f32_16x16x32_bf16 v[16:19], a[144:147], a[128:131], v[16:19]
  s_waitcnt lgkmcnt(6)
  ds_read_b64_tr_b16 a[172:173], v235 offset:45056
  ds_read_b64_tr_b16 a[174:175], v235 offset:45568
  v_mul_f32 v123, v115, v123
  v_mfma_f32_16x16x32_bf16 v[80:83], a[148:151], a[136:139], v[16:19]
  buffer_load_dwordx4 v216, s[12:15], s35 offen sc1 lds
  v_add_f32 v200, 1.0, v200
  v_mfma_f32_16x16x32_bf16 v[20:23], a[192:195], a[100:103], v[20:23]
  ds_read_b64_tr_b16 a[176:177], v236 offset:0
  ds_read_b64_tr_b16 a[178:179], v236 offset:512
  v_add_f32 v201, 1.0, v201
  v_mfma_f32_16x16x32_bf16 v[20:23], a[196:199], a[108:111], v[20:23]
  ds_read_b64_tr_b16 a[180:181], v236 offset:4096
  v_add_f32 v202, 1.0, v202
  v_mfma_f32_16x16x32_bf16 v[20:23], a[200:203], a[116:119], v[20:23]
  ds_read_b64_tr_b16 a[182:183], v236 offset:4608
  v_add_f32 v203, 1.0, v203
  v_mfma_f32_16x16x32_bf16 v[20:23], a[204:207], a[124:127], v[20:23]
  ds_read_b64_tr_b16 a[184:185], v236 offset:8192
  ds_read_b64_tr_b16 a[186:187], v236 offset:8704
  v_mfma_f32_16x16x32_bf16 v[20:23], a[144:147], a[132:135], v[20:23]
  v_rcp_f32 v200, v200
  v_mfma_f32_16x16x32_bf16 v[84:87], a[148:151], a[140:143], v[20:23]
  buffer_load_dwordx4 v217, s[12:15], s35 offen offset:1024 sc1 lds
  v_mfma_f32_16x16x32_bf16 v[24:27], a[152:155], a[96:99], v[24:27]
  ds_read_b64_tr_b16 a[188:189], v236 offset:24576
  ds_read_b64_tr_b16 a[190:191], v236 offset:25088
  v_rcp_f32 v201, v201
  v_mfma_f32_16x16x32_bf16 v[24:27], a[156:159], a[104:107], v[24:27]
  s_waitcnt lgkmcnt(8)
  ds_read_b64_tr_b16 a[192:193], v236 offset:28672
  ds_read_b64_tr_b16 a[194:195], v236 offset:29184
  v_rcp_f32 v202, v202
  v_mfma_f32_16x16x32_bf16 v[24:27], a[160:163], a[112:115], v[24:27]
  v_rcp_f32 v203, v203
  v_mfma_f32_16x16x32_bf16 v[24:27], a[164:167], a[120:123], v[24:27]
  ds_read_b64_tr_b16 a[196:197], v236 offset:32768
  v_mul_f32 v120, v120, v200
  v_mfma_f32_16x16x32_bf16 v[24:27], a[168:171], a[128:131], v[24:27]
  ds_read_b64_tr_b16 a[198:199], v236 offset:33280
  v_mul_f32 v121, v121, v201
  v_mfma_f32_16x16x32_bf16 v[88:91], a[172:175], a[136:139], v[24:27]
  ds_read_b64_tr_b16 a[200:201], v236 offset:12288
  ds_read_b64_tr_b16 a[202:203], v236 offset:12800
  v_mfma_f32_16x16x32_bf16 v[28:31], a[152:155], a[100:103], v[28:31]
  buffer_load_dwordx4 v218, s[12:15], s35 offen offset:2048 sc1 lds
  v_mul_f32 v122, v122, v202
  v_mfma_f32_16x16x32_bf16 v[28:31], a[156:159], a[108:111], v[28:31]
  ds_read_b64_tr_b16 a[204:205], v236 offset:16384
  ds_read_b64_tr_b16 a[206:207], v236 offset:16896
  v_mul_f32 v123, v123, v203
  v_mfma_f32_16x16x32_bf16 v[28:31], a[160:163], a[116:119], v[28:31]
  ds_read_b64_tr_b16 a[144:145], v236 offset:20480
  v_cvt_pk_bf16_f32 v154, v120, v121
  v_mfma_f32_16x16x32_bf16 v[28:31], a[164:167], a[124:127], v[28:31]
  ds_read_b64_tr_b16 a[146:147], v236 offset:20992
  v_cvt_pk_bf16_f32 v155, v122, v123
  v_mfma_f32_16x16x32_bf16 v[28:31], a[168:171], a[132:135], v[28:31]
  ds_read_b64_tr_b16 a[148:149], v236 offset:36864
  ds_read_b64_tr_b16 a[150:151], v236 offset:37376
  v_mfma_f32_16x16x32_bf16 v[92:95], a[172:175], a[140:143], v[28:31]
  s_waitcnt lgkmcnt(10)
  buffer_store_dwordx4 v[152:155], v225, s[56:59], s28 offen offset:2048 sc1
  v_fma_f32 v200, -v116, v116, s37
  v_mfma_f32_16x16x32_bf16 v[32:35], a[176:179], a[96:99], v[32:35]
  ds_read_b64_tr_b16 a[152:153], v236 offset:40960
  v_fma_f32 v201, -v117, v117, s37
  v_mfma_f32_16x16x32_bf16 v[32:35], a[180:183], a[104:107], v[32:35]
  buffer_load_dwordx4 v219, s[12:15], s35 offen offset:3072 sc1 lds
  v_fma_f32 v202, -v118, v118, s37
  v_mfma_f32_16x16x32_bf16 v[32:35], a[184:187], a[112:115], v[32:35]
  s_add_u32 m0, s29, 77824
  ds_read_b64_tr_b16 a[154:155], v236 offset:41472
  ds_read_b64_tr_b16 a[156:157], v236 offset:45056
  v_fma_f32 v203, -v119, v119, s37
  v_mfma_f32_16x16x32_bf16 v[32:35], a[188:191], a[120:123], v[32:35]
  s_add_u32 s35, s31, 2949504
  ds_read_b64_tr_b16 a[158:159], v236 offset:45568
  v_mul_f32 v200, v116, v200
  v_mfma_f32_16x16x32_bf16 v[32:35], a[192:195], a[128:131], v[32:35]
  s_waitcnt lgkmcnt(8)
  ds_read_b64_tr_b16 a[160:161], v237 offset:0
  v_mul_f32 v201, v117, v201
  v_mfma_f32_16x16x32_bf16 v[96:99], a[196:199], a[136:139], v[32:35]
  ds_read_b64_tr_b16 a[162:163], v237 offset:512
  v_mul_f32 v202, v118, v202
  v_mfma_f32_16x16x32_bf16 v[36:39], a[176:179], a[100:103], v[36:39]
  ds_read_b64_tr_b16 a[164:165], v237 offset:4096
  ds_read_b64_tr_b16 a[166:167], v237 offset:4608
  v_mul_f32 v203, v119, v203
  v_mfma_f32_16x16x32_bf16 v[36:39], a[180:183], a[108:111], v[36:39]
  buffer_load_dwordx4 v216, s[12:15], s35 offen sc1 lds
  v_mfma_f32_16x16x32_bf16 v[36:39], a[184:187], a[116:119], v[36:39]
  ds_read_b64_tr_b16 a[168:169], v237 offset:8192
  ds_read_b64_tr_b16 a[170:171], v237 offset:8704
  v_exp_f32 v200, v200
  v_mfma_f32_16x16x32_bf16 v[36:39], a[188:191], a[124:127], v[36:39]
  ds_read_b64_tr_b16 a[172:173], v237 offset:24576
  ds_read_b64_tr_b16 a[174:175], v237 offset:25088
  v_exp_f32 v201, v201
  v_mfma_f32_16x16x32_bf16 v[36:39], a[192:195], a[132:135], v[36:39]
  v_exp_f32 v202, v202
  v_mfma_f32_16x16x32_bf16 v[100:103], a[196:199], a[140:143], v[36:39]
  ds_read_b64_tr_b16 a[176:177], v237 offset:28672
  ds_read_b64_tr_b16 a[178:179], v237 offset:29184
  v_mfma_f32_16x16x32_bf16 v[40:43], a[200:203], a[96:99], v[40:43]
  v_exp_f32 v203, v203
  v_mfma_f32_16x16x32_bf16 v[40:43], a[204:207], a[104:107], v[40:43]
  s_waitcnt lgkmcnt(8)
  ds_read_b64_tr_b16 a[180:181], v237 offset:32768
  v_mul_f32 v124, v116, v124
  v_mfma_f32_16x16x32_bf16 v[40:43], a[144:147], a[112:115], v[40:43]
  buffer_load_dwordx4 v217, s[12:15], s35 offen offset:1024 sc1 lds
  v_mfma_f32_16x16x32_bf16 v[40:43], a[148:151], a[120:123], v[40:43]
  ds_read_b64_tr_b16 a[182:183], v237 offset:33280
  ds_read_b64_tr_b16 a[184:185], v237 offset:12288
  v_mul_f32 v125, v117, v125
  v_mfma_f32_16x16x32_bf16 v[40:43], a[152:155], a[128:131], v[40:43]
  ds_read_b64_tr_b16 a[186:187], v237 offset:12800
  v_mul_f32 v126, v118, v126
  v_mfma_f32_16x16x32_bf16 v[104:107], a[156:159], a[136:139], v[40:43]
  ds_read_b64_tr_b16 a[188:189], v237 offset:16384
  v_mul_f32 v127, v119, v127
  v_mfma_f32_16x16x32_bf16 v[44:47], a[200:203], a[100:103], v[44:47]
  ds_read_b64_tr_b16 a[190:191], v237 offset:16896
  ds_read_b64_tr_b16 a[192:193], v237 offset:20480
  v_add_f32 v200, 1.0, v200
  v_mfma_f32_16x16x32_bf16 v[44:47], a[204:207], a[108:111], v[44:47]
  ds_read_b64_tr_b16 a[194:195], v237 offset:20992
  v_add_f32 v201, 1.0, v201
  v_add_f32 v202, 1.0, v202
  v_mfma_f32_16x16x32_bf16 v[44:47], a[144:147], a[116:119], v[44:47]
  ds_read_b64_tr_b16 a[196:197], v237 offset:36864
  v_add_f32 v203, 1.0, v203
  v_mfma_f32_16x16x32_bf16 v[44:47], a[148:151], a[124:127], v[44:47]
  ds_read_b64_tr_b16 a[198:199], v237 offset:37376
  ds_read_b64_tr_b16 a[200:201], v237 offset:40960
  v_mfma_f32_16x16x32_bf16 v[44:47], a[152:155], a[132:135], v[44:47]
  v_rcp_f32 v200, v200
  v_mfma_f32_16x16x32_bf16 v[108:111], a[156:159], a[140:143], v[44:47]
  ds_read_b64_tr_b16 a[202:203], v237 offset:41472
  ds_read_b64_tr_b16 a[204:205], v237 offset:45056
  v_mfma_f32_16x16x32_bf16 v[48:51], a[160:163], a[96:99], v[48:51]
  s_waitcnt lgkmcnt(9)
  ds_read_b64_tr_b16 a[206:207], v237 offset:45568
  v_rcp_f32 v201, v201
  v_mfma_f32_16x16x32_bf16 v[48:51], a[164:167], a[104:107], v[48:51]
  v_rcp_f32 v202, v202
  v_mfma_f32_16x16x32_bf16 v[48:51], a[168:171], a[112:115], v[48:51]
  v_rcp_f32 v203, v203
  v_mfma_f32_16x16x32_bf16 v[48:51], a[172:175], a[120:123], v[48:51]
  v_mul_f32 v124, v124, v200
  v_mul_f32 v125, v125, v201
  v_mfma_f32_16x16x32_bf16 v[48:51], a[176:179], a[128:131], v[48:51]
  v_mul_f32 v126, v126, v202
  v_mul_f32 v127, v127, v203
  v_mfma_f32_16x16x32_bf16 v[112:115], a[180:183], a[136:139], v[48:51]
  v_cvt_pk_bf16_f32 v158, v124, v125
  v_cvt_pk_bf16_f32 v159, v126, v127
  v_mfma_f32_16x16x32_bf16 v[52:55], a[160:163], a[100:103], v[52:55]
  buffer_store_dwordx4 v[156:159], v225, s[56:59], s28 offen offset:3072 sc1
  v_mfma_f32_16x16x32_bf16 v[52:55], a[164:167], a[108:111], v[52:55]
L_st17:
  s_waitcnt vmcnt(15) lgkmcnt(0)
  s_barrier
  ds_read_b64_tr_b16 a[144:145], v226 offset:0
  v_fma_f32 v200, -v64, v64, s37
  v_mfma_f32_16x16x32_bf16 v[52:55], a[168:171], a[116:119], v[52:55]
  s_add_u32 m0, s29, 98304
  ds_read_b64_tr_b16 a[146:147], v226 offset:512
  v_fma_f32 v201, -v65, v65, s37
  v_mfma_f32_16x16x32_bf16 v[52:55], a[172:175], a[124:127], v[52:55]
  s_add_u32 s35, s31, 3539328
  ds_read_b64_tr_b16 a[148:149], v226 offset:4096
  v_fma_f32 v202, -v66, v66, s37
  v_mfma_f32_16x16x32_bf16 v[52:55], a[176:179], a[132:135], v[52:55]
  s_mov_b32 s41, L_st23-L_common
  ds_read_b64_tr_b16 a[150:151], v226 offset:4608
  v_fma_f32 v203, -v67, v67, s37
  v_mfma_f32_16x16x32_bf16 v[116:119], a[180:183], a[140:143], v[52:55]
  buffer_load_dword v239, v214, s[52:55], s41 offen
  v_mfma_f32_16x16x32_bf16 v[56:59], a[184:187], a[96:99], v[56:59]
  ds_read_b64_tr_b16 a[152:153], v226 offset:8192
  ds_read_b64_tr_b16 a[154:155], v226 offset:8704
  v_mfma_f32_16x16x32_bf16 v[56:59], a[188:191], a[104:107], v[56:59]
  buffer_load_dwordx4 v216, s[12:15], s35 offen sc1 lds
  v_mfma_f32_16x16x32_bf16 v[56:59], a[192:195], a[112:115], v[56:59]
  ds_read_b64_tr_b16 a[156:157], v226 offset:24576
  ds_read_b64_tr_b16 a[158:159], v226 offset:25088
  v_mfma_f32_16x16x32_bf16 v[56:59], a[196:199], a[120:123], v[56:59]
  ds_read_b64_tr_b16 a[160:161], v226 offset:28672
  v_mul_f32 v200, v64, v200
  v_mfma_f32_16x16x32_bf16 v[56:59], a[200:203], a[128:131], v[56:59]
  ds_read_b64_tr_b16 a[162:163], v226 offset:29184
  v_mul_f32 v201, v65, v201
  v_mfma_f32_16x16x32_bf16 v[120:123], a[204:207], a[136:139], v[56:59]
  ds_read_b64_tr_b16 a[164:165], v226 offset:32768
  v_mul_f32 v202, v66, v202
  v_mfma_f32_16x16x32_bf16 v[60:63], a[184:187], a[100:103], v[60:63]
  ds_read_b64_tr_b16 a[166:167], v226 offset:33280
  v_mul_f32 v203, v67, v203
  v_mfma_f32_16x16x32_bf16 v[60:63], a[188:191], a[108:111], v[60:63]
  buffer_load_dwordx4 v217, s[12:15], s35 offen offset:1024 sc1 lds
  v_mfma_f32_16x16x32_bf16 v[60:63], a[192:195], a[116:119], v[60:63]
  ds_read_b64_tr_b16 a[168:169], v226 offset:12288
  ds_read_b64_tr_b16 a[170:171], v226 offset:12800
  v_mfma_f32_16x16x32_bf16 v[60:63], a[196:199], a[124:127], v[60:63]
  ds_read_b64_tr_b16 a[172:173], v226 offset:16384
  ds_read_b64_tr_b16 a[174:175], v226 offset:16896
  v_mfma_f32_16x16x32_bf16 v[60:63], a[200:203], a[132:135], v[60:63]
  v_exp_f32 v200, v200
  v_mfma_f32_16x16x32_bf16 v[124:127], a[204:207], a[140:143], v[60:63]
  s_waitcnt lgkmcnt(8)
  ds_read_b64_tr_b16 a[176:177], v226 offset:20480
  ds_read_b64_tr_b16 a[178:179], v226 offset:20992
  v_mfma_f32_16x16x32_bf16 v[0:3], a[144:147], a[0:3], 0
  v_exp_f32 v201, v201
  v_mfma_f32_16x16x32_bf16 v[0:3], a[148:151], a[8:11], v[0:3]
  ds_read_b64_tr_b16 a[180:181], v226 offset:36864
  ds_read_b64_tr_b16 a[182:183], v226 offset:37376
  v_mfma_f32_16x16x32_bf16 v[0:3], a[152:155], a[16:19], v[0:3]
  buffer_load_dwordx4 v218, s[12:15], s35 offen offset:2048 sc1 lds
  v_mfma_f32_16x16x32_bf16 v[0:3], a[156:159], a[24:27], v[0:3]
  s_waitcnt lgkmcnt(8)
  ds_read_b64_tr_b16 a[184:185], v226 offset:40960
  ds_read_b64_tr_b16 a[186:187], v226 offset:41472
  v_exp_f32 v202, v202
  v_mfma_f32_16x16x32_bf16 v[0:3], a[160:163], a[32:35], v[0:3]
  ds_read_b64_tr_b16 a[188:189], v226 offset:45056
  ds_read_b64_tr_b16 a[190:191], v226 offset:45568
  v_mfma_f32_16x16x32_bf16 v[0:3], a[164:167], a[40:43], v[0:3]
  v_exp_f32 v203, v203
  v_mfma_f32_16x16x32_bf16 v[4:7], a[144:147], a[4:7], 0
  ds_read_b64_tr_b16 a[192:193], v227 offset:0
  v_mul_f32 v72, v64, v72
  v_mfma_f32_16x16x32_bf16 v[4:7], a[148:151], a[12:15], v[4:7]
  ds_read_b64_tr_b16 a[194:195], v227 offset:512
  v_mul_f32 v73, v65, v73
  v_mfma_f32_16x16x32_bf16 v[4:7], a[152:155], a[20:23], v[4:7]
  ds_read_b64_tr_b16 a[196:197], v227 offset:4096
  v_mul_f32 v74, v66, v74
  v_mfma_f32_16x16x32_bf16 v[4:7], a[156:159], a[28:31], v[4:7]
  buffer_load_dwordx4 v219, s[12:15], s35 offen offset:3072 sc1 lds
  v_mul_f32 v75, v67, v75
  v_mfma_f32_16x16x32_bf16 v[4:7], a[160:163], a[36:39], v[4:7]
  s_add_u32 m0, s29, 102400
  ds_read_b64_tr_b16 a[198:199], v227 offset:4608
  ds_read_b64_tr_b16 a[200:201], v227 offset:8192
  v_add_f32 v200, 1.0, v200
  v_mfma_f32_16x16x32_bf16 v[4:7], a[164:167], a[44:47], v[4:7]
  s_waitcnt lgkmcnt(7)
  ds_read_b64_tr_b16 a[202:203], v227 offset:8704
  v_add_f32 v201, 1.0, v201
  v_add_f32 v202, 1.0, v202
  v_mfma_f32_16x16x32_bf16 v[8:11], a[168:171], a[0:3], 0
  s_add_u32 s35, s31, 3834240
  ds_read_b64_tr_b16 a[204:205], v227 offset:24576
  v_add_f32 v203, 1.0, v203
  v_mfma_f32_16x16x32_bf16 v[8:11], a[172:175], a[8:11], v[8:11]
  ds_read_b64_tr_b16 a[206:207], v227 offset:25088
  ds_read_b64_tr_b16 a[144:145], v227 offset:28672
  v_mfma_f32_16x16x32_bf16 v[8:11], a[176:179], a[16:19], v[8:11]
  v_rcp_f32 v200, v200
  v_mfma_f32_16x16x32_bf16 v[8:11], a[180:183], a[24:27], v[8:11]
  buffer_load_dwordx4 v216, s[12:15], s35 offen sc1 lds
  v_mfma_f32_16x16x32_bf16 v[8:11], a[184:187], a[32:35], v[8:11]
  s_waitcnt lgkmcnt(7)
  ds_read_b64_tr_b16 a[146:147], v227 offset:29184
  ds_read_b64_tr_b16 a[148:149], v227 offset:32768
  v_rcp_f32 v201, v201
  v_mfma_f32_16x16x32_bf16 v[8:11], a[188:191], a[40:43], v[8:11]
  ds_read_b64_tr_b16 a[150:151], v227 offset:33280
  ds_read_b64_tr_b16 a[152:153], v227 offset:12288
  v_mfma_f32_16x16x32_bf16 v[12:15], a[168:171], a[4:7], 0
  v_rcp_f32 v202, v202
  v_mfma_f32_16x16x32_bf16 v[12:15], a[172:175], a[12:15], v[12:15]
  ds_read_b64_tr_b16 a[154:155], v227 offset:12800
  ds_read_b64_tr_b16 a[156:157], v227 offset:16384
  v_mfma_f32_16x16x32_bf16 v[12:15], a[176:179], a[20:23], v[12:15]
  v_rcp_f32 v203, v203
  v_mfma_f32_16x16x32_bf16 v[12:15], a[180:183], a[28:31], v[12:15]
  ds_read_b64_tr_b16 a[158:159], v227 offset:16896
  v_mul_f32 v72, v72, v200
  v_mul_f32 v73, v73, v201
  v_mfma_f32_16x16x32_bf16 v[12:15], a[184:187], a[36:39], v[12:15]
  buffer_load_dwordx4 v217, s[12:15], s35 offen offset:1024 sc1 lds
  v_mul_f32 v74, v74, v202
  v_mfma_f32_16x16x32_bf16 v[12:15], a[188:191], a[44:47], v[12:15]
  s_add_u32 m0, s29, 122880
  ds_read_b64_tr_b16 a[160:161], v227 offset:20480
  ds_read_b64_tr_b16 a[162:163], v227 offset:20992
  v_mul_f32 v75, v75, v203
  v_mfma_f32_16x16x32_bf16 v[16:19], a[192:195], a[0:3], 0
  s_waitcnt lgkmcnt(8)
  ds_read_b64_tr_b16 a[164:165], v227 offset:36864
  v_cvt_pk_bf16_f32 v160, v72, v73
  v_mfma_f32_16x16x32_bf16 v[16:19], a[196:199], a[8:11], v[16:19]
  s_add_u32 s35, s31, 4424064
  ds_read_b64_tr_b16 a[166:167], v227 offset:37376
  v_cvt_pk_bf16_f32 v161, v74, v75
  v_mfma_f32_16x16x32_bf16 v[16:19], a[200:203], a[16:19], v[16:19]
  ds_read_b64_tr_b16 a[168:169], v227 offset:40960
  v_fma_f32 v200, -v68, v68, s37
  v_mfma_f32_16x16x32_bf16 v[16:19], a[204:207], a[24:27], v[16:19]
  ds_read_b64_tr_b16 a[170:171], v227 offset:41472
  v_fma_f32 v201, -v69, v69, s37
  v_mfma_f32_16x16x32_bf16 v[16:19], a[144:147], a[32:35], v[16:19]
  s_waitcnt lgkmcnt(8)
  ds_read_b64_tr_b16 a[172:173], v227 offset:45056
  ds_read_b64_tr_b16 a[174:175], v227 offset:45568
  v_fma_f32 v202, -v70, v70, s37
  v_mfma_f32_16x16x32_bf16 v[16:19], a[148:151], a[40:43], v[16:19]
  buffer_load_dwordx4 v216, s[12:15], s35 offen sc1 lds
  v_fma_f32 v203, -v71, v71, s37
  v_mfma_f32_16x16x32_bf16 v[20:23], a[192:195], a[4:7], 0
  ds_read_b64_tr_b16 a[176:177], v228 offset:0
  ds_read_b64_tr_b16 a[178:179], v228 offset:512
  v_mul_f32 v200, v68, v200
  v_mfma_f32_16x16x32_bf16 v[20:23], a[196:199], a[12:15], v[20:23]
  ds_read_b64_tr_b16 a[180:181], v228 offset:4096
  v_mul_f32 v201, v69, v201
  v_mul_f32 v202, v70, v202
  v_mfma_f32_16x16x32_bf16 v[20:23], a[200:203], a[20:23], v[20:23]
  ds_read_b64_tr_b16 a[182:183], v228 offset:4608
  v_mul_f32 v203, v71, v203
  v_mfma_f32_16x16x32_bf16 v[20:23], a[204:207], a[28:31], v[20:23]
  ds_read_b64_tr_b16 a[184:185], v228 offset:8192
  ds_read_b64_tr_b16 a[186:187], v228 offset:8704
  v_mfma_f32_16x16x32_bf16 v[20:23], a[144:147], a[36:39], v[20:23]
  v_exp_f32 v200, v200
  v_mfma_f32_16x16x32_bf16 v[20:23], a[148:151], a[44:47], v[20:23]
  buffer_load_dwordx4 v217, s[12:15], s35 offen offset:1024 sc1 lds
  v_mfma_f32_16x16x32_bf16 v[24:27], a[152:155], a[0:3], 0
  s_waitcnt lgkmcnt(6)
  ds_read_b64_tr_b16 a[188:189], v228 offset:24576
  ds_read_b64_tr_b16 a[190:191], v228 offset:25088
  v_exp_f32 v201, v201
  v_mfma_f32_16x16x32_bf16 v[24:27], a[156:159], a[8:11], v[24:27]
  ds_read_b64_tr_b16 a[192:193], v228 offset:28672
  ds_read_b64_tr_b16 a[194:195], v228 offset:29184
  v_mfma_f32_16x16x32_bf16 v[24:27], a[160:163], a[16:19], v[24:27]
  v_exp_f32 v202, v202
  v_mfma_f32_16x16x32_bf16 v[24:27], a[164:167], a[24:27], v[24:27]
  ds_read_b64_tr_b16 a[196:197], v228 offset:32768
  ds_read_b64_tr_b16 a[198:199], v228 offset:33280
  v_mfma_f32_16x16x32_bf16 v[24:27], a[168:171], a[32:35], v[24:27]
  v_exp_f32 v203, v203
  v_mfma_f32_16x16x32_bf16 v[24:27], a[172:175], a[40:43], v[24:27]
  ds_read_b64_tr_b16 a[200:201], v228 offset:12288
  ds_read_b64_tr_b16 a[202:203], v228 offset:12800
  v_mul_f32 v76, v68, v76
  v_mfma_f32_16x16x32_bf16 v[28:31], a[152:155], a[4:7], 0
  buffer_load_dwordx4 v218, s[12:15], s35 offen offset:2048 sc1 lds
  v_mul_f32 v77, v69, v77
  v_mfma_f32_16x16x32_bf16 v[28:31], a[156:159], a[12:15], v[28:31]
  ds_read_b64_tr_b16 a[204:205], v228 offset:16384
  ds_read_b64_tr_b16 a[206:207], v228 offset:16896
  v_mul_f32 v78, v70, v78
  v_mfma_f32_16x16x32_bf16 v[28:31], a[160:163], a[20:23], v[28:31]
  ds_read_b64_tr_b16 a[144:145], v228 offset:20480
  v_mul_f32 v79, v71, v79
  v_add_f32 v200, 1.0, v200
  v_mfma_f32_16x16x32_bf16 v[28:31], a[164:167], a[28:31], v[28:31]
  ds_read_b64_tr_b16 a[146:147], v228 offset:20992
  v_add_f32 v201, 1.0, v201
  v_mfma_f32_16x16x32_bf16 v[28:31], a[168:171], a[36:39], v[28:31]
  ds_read_b64_tr_b16 a[148:149], v228 offset:36864
  v_add_f32 v202, 1.0, v202
  v_mfma_f32_16x16x32_bf16 v[28:31], a[172:175], a[44:47], v[28:31]
  s_waitcnt lgkmcnt(7)
  ds_read_b64_tr_b16 a[150:151], v228 offset:37376
  v_add_f32 v203, 1.0, v203
  v_mfma_f32_16x16x32_bf16 v[32:35], a[176:179], a[0:3], 0
  ds_read_b64_tr_b16 a[152:153], v228 offset:40960
  ds_read_b64_tr_b16 a[154:155], v228 offset:41472
  v_mfma_f32_16x16x32_bf16 v[32:35], a[180:183], a[8:11], v[32:35]
  buffer_load_dwordx4 v219, s[12:15], s35 offen offset:3072 sc1 lds
  v_rcp_f32 v200, v200
  v_mfma_f32_16x16x32_bf16 v[32:35], a[184:187], a[16:19], v[32:35]
  s_add_u32 m0, s29, 126976
  ds_read_b64_tr_b16 a[156:157], v228 offset:45056
  ds_read_b64_tr_b16 a[158:159], v228 offset:45568
  v_mfma_f32_16x16x32_bf16 v[32:35], a[188:191], a[24:27], v[32:35]
  s_add_u32 s35, s31, 4718976
  ds_read_b64_tr_b16 a[160:161], v229 offset:0
  ds_read_b64_tr_b16 a[162:163], v229 offset:512
  v_rcp_f32 v201, v201
  v_mfma_f32_16x16x32_bf16 v[32:35], a[192:195], a[32:35], v[32:35]
  v_rcp_f32 v202, v202
  v_mfma_f32_16x16x32_bf16 v[32:35], a[196:199], a[40:43], v[32:35]
  ds_read_b64_tr_b16 a[164:165], v229 offset:4096
  ds_read_b64_tr_b16 a[166:167], v229 offset:4608
  v_mfma_f32_16x16x32_bf16 v[36:39], a[176:179], a[4:7], 0
  v_rcp_f32 v203, v203
  v_mfma_f32_16x16x32_bf16 v[36:39], a[180:183], a[12:15], v[36:39]
  buffer_load_dwordx4 v216, s[12:15], s35 offen sc1 lds
  v_mul_f32 v76, v76, v200
  v_mfma_f32_16x16x32_bf16 v[36:39], a[184:187], a[20:23], v[36:39]
  ds_read_b64_tr_b16 a[168:169], v229 offset:8192
  ds_read_b64_tr_b16 a[170:171], v229 offset:8704
  v_mul_f32 v77, v77, v201
  v_mfma_f32_16x16x32_bf16 v[36:39], a[188:191], a[28:31], v[36:39]
  ds_read_b64_tr_b16 a[172:173], v229 offset:24576
  v_mul_f32 v78, v78, v202
  v_mfma_f32_16x16x32_bf16 v[36:39], a[192:195], a[36:39], v[36:39]
  ds_read_b64_tr_b16 a[174:175], v229 offset:25088
  v_mul_f32 v79, v79, v203
  v_mfma_f32_16x16x32_bf16 v[36:39], a[196:199], a[44:47], v[36:39]
  s_waitcnt lgkmcnt(8)
  ds_read_b64_tr_b16 a[176:177], v229 offset:28672
  v_cvt_pk_bf16_f32 v164, v76, v77
  v_mfma_f32_16x16x32_bf16 v[40:43], a[200:203], a[0:3], 0
  ds_read_b64_tr_b16 a[178:179], v229 offset:29184
  ds_read_b64_tr_b16 a[180:181], v229 offset:32768
  v_cvt_pk_bf16_f32 v165, v78, v79
  v_mfma_f32_16x16x32_bf16 v[40:43], a[204:207], a[8:11], v[40:43]
  ds_read_b64_tr_b16 a[182:183], v229 offset:33280
  v_fma_f32 v200, -v80, v80, s37
  v_fma_f32 v201, -v81, v81, s37
  v_mfma_f32_16x16x32_bf16 v[40:43], a[144:147], a[16:19], v[40:43]
  buffer_load_dwordx4 v217, s[12:15], s35 offen offset:1024 sc1 lds
  v_fma_f32 v202, -v82, v82, s37
  v_mfma_f32_16x16x32_bf16 v[40:43], a[148:151], a[24:27], v[40:43]
  ds_read_b64_tr_b16 a[184:185], v229 offset:12288
  ds_read_b64_tr_b16 a[186:187], v229 offset:12800
  v_fma_f32 v203, -v83, v83, s37
  v_mfma_f32_16x16x32_bf16 v[40:43], a[152:155], a[32:35], v[40:43]
  ds_read_b64_tr_b16 a[188:189], v229 offset:16384
  v_mul_f32 v200, v80, v200
  v_mfma_f32_16x16x32_bf16 v[40:43], a[156:159], a[40:43], v[40:43]
  ds_read_b64_tr_b16 a[190:191], v229 offset:16896
  v_mul_f32 v201, v81, v201
  v_mfma_f32_16x16x32_bf16 v[44:47], a[200:203], a[4:7], 0
  ds_read_b64_tr_b16 a[192:193], v229 offset:20480
  v_mul_f32 v202, v82, v202
  v_mfma_f32_16x16x32_bf16 v[44:47], a[204:207], a[12:15], v[44:47]
  ds_read_b64_tr_b16 a[194:195], v229 offset:20992
  v_mul_f32 v203, v83, v203
  v_mfma_f32_16x16x32_bf16 v[44:47], a[144:147], a[20:23], v[44:47]
  ds_read_b64_tr_b16 a[196:197], v229 offset:36864
  ds_read_b64_tr_b16 a[198:199], v229 offset:37376
  v_mfma_f32_16x16x32_bf16 v[44:47], a[148:151], a[28:31], v[44:47]
  ds_read_b64_tr_b16 a[200:201], v229 offset:40960
  ds_read_b64_tr_b16 a[202:203], v229 offset:41472
  v_exp_f32 v200, v200
  v_mfma_f32_16x16x32_bf16 v[44:47], a[152:155], a[36:39], v[44:47]
  v_exp_f32 v201, v201
  v_mfma_f32_16x16x32_bf16 v[44:47], a[156:159], a[44:47], v[44:47]
  s_waitcnt lgkmcnt(10)
  v_exp_f32 v202, v202
  v_mfma_f32_16x16x32_bf16 v[48:51], a[160:163], a[0:3], 0
  ds_read_b64_tr_b16 a[204:205], v229 offset:45056
  ds_read_b64_tr_b16 a[206:207], v229 offset:45568
  v_mfma_f32_16x16x32_bf16 v[48:51], a[164:167], a[8:11], v[48:51]
  v_exp_f32 v203, v203
  v_mfma_f32_16x16x32_bf16 v[48:51], a[168:171], a[16:19], v[48:51]
  v_mul_f32 v88, v80, v88
  v_mul_f32 v89, v81, v89
  v_mfma_f32_16x16x32_bf16 v[48:51], a[172:175], a[24:27], v[48:51]
  v_mul_f32 v90, v82, v90
  v_mul_f32 v91, v83, v91
  v_mfma_f32_16x16x32_bf16 v[48:51], a[176:179], a[32:35], v[48:51]
  v_add_f32 v200, 1.0, v200
  v_add_f32 v201, 1.0, v201
  v_mfma_f32_16x16x32_bf16 v[48:51], a[180:183], a[40:43], v[48:51]
  v_add_f32 v202, 1.0, v202
  v_add_f32 v203, 1.0, v203
  v_mfma_f32_16x16x32_bf16 v[52:55], a[160:163], a[4:7], 0
  v_rcp_f32 v200, v200
  v_mfma_f32_16x16x32_bf16 v[52:55], a[164:167], a[12:15], v[52:55]
L_st19:
  s_waitcnt vmcnt(14) lgkmcnt(0)
  s_barrier
  ds_read_b64_tr_b16 a[144:145], v230 offset:0
  ds_read_b64_tr_b16 a[146:147], v230 offset:512
  v_mfma_f32_16x16x32_bf16 v[52:55], a[168:171], a[20:23], v[52:55]
  s_add_u32 m0, s29, 0
  v_rcp_f32 v201, v201
  v_mfma_f32_16x16x32_bf16 v[52:55], a[172:175], a[28:31], v[52:55]
  s_add_u32 s35, s32, 0
  ds_read_b64_tr_b16 a[148:149], v230 offset:4096
  ds_read_b64_tr_b16 a[150:151], v230 offset:4608
  v_mfma_f32_16x16x32_bf16 v[52:55], a[176:179], a[36:39], v[52:55]
  v_rcp_f32 v202, v202
  v_mfma_f32_16x16x32_bf16 v[52:55], a[180:183], a[44:47], v[52:55]
  ds_read_b64_tr_b16 a[152:153], v230 offset:8192
  ds_read_b64_tr_b16 a[154:155], v230 offset:8704
  v_mfma_f32_16x16x32_bf16 v[56:59], a[184:187], a[0:3], 0
  v_rcp_f32 v203, v203
  v_mfma_f32_16x16x32_bf16 v[56:59], a[188:191], a[8:11], v[56:59]
  buffer_load_dwordx4 v220, s[12:15], s35 offen sc1 lds
  v_mfma_f32_16x16x32_bf16 v[56:59], a[192:195], a[16:19], v[56:59]
  ds_read_b64_tr_b16 a[156:157], v230 offset:24576
  ds_read_b64_tr_b16 a[158:159], v230 offset:25088
  v_mfma_f32_16x16x32_bf16 v[56:59], a[196:199], a[24:27], v[56:59]
  ds_read_b64_tr_b16 a[160:161], v230 offset:28672
  v_mul_f32 v88, v88, v200
  v_mfma_f32_16x16x32_bf16 v[56:59], a[200:203], a[32:35], v[56:59]
  ds_read_b64_tr_b16 a[162:163], v230 offset:29184
  v_mul_f32 v89, v89, v201
  v_mfma_f32_16x16x32_bf16 v[56:59], a[204:207], a[40:43], v[56:59]
  ds_read_b64_tr_b16 a[164:165], v230 offset:32768
  v_mul_f32 v90, v90, v202
  v_mfma_f32_16x16x32_bf16 v[60:63], a[184:187], a[4:7], 0
  ds_read_b64_tr_b16 a[166:167], v230 offset:33280
  v_mul_f32 v91, v91, v203
  v_mfma_f32_16x16x32_bf16 v[60:63], a[188:191], a[12:15], v[60:63]
  buffer_load_dwordx4 v221, s[12:15], s35 offen offset:1024 sc1 lds
  v_mfma_f32_16x16x32_bf16 v[60:63], a[192:195], a[20:23], v[60:63]
  ds_read_b64_tr_b16 a[168:169], v230 offset:12288
  ds_read_b64_tr_b16 a[170:171], v230 offset:12800
  v_mfma_f32_16x16x32_bf16 v[60:63], a[196:199], a[28:31], v[60:63]
  ds_read_b64_tr_b16 a[172:173], v230 offset:16384
  v_cvt_pk_bf16_f32 v162, v88, v89
  v_mfma_f32_16x16x32_bf16 v[60:63], a[200:203], a[36:39], v[60:63]
  ds_read_b64_tr_b16 a[174:175], v230 offset:16896
  v_cvt_pk_bf16_f32 v163, v90, v91
  v_mfma_f32_16x16x32_bf16 v[60:63], a[204:207], a[44:47], v[60:63]
  s_waitcnt lgkmcnt(8)
  ds_read_b64_tr_b16 a[176:177], v230 offset:20480
  v_mfma_f32_16x16x32_bf16 v[0:3], a[144:147], a[48:51], v[0:3]
  s_add_u32 s28, s76, 8192
  ds_read_b64_tr_b16 a[178:179], v230 offset:20992
  ds_read_b64_tr_b16 a[180:181], v230 offset:36864
  buffer_store_dwordx4 v[160:163], v225, s[56:59], s28 offen sc1
  v_mfma_f32_16x16x32_bf16 v[0:3], a[148:151], a[56:59], v[0:3]
  v_fma_f32 v200, -v84, v84, s37
  v_fma_f32 v201, -v85, v85, s37
  v_mfma_f32_16x16x32_bf16 v[0:3], a[152:155], a[64:67], v[0:3]
  buffer_load_dwordx4 v222, s[12:15], s35 offen offset:2048 sc1 lds
  v_mfma_f32_16x16x32_bf16 v[0:3], a[156:159], a[72:75], v[0:3]
  s_waitcnt lgkmcnt(7)
  ds_read_b64_tr_b16 a[182:183], v230 offset:37376
  ds_read_b64_tr_b16 a[184:185], v230 offset:40960
  v_fma_f32 v202, -v86, v86, s37
  v_mfma_f32_16x16x32_bf16 v[0:3], a[160:163], a[80:83], v[0:3]
  ds_read_b64_tr_b16 a[186:187], v230 offset:41472
  v_fma_f32 v203, -v87, v87, s37
  v_mfma_f32_16x16x32_bf16 v[0:3], a[164:167], a[88:91], v[0:3]
  ds_read_b64_tr_b16 a[188:189], v230 offset:45056
  v_mul_f32 v200, v84, v200
  v_mfma_f32_16x16x32_bf16 v[4:7], a[144:147], a[52:55], v[4:7]
  ds_read_b64_tr_b16 a[190:191], v230 offset:45568
  v_mul_f32 v201, v85, v201
  v_mfma_f32_16x16x32_bf16 v[4:7], a[148:151], a[60:63], v[4:7]
  ds_read_b64_tr_b16 a[192:193], v231 offset:0
  v_mul_f32 v202, v86, v202
  v_mfma_f32_16x16x32_bf16 v[4:7], a[152:155], a[68:71], v[4:7]
  ds_read_b64_tr_b16 a[194:195], v231 offset:512
  v_mul_f32 v203, v87, v203
  v_mfma_f32_16x16x32_bf16 v[4:7], a[156:159], a[76:79], v[4:7]
  buffer_load_dwordx4 v223, s[12:15], s35 offen offset:3072 sc1 lds
  v_mfma_f32_16x16x32_bf16 v[4:7], a[160:163], a[84:87], v[4:7]
  s_add_u32 m0, s29, 4096
  ds_read_b64_tr_b16 a[196:197], v231 offset:4096
  ds_read_b64_tr_b16 a[198:199], v231 offset:4608
  v_exp_f32 v200, v200
  v_mfma_f32_16x16x32_bf16 v[4:7], a[164:167], a[92:95], v[4:7]
  s_waitcnt lgkmcnt(8)
  ds_read_b64_tr_b16 a[200:201], v231 offset:8192
  ds_read_b64_tr_b16 a[202:203], v231 offset:8704
  v_exp_f32 v201, v201
  v_mfma_f32_16x16x32_bf16 v[8:11], a[168:171], a[48:51], v[8:11]
  s_add_u32 s35, s32, 589824
  v_exp_f32 v202, v202
  v_mfma_f32_16x16x32_bf16 v[8:11], a[172:175], a[56:59], v[8:11]
  ds_read_b64_tr_b16 a[204:205], v231 offset:24576
  ds_read_b64_tr_b16 a[206:207], v231 offset:25088
  v_mfma_f32_16x16x32_bf16 v[8:11], a[176:179], a[64:67], v[8:11]
  v_exp_f32 v203, v203
  v_mfma_f32_16x16x32_bf16 v[8:11], a[180:183], a[72:75], v[8:11]
  s_waitcnt lgkmcnt(8)
  ds_read_b64_tr_b16 a[144:145], v231 offset:28672
  ds_read_b64_tr_b16 a[146:147], v231 offset:29184
  v_mfma_f32_16x16x32_bf16 v[8:11], a[184:187], a[80:83], v[8:11]
  buffer_load_dwordx4 v220, s[12:15], s35 offen sc1 lds
  v_mul_f32 v92, v84, v92
  v_mfma_f32_16x16x32_bf16 v[8:11], a[188:191], a[88:91], v[8:11]
  ds_read_b64_tr_b16 a[148:149], v231 offset:32768
  ds_read_b64_tr_b16 a[150:151], v231 offset:33280
  v_mul_f32 v93, v85, v93
  v_mfma_f32_16x16x32_bf16 v[12:15], a[168:171], a[52:55], v[12:15]
  ds_read_b64_tr_b16 a[152:153], v231 offset:12288
  v_mul_f32 v94, v86, v94
  v_mfma_f32_16x16x32_bf16 v[12:15], a[172:175], a[60:63], v[12:15]
  ds_read_b64_tr_b16 a[154:155], v231 offset:12800
  v_mul_f32 v95, v87, v95
  v_mfma_f32_16x16x32_bf16 v[12:15], a[176:179], a[68:71], v[12:15]
  ds_read_b64_tr_b16 a[156:157], v231 offset:16384
  v_add_f32 v200, 1.0, v200
  v_mfma_f32_16x16x32_bf16 v[12:15], a[180:183], a[76:79], v[12:15]
  ds_read_b64_tr_b16 a[158:159], v231 offset:16896
  v_add_f32 v201, 1.0, v201
  v_add_f32 v202, 1.0, v202
  v_mfma_f32_16x16x32_bf16 v[12:15], a[184:187], a[84:87], v[12:15]
  buffer_load_dwordx4 v221, s[12:15], s35 offen offset:1024 sc1 lds
  v_add_f32 v203, 1.0, v203
  v_mfma_f32_16x16x32_bf16 v[12:15], a[188:191], a[92:95], v[12:15]
  s_waitcnt lgkmcnt(6)
  ds_read_b64_tr_b16 a[160:161], v231 offset:20480
  ds_read_b64_tr_b16 a[162:163], v231 offset:20992
  v_mfma_f32_16x16x32_bf16 v[16:19], a[192:195], a[48:51], v[16:19]
  s_add_u32 m0, s29, 24576
  ds_read_b64_tr_b16 a[164:165], v231 offset:36864
  ds_read_b64_tr_b16 a[166:167], v231 offset:37376
  v_rcp_f32 v200, v200
  v_mfma_f32_16x16x32_bf16 v[16:19], a[196:199], a[56:59], v[16:19]
  s_add_u32 s35, s32, 1769472
  v_rcp_f32 v201, v201
  v_mfma_f32_16x16x32_bf16 v[16:19], a[200:203], a[64:67], v[16:19]
  ds_read_b64_tr_b16 a[168:169], v231 offset:40960
  ds_read_b64_tr_b16 a[170:171], v231 offset:41472
  v_mfma_f32_16x16x32_bf16 v[16:19], a[204:207], a[72:75], v[16:19]
  v_rcp_f32 v202, v202
  v_mfma_f32_16x16x32_bf16 v[16:19], a[144:147], a[80:83], v[16:19]
  s_waitcnt lgkmcnt(8)
  ds_read_b64_tr_b16 a[172:173], v231 offset:45056
  ds_read_b64_tr_b16 a[174:175], v231 offset:45568
  v_mfma_f32_16x16x32_bf16 v[16:19], a[148:151], a[88:91], v[16:19]
  buffer_load_dwordx4 v220, s[12:15], s35 offen sc1 lds
  v_mfma_f32_16x16x32_bf16 v[20:23], a[192:195], a[52:55], v[20:23]
  ds_read_b64_tr_b16 a[176:177], v232 offset:0
  ds_read_b64_tr_b16 a[178:179], v232 offset:512
  v_rcp_f32 v203, v203
  v_mfma_f32_16x16x32_bf16 v[20:23], a[196:199], a[60:63], v[20:23]
  ds_read_b64_tr_b16 a[180:181], v232 offset:4096
  v_mul_f32 v92, v92, v200
  v_mul_f32 v93, v93, v201
  v_mfma_f32_16x16x32_bf16 v[20:23], a[200:203], a[68:71], v[20:23]
  ds_read_b64_tr_b16 a[182:183], v232 offset:4608
  v_mul_f32 v94, v94, v202
  v_mfma_f32_16x16x32_bf16 v[20:23], a[204:207], a[76:79], v[20:23]
  ds_read_b64_tr_b16 a[184:185], v232 offset:8192
  v_mul_f32 v95, v95, v203
  v_mfma_f32_16x16x32_bf16 v[20:23], a[144:147], a[84:87], v[20:23]
  ds_read_b64_tr_b16 a[186:187], v232 offset:8704
  v_cvt_pk_bf16_f32 v166, v92, v93
  v_mfma_f32_16x16x32_bf16 v[20:23], a[148:151], a[92:95], v[20:23]
  buffer_load_dwordx4 v221, s[12:15], s35 offen offset:1024 sc1 lds
  v_cvt_pk_bf16_f32 v167, v94, v95
  v_mfma_f32_16x16x32_bf16 v[24:27], a[152:155], a[48:51], v[24:27]
  s_waitcnt lgkmcnt(6)
  ds_read_b64_tr_b16 a[188:189], v232 offset:24576
  ds_read_b64_tr_b16 a[190:191], v232 offset:25088
  v_mfma_f32_16x16x32_bf16 v[24:27], a[156:159], a[56:59], v[24:27]
  ds_read_b64_tr_b16 a[192:193], v232 offset:28672
  ds_read_b64_tr_b16 a[194:195], v232 offset:29184
  buffer_store_dwordx4 v[164:167], v225, s[56:59], s28 offen offset:1024 sc1
  v_mfma_f32_16x16x32_bf16 v[24:27], a[160:163], a[64:67], v[24:27]
  v_fma_f32 v200, -v96, v96, s37
  v_fma_f32 v201, -v97, v97, s37
  v_mfma_f32_16x16x32_bf16 v[24:27], a[164:167], a[72:75], v[24:27]
  ds_read_b64_tr_b16 a[196:197], v232 offset:32768
  v_fma_f32 v202, -v98, v98, s37
  v_mfma_f32_16x16x32_bf16 v[24:27], a[168:171], a[80:83], v[24:27]
  ds_read_b64_tr_b16 a[198:199], v232 offset:33280
  v_fma_f32 v203, -v99, v99, s37
  v_mfma_f32_16x16x32_bf16 v[24:27], a[172:175], a[88:91], v[24:27]
  ds_read_b64_tr_b16 a[200:201], v232 offset:12288
  ds_read_b64_tr_b16 a[202:203], v232 offset:12800
  v_mul_f32 v200, v96, v200
  v_mfma_f32_16x16x32_bf16 v[28:31], a[152:155], a[52:55], v[28:31]
  buffer_load_dwordx4 v222, s[12:15], s35 offen offset:2048 sc1 lds
  v_mul_f32 v201, v97, v201
  v_mfma_f32_16x16x32_bf16 v[28:31], a[156:159], a[60:63], v[28:31]
  ds_read_b64_tr_b16 a[204:205], v232 offset:16384
  ds_read_b64_tr_b16 a[206:207], v232 offset:16896
  v_mul_f32 v202, v98, v202
  v_mfma_f32_16x16x32_bf16 v[28:31], a[160:163], a[68:71], v[28:31]
  ds_read_b64_tr_b16 a[144:145], v232 offset:20480
  v_mul_f32 v203, v99, v203
  v_mfma_f32_16x16x32_bf16 v[28:31], a[164:167], a[76:79], v[28:31]
  ds_read_b64_tr_b16 a[146:147], v232 offset:20992
  ds_read_b64_tr_b16 a[148:149], v232 offset:36864
  v_mfma_f32_16x16x32_bf16 v[28:31], a[168:171], a[84:87], v[28:31]
  v_exp_f32 v200, v200
  v_mfma_f32_16x16x32_bf16 v[28:31], a[172:175], a[92:95], v[28:31]
  s_waitcnt lgkmcnt(9)
  ds_read_b64_tr_b16 a[150:151], v232 offset:37376
  ds_read_b64_tr_b16 a[152:153], v232 offset:40960
  v_mfma_f32_16x16x32_bf16 v[32:35], a[176:179], a[48:51], v[32:35]
  v_exp_f32 v201, v201
  v_mfma_f32_16x16x32_bf16 v[32:35], a[180:183], a[56:59], v[32:35]
  buffer_load_dwordx4 v223, s[12:15], s35 offen offset:3072 sc1 lds
  v_mfma_f32_16x16x32_bf16 v[32:35], a[184:187], a[64:67], v[32:35]
  s_add_u32 m0, s29, 28672
  ds_read_b64_tr_b16 a[154:155], v232 offset:41472
  ds_read_b64_tr_b16 a[156:157], v232 offset:45056
  v_exp_f32 v202, v202
  v_mfma_f32_16x16x32_bf16 v[32:35], a[188:191], a[72:75], v[32:35]
  s_add_u32 s35, s32, 2359296
  ds_read_b64_tr_b16 a[158:159], v232 offset:45568
  ds_read_b64_tr_b16 a[160:161], v233 offset:0
  v_exp_f32 v203, v203
  v_mfma_f32_16x16x32_bf16 v[32:35], a[192:195], a[80:83], v[32:35]
  s_waitcnt lgkmcnt(9)
  v_mul_f32 v104, v96, v104
  v_mul_f32 v105, v97, v105
  v_mfma_f32_16x16x32_bf16 v[32:35], a[196:199], a[88:91], v[32:35]
  ds_read_b64_tr_b16 a[162:163], v233 offset:512
  v_mul_f32 v106, v98, v106
  v_mfma_f32_16x16x32_bf16 v[36:39], a[176:179], a[52:55], v[36:39]
  ds_read_b64_tr_b16 a[164:165], v233 offset:4096
  ds_read_b64_tr_b16 a[166:167], v233 offset:4608
  v_mfma_f32_16x16x32_bf16 v[36:39], a[180:183], a[60:63], v[36:39]
  buffer_load_dwordx4 v220, s[12:15], s35 offen sc1 lds
  v_mul_f32 v107, v99, v107
  v_mfma_f32_16x16x32_bf16 v[36:39], a[184:187], a[68:71], v[36:39]
  ds_read_b64_tr_b16 a[168:169], v233 offset:8192
  ds_read_b64_tr_b16 a[170:171], v233 offset:8704
  v_add_f32 v200, 1.0, v200
  v_mfma_f32_16x16x32_bf16 v[36:39], a[188:191], a[76:79], v[36:39]
  ds_read_b64_tr_b16 a[172:173], v233 offset:24576
  v_add_f32 v201, 1.0, v201
  v_mfma_f32_16x16x32_bf16 v[36:39], a[192:195], a[84:87], v[36:39]
  ds_read_b64_tr_b16 a[174:175], v233 offset:25088
  v_add_f32 v202, 1.0, v202
  v_mfma_f32_16x16x32_bf16 v[36:39], a[196:199], a[92:95], v[36:39]
  ds_read_b64_tr_b16 a[176:177], v233 offset:28672
  v_add_f32 v203, 1.0, v203
  v_mfma_f32_16x16x32_bf16 v[40:43], a[200:203], a[48:51], v[40:43]
  ds_read_b64_tr_b16 a[178:179], v233 offset:29184
  ds_read_b64_tr_b16 a[180:181], v233 offset:32768
  v_mfma_f32_16x16x32_bf16 v[40:43], a[204:207], a[56:59], v[40:43]
  s_waitcnt lgkmcnt(9)
  v_rcp_f32 v200, v200
  v_mfma_f32_16x16x32_bf16 v[40:43], a[144:147], a[64:67], v[40:43]
  buffer_load_dwordx4 v221, s[12:15], s35 offen offset:1024 sc1 lds
  v_rcp_f32 v201, v201
  v_mfma_f32_16x16x32_bf16 v[40:43], a[148:151], a[72:75], v[40:43]
  ds_read_b64_tr_b16 a[182:183], v233 offset:33280
  ds_read_b64_tr_b16 a[184:185], v233 offset:12288
  v_mfma_f32_16x16x32_bf16 v[40:43], a[152:155], a[80:83], v[40:43]
  ds_read_b64_tr_b16 a[186:187], v233 offset:12800
  ds_read_b64_tr_b16 a[188:189], v233 offset:16384
  v_rcp_f32 v202, v202
  v_mfma_f32_16x16x32_bf16 v[40:43], a[156:159], a[88:91], v[40:43]
  v_rcp_f32 v203, v203
  v_mfma_f32_16x16x32_bf16 v[44:47], a[200:203], a[52:55], v[44:47]
  ds_read_b64_tr_b16 a[190:191], v233 offset:16896
  ds_read_b64_tr_b16 a[192:193], v233 offset:20480
  v_mfma_f32_16x16x32_bf16 v[44:47], a[204:207], a[60:63], v[44:47]
  ds_read_b64_tr_b16 a[194:195], v233 offset:20992
  v_mul_f32 v104, v104, v200
  v_mfma_f32_16x16x32_bf16 v[44:47], a[144:147], a[68:71], v[44:47]
  ds_read_b64_tr_b16 a[196:197], v233 offset:36864
  v_mul_f32 v105, v105, v201
  v_mfma_f32_16x16x32_bf16 v[44:47], a[148:151], a[76:79], v[44:47]
  ds_read_b64_tr_b16 a[198:199], v233 offset:37376
  v_mul_f32 v106, v106, v202
  v_mfma_f32_16x16x32_bf16 v[44:47], a[152:155], a[84:87], v[44:47]
  ds_read_b64_tr_b16 a[200:201], v233 offset:40960
  ds_read_b64_tr_b16 a[202:203], v233 offset:41472
  v_mul_f32 v107, v107, v203
  v_mfma_f32_16x16x32_bf16 v[44:47], a[156:159], a[92:95], v[44:47]
  ds_read_b64_tr_b16 a[204:205], v233 offset:45056
  v_cvt_pk_bf16_f32 v168, v104, v105
  v_cvt_pk_bf16_f32 v169, v106, v107
  v_mfma_f32_16x16x32_bf16 v[48:51], a[160:163], a[48:51], v[48:51]
  s_waitcnt lgkmcnt(9)
  ds_read_b64_tr_b16 a[206:207], v233 offset:45568
  v_fma_f32 v200, -v100, v100, s37
  v_mfma_f32_16x16x32_bf16 v[48:51], a[164:167], a[56:59], v[48:51]
  v_fma_f32 v201, -v101, v101, s37
  v_fma_f32 v202, -v102, v102, s37
  v_mfma_f32_16x16x32_bf16 v[48:51], a[168:171], a[64:67], v[48:51]
  v_fma_f32 v203, -v103, v103, s37
  v_mul_f32 v200, v100, v200
  v_mfma_f32_16x16x32_bf16 v[48:51], a[172:175], a[72:75], v[48:51]
  v_mul_f32 v201, v101, v201
  v_mul_f32 v202, v102, v202
  v_mfma_f32_16x16x32_bf16 v[48:51], a[176:179], a[80:83], v[48:51]
  v_mul_f32 v203, v103, v203
  v_mfma_f32_16x16x32_bf16 v[48:51], a[180:183], a[88:91], v[48:51]
  v_exp_f32 v200, v200
  v_mfma_f32_16x16x32_bf16 v[52:55], a[160:163], a[52:55], v[52:55]
  v_exp_f32 v201, v201
  v_mfma_f32_16x16x32_bf16 v[52:55], a[164:167], a[60:63], v[52:55]
L_st21:
  s_waitcnt vmcnt(14) lgkmcnt(0)
  s_barrier
  ds_read_b64_tr_b16 a[144:145], v234 offset:0
  ds_read_b64_tr_b16 a[146:147], v234 offset:512
  v_mfma_f32_16x16x32_bf16 v[52:55], a[168:171], a[68:71], v[52:55]
  s_add_u32 m0, s29, 49152
  v_exp_f32 v202, v202
  v_mfma_f32_16x16x32_bf16 v[52:55], a[172:175], a[76:79], v[52:55]
  s_add_u32 s35, s32, 3538944
  ds_read_b64_tr_b16 a[148:149], v234 offset:4096
  ds_read_b64_tr_b16 a[150:151], v234 offset:4608
  v_mfma_f32_16x16x32_bf16 v[52:55], a[176:179], a[84:87], v[52:55]
  v_exp_f32 v203, v203
  v_mfma_f32_16x16x32_bf16 v[52:55], a[180:183], a[92:95], v[52:55]
  ds_read_b64_tr_b16 a[152:153], v234 offset:8192
  v_mul_f32 v108, v100, v108
  v_mfma_f32_16x16x32_bf16 v[56:59], a[184:187], a[48:51], v[56:59]
  ds_read_b64_tr_b16 a[154:155], v234 offset:8704
  v_mul_f32 v109, v101, v109
  v_mfma_f32_16x16x32_bf16 v[56:59], a[188:191], a[56:59], v[56:59]
  buffer_load_dwordx4 v220, s[12:15], s35 offen sc1 lds
  v_mfma_f32_16x16x32_bf16 v[56:59], a[192:195], a[64:67], v[56:59]
  ds_read_b64_tr_b16 a[156:157], v234 offset:24576
  ds_read_b64_tr_b16 a[158:159], v234 offset:25088
  v_mfma_f32_16x16x32_bf16 v[56:59], a[196:199], a[72:75], v[56:59]
  ds_read_b64_tr_b16 a[160:161], v234 offset:28672
  v_mul_f32 v110, v102, v110
  v_mfma_f32_16x16x32_bf16 v[56:59], a[200:203], a[80:83], v[56:59]
  ds_read_b64_tr_b16 a[162:163], v234 offset:29184
  v_mul_f32 v111, v103, v111
  v_mfma_f32_16x16x32_bf16 v[56:59], a[204:207], a[88:91], v[56:59]
  ds_read_b64_tr_b16 a[164:165], v234 offset:32768
  v_add_f32 v200, 1.0, v200
  v_mfma_f32_16x16x32_bf16 v[60:63], a[184:187], a[52:55], v[60:63]
  ds_read_b64_tr_b16 a[166:167], v234 offset:33280
  v_add_f32 v201, 1.0, v201
  v_mfma_f32_16x16x32_bf16 v[60:63], a[188:191], a[60:63], v[60:63]
  buffer_load_dwordx4 v221, s[12:15], s35 offen offset:1024 sc1 lds
  v_mfma_f32_16x16x32_bf16 v[60:63], a[192:195], a[68:71], v[60:63]
  ds_read_b64_tr_b16 a[168:169], v234 offset:12288
  ds_read_b64_tr_b16 a[170:171], v234 offset:12800
  v_mfma_f32_16x16x32_bf16 v[60:63], a[196:199], a[76:79], v[60:63]
  ds_read_b64_tr_b16 a[172:173], v234 offset:16384
  v_add_f32 v202, 1.0, v202
  v_mfma_f32_16x16x32_bf16 v[60:63], a[200:203], a[84:87], v[60:63]
  ds_read_b64_tr_b16 a[174:175], v234 offset:16896
  v_add_f32 v203, 1.0, v203
  v_mfma_f32_16x16x32_bf16 v[60:63], a[204:207], a[92:95], v[60:63]
  s_waitcnt lgkmcnt(8)
  ds_read_b64_tr_b16 a[176:177], v234 offset:20480
  ds_read_b64_tr_b16 a[178:179], v234 offset:20992
  v_mfma_f32_16x16x32_bf16 v[0:3], a[144:147], a[96:99], v[0:3]
  v_rcp_f32 v200, v200
  v_mfma_f32_16x16x32_bf16 v[0:3], a[148:151], a[104:107], v[0:3]
  ds_read_b64_tr_b16 a[180:181], v234 offset:36864
  ds_read_b64_tr_b16 a[182:183], v234 offset:37376
  v_rcp_f32 v201, v201
  v_mfma_f32_16x16x32_bf16 v[0:3], a[152:155], a[112:115], v[0:3]
  buffer_load_dwordx4 v222, s[12:15], s35 offen offset:2048 sc1 lds
  v_mfma_f32_16x16x32_bf16 v[0:3], a[156:159], a[120:123], v[0:3]
  s_waitcnt lgkmcnt(8)
  ds_read_b64_tr_b16 a[184:185], v234 offset:40960
  ds_read_b64_tr_b16 a[186:187], v234 offset:41472
  v_rcp_f32 v202, v202
  v_mfma_f32_16x16x32_bf16 v[0:3], a[160:163], a[128:131], v[0:3]
  ds_read_b64_tr_b16 a[188:189], v234 offset:45056
  ds_read_b64_tr_b16 a[190:191], v234 offset:45568
  v_mfma_f32_16x16x32_bf16 v[64:67], a[164:167], a[136:139], v[0:3]
  v_rcp_f32 v203, v203
  v_mfma_f32_16x16x32_bf16 v[4:7], a[144:147], a[100:103], v[4:7]
  ds_read_b64_tr_b16 a[192:193], v235 offset:0
  v_mul_f32 v108, v108, v200
  v_mfma_f32_16x16x32_bf16 v[4:7], a[148:151], a[108:111], v[4:7]
  ds_read_b64_tr_b16 a[194:195], v235 offset:512
  v_mul_f32 v109, v109, v201
  v_mfma_f32_16x16x32_bf16 v[4:7], a[152:155], a[116:119], v[4:7]
  ds_read_b64_tr_b16 a[196:197], v235 offset:4096
  v_mul_f32 v110, v110, v202
  v_mfma_f32_16x16x32_bf16 v[4:7], a[156:159], a[124:127], v[4:7]
  buffer_load_dwordx4 v223, s[12:15], s35 offen offset:3072 sc1 lds
  v_mul_f32 v111, v111, v203
  v_mfma_f32_16x16x32_bf16 v[4:7], a[160:163], a[132:135], v[4:7]
  s_add_u32 m0, s29, 53248
  ds_read_b64_tr_b16 a[198:199], v235 offset:4608
  ds_read_b64_tr_b16 a[200:201], v235 offset:8192
  v_cvt_pk_bf16_f32 v172, v108, v109
  v_mfma_f32_16x16x32_bf16 v[68:71], a[164:167], a[140:143], v[4:7]
  s_waitcnt lgkmcnt(7)
  ds_read_b64_tr_b16 a[202:203], v235 offset:8704
  v_cvt_pk_bf16_f32 v173, v110, v111
  v_fma_f32 v200, -v112, v112, s37
  v_mfma_f32_16x16x32_bf16 v[8:11], a[168:171], a[96:99], v[8:11]
  s_add_u32 s35, s32, 4128768
  ds_read_b64_tr_b16 a[204:205], v235 offset:24576
  v_fma_f32 v201, -v113, v113, s37
  v_mfma_f32_16x16x32_bf16 v[8:11], a[172:175], a[104:107], v[8:11]
  ds_read_b64_tr_b16 a[206:207], v235 offset:25088
  v_fma_f32 v202, -v114, v114, s37
  v_mfma_f32_16x16x32_bf16 v[8:11], a[176:179], a[112:115], v[8:11]
  ds_read_b64_tr_b16 a[144:145], v235 offset:28672
  v_fma_f32 v203, -v115, v115, s37
  v_mfma_f32_16x16x32_bf16 v[8:11], a[180:183], a[120:123], v[8:11]
  buffer_load_dwordx4 v220, s[12:15], s35 offen sc1 lds
  v_mul_f32 v200, v112, v200
  v_mfma_f32_16x16x32_bf16 v[8:11], a[184:187], a[128:131], v[8:11]
  s_waitcnt lgkmcnt(7)
  ds_read_b64_tr_b16 a[146:147], v235 offset:29184
  ds_read_b64_tr_b16 a[148:149], v235 offset:32768
  v_mul_f32 v201, v113, v201
  v_mfma_f32_16x16x32_bf16 v[72:75], a[188:191], a[136:139], v[8:11]
  ds_read_b64_tr_b16 a[150:151], v235 offset:33280
  v_mul_f32 v202, v114, v202
  v_mfma_f32_16x16x32_bf16 v[12:15], a[168:171], a[100:103], v[12:15]
  ds_read_b64_tr_b16 a[152:153], v235 offset:12288
  v_mul_f32 v203, v115, v203
  v_mfma_f32_16x16x32_bf16 v[12:15], a[172:175], a[108:111], v[12:15]
  ds_read_b64_tr_b16 a[154:155], v235 offset:12800
  ds_read_b64_tr_b16 a[156:157], v235 offset:16384
  v_mfma_f32_16x16x32_bf16 v[12:15], a[176:179], a[116:119], v[12:15]
  v_exp_f32 v200, v200
  v_mfma_f32_16x16x32_bf16 v[12:15], a[180:183], a[124:127], v[12:15]
  ds_read_b64_tr_b16 a[158:159], v235 offset:16896
  ds_read_b64_tr_b16 a[160:161], v235 offset:20480
  v_exp_f32 v201, v201
  v_mfma_f32_16x16x32_bf16 v[12:15], a[184:187], a[132:135], v[12:15]
  buffer_load_dwordx4 v221, s[12:15], s35 offen offset:1024 sc1 lds
  v_mfma_f32_16x16x32_bf16 v[76:79], a[188:191], a[140:143], v[12:15]
  s_add_u32 m0, s30, 73728
  ds_read_b64_tr_b16 a[162:163], v235 offset:20992
  ds_read_b64_tr_b16 a[164:165], v235 offset:36864
  v_exp_f32 v202, v202
  v_mfma_f32_16x16x32_bf16 v[16:19], a[192:195], a[96:99], v[16:19]
  s_waitcnt lgkmcnt(9)
  ds_read_b64_tr_b16 a[166:167], v235 offset:37376
  ds_read_b64_tr_b16 a[168:169], v235 offset:40960
  v_mfma_f32_16x16x32_bf16 v[16:19], a[196:199], a[104:107], v[16:19]
  s_add_u32 s35, s33, 0
  v_exp_f32 v203, v203
  v_mfma_f32_16x16x32_bf16 v[16:19], a[200:203], a[112:115], v[16:19]
  ds_read_b64_tr_b16 a[170:171], v235 offset:41472
  v_mul_f32 v120, v112, v120
  v_mfma_f32_16x16x32_bf16 v[16:19], a[204:207], a[120:123], v[16:19]
  ds_read_b64_tr_b16 a[172:173], v235 offset:45056
  v_mul_f32 v121, v113, v121
  v_mfma_f32_16x16x32_bf16 v[16:19], a[144:147], a[128:131], v[16:19]
  s_waitcnt lgkmcnt(9)
  ds_read_b64_tr_b16 a[174:175], v235 offset:45568
  v_mul_f32 v122, v114, v122
  v_mul_f32 v123, v115, v123
  v_mfma_f32_16x16x32_bf16 v[80:83], a[148:151], a[136:139], v[16:19]
  buffer_load_dwordx4 v224, s[16:19], s35 offen sc1 lds
  v_add_f32 v200, 1.0, v200
  v_mfma_f32_16x16x32_bf16 v[20:23], a[192:195], a[100:103], v[20:23]
  s_add_u32 m0, s30, 77824
  ds_read_b64_tr_b16 a[176:177], v236 offset:0
  ds_read_b64_tr_b16 a[178:179], v236 offset:512
  v_add_f32 v201, 1.0, v201
  v_mfma_f32_16x16x32_bf16 v[20:23], a[196:199], a[108:111], v[20:23]
  s_add_u32 s35, s33, 36864
  ds_read_b64_tr_b16 a[180:181], v236 offset:4096
  v_add_f32 v202, 1.0, v202
  v_mfma_f32_16x16x32_bf16 v[20:23], a[200:203], a[116:119], v[20:23]
  ds_read_b64_tr_b16 a[182:183], v236 offset:4608
  v_add_f32 v203, 1.0, v203
  v_mfma_f32_16x16x32_bf16 v[20:23], a[204:207], a[124:127], v[20:23]
  ds_read_b64_tr_b16 a[184:185], v236 offset:8192
  ds_read_b64_tr_b16 a[186:187], v236 offset:8704
  v_mfma_f32_16x16x32_bf16 v[20:23], a[144:147], a[132:135], v[20:23]
  v_rcp_f32 v200, v200
  v_mfma_f32_16x16x32_bf16 v[84:87], a[148:151], a[140:143], v[20:23]
  buffer_load_dwordx4 v224, s[16:19], s35 offen sc1 lds
  v_mfma_f32_16x16x32_bf16 v[24:27], a[152:155], a[96:99], v[24:27]
  s_waitcnt lgkmcnt(6)
  ds_read_b64_tr_b16 a[188:189], v236 offset:24576
  ds_read_b64_tr_b16 a[190:191], v236 offset:25088
  v_rcp_f32 v201, v201
  v_mfma_f32_16x16x32_bf16 v[24:27], a[156:159], a[104:107], v[24:27]
  s_add_u32 m0, s30, 81920
  ds_read_b64_tr_b16 a[192:193], v236 offset:28672
  ds_read_b64_tr_b16 a[194:195], v236 offset:29184
  v_mfma_f32_16x16x32_bf16 v[24:27], a[160:163], a[112:115], v[24:27]
  s_add_u32 s35, s33, 73728
  v_rcp_f32 v202, v202
  v_mfma_f32_16x16x32_bf16 v[24:27], a[164:167], a[120:123], v[24:27]
  ds_read_b64_tr_b16 a[196:197], v236 offset:32768
  ds_read_b64_tr_b16 a[198:199], v236 offset:33280
  v_rcp_f32 v203, v203
  v_mfma_f32_16x16x32_bf16 v[24:27], a[168:171], a[128:131], v[24:27]
  v_mul_f32 v120, v120, v200
  v_mul_f32 v121, v121, v201
  v_mfma_f32_16x16x32_bf16 v[88:91], a[172:175], a[136:139], v[24:27]
  ds_read_b64_tr_b16 a[200:201], v236 offset:12288
  ds_read_b64_tr_b16 a[202:203], v236 offset:12800
  v_mfma_f32_16x16x32_bf16 v[28:31], a[152:155], a[100:103], v[28:31]
  buffer_load_dwordx4 v224, s[16:19], s35 offen sc1 lds
  v_mul_f32 v122, v122, v202
  v_mfma_f32_16x16x32_bf16 v[28:31], a[156:159], a[108:111], v[28:31]
  s_add_u32 m0, s30, 86016
  ds_read_b64_tr_b16 a[204:205], v236 offset:16384
  ds_read_b64_tr_b16 a[206:207], v236 offset:16896
  v_mul_f32 v123, v123, v203
  v_mfma_f32_16x16x32_bf16 v[28:31], a[160:163], a[116:119], v[28:31]
  s_add_u32 s35, s33, 110592
  ds_read_b64_tr_b16 a[144:145], v236 offset:20480
  v_cvt_pk_bf16_f32 v170, v120, v121
  v_mfma_f32_16x16x32_bf16 v[28:31], a[164:167], a[124:127], v[28:31]
  ds_read_b64_tr_b16 a[146:147], v236 offset:20992
  v_cvt_pk_bf16_f32 v171, v122, v123
  v_mfma_f32_16x16x32_bf16 v[28:31], a[168:171], a[132:135], v[28:31]
  ds_read_b64_tr_b16 a[148:149], v236 offset:36864
  ds_read_b64_tr_b16 a[150:151], v236 offset:37376
  v_mfma_f32_16x16x32_bf16 v[92:95], a[172:175], a[140:143], v[28:31]
  s_waitcnt lgkmcnt(8)
  buffer_store_dwordx4 v[168:171], v225, s[56:59], s28 offen offset:2048 sc1
  v_fma_f32 v200, -v116, v116, s37
  v_mfma_f32_16x16x32_bf16 v[32:35], a[176:179], a[96:99], v[32:35]
  ds_read_b64_tr_b16 a[152:153], v236 offset:40960
  v_fma_f32 v201, -v117, v117, s37
  v_mfma_f32_16x16x32_bf16 v[32:35], a[180:183], a[104:107], v[32:35]
  buffer_load_dwordx4 v224, s[16:19], s35 offen sc1 lds
  v_fma_f32 v202, -v118, v118, s37
  v_mfma_f32_16x16x32_bf16 v[32:35], a[184:187], a[112:115], v[32:35]
  s_add_u32 m0, s30, 90112
  ds_read_b64_tr_b16 a[154:155], v236 offset:41472
  ds_read_b64_tr_b16 a[156:157], v236 offset:45056
  v_fma_f32 v203, -v119, v119, s37
  v_mfma_f32_16x16x32_bf16 v[32:35], a[188:191], a[120:123], v[32:35]
  s_add_u32 s35, s33, 147456
  ds_read_b64_tr_b16 a[158:159], v236 offset:45568
  v_mul_f32 v200, v116, v200
  v_mfma_f32_16x16x32_bf16 v[32:35], a[192:195], a[128:131], v[32:35]
  ds_read_b64_tr_b16 a[160:161], v237 offset:0
  v_mul_f32 v201, v117, v201
  v_mfma_f32_16x16x32_bf16 v[96:99], a[196:199], a[136:139], v[32:35]
  ds_read_b64_tr_b16 a[162:163], v237 offset:512
  v_mul_f32 v202, v118, v202
  v_mfma_f32_16x16x32_bf16 v[36:39], a[176:179], a[100:103], v[36:39]
  ds_read_b64_tr_b16 a[164:165], v237 offset:4096
  ds_read_b64_tr_b16 a[166:167], v237 offset:4608
  v_mul_f32 v203, v119, v203
  v_mfma_f32_16x16x32_bf16 v[36:39], a[180:183], a[108:111], v[36:39]
  buffer_load_dwordx4 v224, s[16:19], s35 offen sc1 lds
  v_mfma_f32_16x16x32_bf16 v[36:39], a[184:187], a[116:119], v[36:39]
  s_add_u32 m0, s30, 94208
  ds_read_b64_tr_b16 a[168:169], v237 offset:8192
  ds_read_b64_tr_b16 a[170:171], v237 offset:8704
  v_exp_f32 v200, v200
  v_mfma_f32_16x16x32_bf16 v[36:39], a[188:191], a[124:127], v[36:39]
  s_add_u32 s35, s33, 184320
  ds_read_b64_tr_b16 a[172:173], v237 offset:24576
  ds_read_b64_tr_b16 a[174:175], v237 offset:25088
  v_exp_f32 v201, v201
  v_mfma_f32_16x16x32_bf16 v[36:39], a[192:195], a[132:135], v[36:39]
  v_exp_f32 v202, v202
  v_mfma_f32_16x16x32_bf16 v[100:103], a[196:199], a[140:143], v[36:39]
  s_waitcnt lgkmcnt(8)
  ds_read_b64_tr_b16 a[176:177], v237 offset:28672
  ds_read_b64_tr_b16 a[178:179], v237 offset:29184
  v_mfma_f32_16x16x32_bf16 v[40:43], a[200:203], a[96:99], v[40:43]
  v_exp_f32 v203, v203
  v_mfma_f32_16x16x32_bf16 v[40:43], a[204:207], a[104:107], v[40:43]
  ds_read_b64_tr_b16 a[180:181], v237 offset:32768
  v_mul_f32 v124, v116, v124
  v_mfma_f32_16x16x32_bf16 v[40:43], a[144:147], a[112:115], v[40:43]
  buffer_load_dwordx4 v224, s[16:19], s35 offen sc1 lds
  v_mfma_f32_16x16x32_bf16 v[40:43], a[148:151], a[120:123], v[40:43]
  ds_read_b64_tr_b16 a[182:183], v237 offset:33280
  ds_read_b64_tr_b16 a[184:185], v237 offset:12288
  v_mul_f32 v125, v117, v125
  v_mfma_f32_16x16x32_bf16 v[40:43], a[152:155], a[128:131], v[40:43]
  ds_read_b64_tr_b16 a[186:187], v237 offset:12800
  v_mul_f32 v126, v118, v126
  v_mfma_f32_16x16x32_bf16 v[104:107], a[156:159], a[136:139], v[40:43]
  ds_read_b64_tr_b16 a[188:189], v237 offset:16384
  v_mul_f32 v127, v119, v127
  v_mfma_f32_16x16x32_bf16 v[44:47], a[200:203], a[100:103], v[44:47]
  ds_read_b64_tr_b16 a[190:191], v237 offset:16896
  ds_read_b64_tr_b16 a[192:193], v237 offset:20480
  v_add_f32 v200, 1.0, v200
  v_mfma_f32_16x16x32_bf16 v[44:47], a[204:207], a[108:111], v[44:47]
  ds_read_b64_tr_b16 a[194:195], v237 offset:20992
  v_add_f32 v201, 1.0, v201
  v_add_f32 v202, 1.0, v202
  v_mfma_f32_16x16x32_bf16 v[44:47], a[144:147], a[116:119], v[44:47]
  ds_read_b64_tr_b16 a[196:197], v237 offset:36864
  v_add_f32 v203, 1.0, v203
  v_mfma_f32_16x16x32_bf16 v[44:47], a[148:151], a[124:127], v[44:47]
  ds_read_b64_tr_b16 a[198:199], v237 offset:37376
  ds_read_b64_tr_b16 a[200:201], v237 offset:40960
  v_mfma_f32_16x16x32_bf16 v[44:47], a[152:155], a[132:135], v[44:47]
  v_rcp_f32 v200, v200
  v_mfma_f32_16x16x32_bf16 v[108:111], a[156:159], a[140:143], v[44:47]
  s_waitcnt lgkmcnt(9)
  ds_read_b64_tr_b16 a[202:203], v237 offset:41472
  ds_read_b64_tr_b16 a[204:205], v237 offset:45056
  v_mfma_f32_16x16x32_bf16 v[48:51], a[160:163], a[96:99], v[48:51]
  ds_read_b64_tr_b16 a[206:207], v237 offset:45568
  v_rcp_f32 v201, v201
  v_mfma_f32_16x16x32_bf16 v[48:51], a[164:167], a[104:107], v[48:51]
  v_rcp_f32 v202, v202
  v_mfma_f32_16x16x32_bf16 v[48:51], a[168:171], a[112:115], v[48:51]
  v_rcp_f32 v203, v203
  v_mfma_f32_16x16x32_bf16 v[48:51], a[172:175], a[120:123], v[48:51]
  v_mul_f32 v124, v124, v200
  v_mul_f32 v125, v125, v201
  v_mfma_f32_16x16x32_bf16 v[48:51], a[176:179], a[128:131], v[48:51]
  v_mul_f32 v126, v126, v202
  v_mul_f32 v127, v127, v203
  v_mfma_f32_16x16x32_bf16 v[112:115], a[180:183], a[136:139], v[48:51]
  v_cvt_pk_bf16_f32 v174, v124, v125
  v_cvt_pk_bf16_f32 v175, v126, v127
  v_mfma_f32_16x16x32_bf16 v[52:55], a[160:163], a[100:103], v[52:55]
  buffer_store_dwordx4 v[172:175], v225, s[56:59], s28 offen offset:3072 sc1
  v_mfma_f32_16x16x32_bf16 v[52:55], a[164:167], a[108:111], v[52:55]
L_st23:
  s_waitcnt vmcnt(14) lgkmcnt(0)
  s_barrier
  ds_read_b64_tr_b16 a[144:145], v204 offset:0
  v_add_u32 v226, 0, v210
  v_mfma_f32_16x16x32_bf16 v[52:55], a[168:171], a[116:119], v[52:55]
  s_add_u32 m0, s30, 98304
  ds_read_b64_tr_b16 a[146:147], v204 offset:256
  v_xor_b32 v227, 32, v226
  v_mfma_f32_16x16x32_bf16 v[52:55], a[172:175], a[124:127], v[52:55]
  s_add_u32 s35, s33, 128
  ds_read_b64_tr_b16 a[148:149], v204 offset:2048
  v_xor_b32 v228, 64, v226
  v_mfma_f32_16x16x32_bf16 v[52:55], a[176:179], a[132:135], v[52:55]
  ds_read_b64_tr_b16 a[150:151], v204 offset:2304
  v_xor_b32 v229, 96, v226
  v_mfma_f32_16x16x32_bf16 v[116:119], a[180:183], a[140:143], v[52:55]
  ds_read_b64_tr_b16 a[152:153], v204 offset:4096
  v_add_u32 v230, 49152, v210
  v_mfma_f32_16x16x32_bf16 v[56:59], a[184:187], a[96:99], v[56:59]
  ds_read_b64_tr_b16 a[154:155], v204 offset:4352
  v_xor_b32 v231, 32, v230
  v_mfma_f32_16x16x32_bf16 v[56:59], a[188:191], a[104:107], v[56:59]
  buffer_load_dwordx4 v224, s[16:19], s35 offen sc1 lds
  v_mfma_f32_16x16x32_bf16 v[56:59], a[192:195], a[112:115], v[56:59]
  s_add_u32 m0, s30, 102400
  ds_read_b64_tr_b16 a[156:157], v204 offset:12288
  ds_read_b64_tr_b16 a[158:159], v204 offset:12544
  v_mfma_f32_16x16x32_bf16 v[56:59], a[196:199], a[120:123], v[56:59]
  s_add_u32 s35, s33, 36992
  ds_read_b64_tr_b16 a[160:161], v204 offset:14336
  v_xor_b32 v232, 64, v230
  v_mfma_f32_16x16x32_bf16 v[56:59], a[200:203], a[128:131], v[56:59]
  ds_read_b64_tr_b16 a[162:163], v204 offset:14592
  v_xor_b32 v233, 96, v230
  v_mfma_f32_16x16x32_bf16 v[120:123], a[204:207], a[136:139], v[56:59]
  ds_read_b64_tr_b16 a[164:165], v204 offset:16384
  v_add_u32 v234, 98304, v210
  v_mfma_f32_16x16x32_bf16 v[60:63], a[184:187], a[100:103], v[60:63]
  ds_read_b64_tr_b16 a[166:167], v204 offset:16640
  v_xor_b32 v235, 32, v234
  v_mfma_f32_16x16x32_bf16 v[60:63], a[188:191], a[108:111], v[60:63]
  buffer_load_dwordx4 v224, s[16:19], s35 offen sc1 lds
  v_mfma_f32_16x16x32_bf16 v[60:63], a[192:195], a[116:119], v[60:63]
  s_add_u32 m0, s30, 106496
  ds_read_b64_tr_b16 a[168:169], v205 offset:0
  ds_read_b64_tr_b16 a[170:171], v205 offset:256
  v_mfma_f32_16x16x32_bf16 v[60:63], a[196:199], a[124:127], v[60:63]
  s_add_u32 s35, s33, 73856
  ds_read_b64_tr_b16 a[172:173], v205 offset:2048
  v_xor_b32 v236, 64, v234
  v_mfma_f32_16x16x32_bf16 v[60:63], a[200:203], a[132:135], v[60:63]
  ds_read_b64_tr_b16 a[174:175], v205 offset:2304
  v_xor_b32 v237, 96, v234
  v_mfma_f32_16x16x32_bf16 v[124:127], a[204:207], a[140:143], v[60:63]
  s_waitcnt lgkmcnt(8)
  ds_read_b64_tr_b16 a[176:177], v205 offset:4096
  v_fma_f32 v200, -v64, v64, s37
  v_mfma_f32_16x16x32_bf16 v[0:3], a[144:147], a[0:3], 0
  ds_read_b64_tr_b16 a[178:179], v205 offset:4352
  v_fma_f32 v201, -v65, v65, s37
  v_mfma_f32_16x16x32_bf16 v[0:3], a[148:151], a[8:11], v[0:3]
  ds_read_b64_tr_b16 a[180:181], v205 offset:12288
  v_fma_f32 v202, -v66, v66, s37
  v_mfma_f32_16x16x32_bf16 v[0:3], a[152:155], a[16:19], v[0:3]
  buffer_load_dwordx4 v224, s[16:19], s35 offen sc1 lds
  v_fma_f32 v203, -v67, v67, s37
  v_mfma_f32_16x16x32_bf16 v[4:7], a[144:147], a[4:7], 0
  s_add_u32 m0, s30, 110592
  ds_read_b64_tr_b16 a[182:183], v205 offset:12544
  ds_read_b64_tr_b16 a[184:185], v205 offset:14336
  v_mul_f32 v200, v64, v200
  v_mfma_f32_16x16x32_bf16 v[4:7], a[148:151], a[12:15], v[4:7]
  s_add_u32 s35, s33, 110720
  ds_read_b64_tr_b16 a[186:187], v205 offset:14592
  v_mul_f32 v201, v65, v201
  v_mul_f32 v202, v66, v202
  v_mfma_f32_16x16x32_bf16 v[4:7], a[152:155], a[20:23], v[4:7]
  ds_read_b64_tr_b16 a[188:189], v205 offset:16384
  v_mul_f32 v203, v67, v203
  v_exp_f32 v200, v200
  v_mfma_f32_16x16x32_bf16 v[8:11], a[156:159], a[0:3], 0
  s_waitcnt lgkmcnt(7)
  ds_read_b64_tr_b16 a[190:191], v205 offset:16640
  ds_read_b64_tr_b16 a[192:193], v204 offset:6144
  v_exp_f32 v201, v201
  v_mfma_f32_16x16x32_bf16 v[8:11], a[160:163], a[8:11], v[8:11]
  v_exp_f32 v202, v202
  v_exp_f32 v203, v203
  v_mfma_f32_16x16x32_bf16 v[8:11], a[164:167], a[16:19], v[8:11]
  ds_read_b64_tr_b16 a[194:195], v204 offset:6400
  v_mul_f32 v72, v64, v72
  v_mul_f32 v73, v65, v73
  v_mfma_f32_16x16x32_bf16 v[12:15], a[156:159], a[4:7], 0
  buffer_load_dwordx4 v224, s[16:19], s35 offen sc1 lds
  v_mul_f32 v74, v66, v74
  v_mfma_f32_16x16x32_bf16 v[12:15], a[160:163], a[12:15], v[12:15]
  s_add_u32 m0, s30, 114688
  ds_read_b64_tr_b16 a[196:197], v204 offset:8192
  ds_read_b64_tr_b16 a[198:199], v204 offset:8448
  v_mul_f32 v75, v67, v75
  v_mfma_f32_16x16x32_bf16 v[12:15], a[164:167], a[20:23], v[12:15]
  s_add_u32 s35, s33, 147584
  ds_read_b64_tr_b16 a[200:201], v204 offset:10240
  v_add_f32 v200, 1.0, v200
  v_add_f32 v201, 1.0, v201
  v_mfma_f32_16x16x32_bf16 v[16:19], a[168:171], a[0:3], 0
  ds_read_b64_tr_b16 a[202:203], v204 offset:10496
  v_add_f32 v202, 1.0, v202
  v_add_f32 v203, 1.0, v203
  v_mfma_f32_16x16x32_bf16 v[16:19], a[172:175], a[8:11], v[16:19]
  s_waitcnt lgkmcnt(8)
  ds_read_b64_tr_b16 a[204:205], v204 offset:18432
  ds_read_b64_tr_b16 a[206:207], v204 offset:18688
  v_rcp_f32 v200, v200
  v_mfma_f32_16x16x32_bf16 v[16:19], a[176:179], a[16:19], v[16:19]
  v_rcp_f32 v201, v201
  v_rcp_f32 v202, v202
  v_mfma_f32_16x16x32_bf16 v[20:23], a[168:171], a[4:7], 0
  buffer_load_dwordx4 v224, s[16:19], s35 offen sc1 lds
  v_rcp_f32 v203, v203
  v_mfma_f32_16x16x32_bf16 v[20:23], a[172:175], a[12:15], v[20:23]
  s_add_u32 m0, s30, 118784
  ds_read_b64_tr_b16 a[144:145], v204 offset:20480
  ds_read_b64_tr_b16 a[146:147], v204 offset:20736
  v_mul_f32 v72, v72, v200
  v_mfma_f32_16x16x32_bf16 v[20:23], a[176:179], a[20:23], v[20:23]
  s_add_u32 s35, s33, 184448
  ds_read_b64_tr_b16 a[148:149], v204 offset:22528
  v_mul_f32 v73, v73, v201
  v_mul_f32 v74, v74, v202
  v_mfma_f32_16x16x32_bf16 v[24:27], a[180:183], a[0:3], 0
  ds_read_b64_tr_b16 a[150:151], v204 offset:22784
  v_mul_f32 v75, v75, v203
  v_cvt_pk_bf16_f32 v176, v72, v73
  v_mfma_f32_16x16x32_bf16 v[24:27], a[184:187], a[8:11], v[24:27]
  s_waitcnt lgkmcnt(8)
  ds_read_b64_tr_b16 a[152:153], v205 offset:6144
  v_cvt_pk_bf16_f32 v177, v74, v75
  v_fma_f32 v200, -v68, v68, s37
  v_mfma_f32_16x16x32_bf16 v[24:27], a[188:191], a[16:19], v[24:27]
  ds_read_b64_tr_b16 a[154:155], v205 offset:6400
  v_fma_f32 v201, -v69, v69, s37
  v_fma_f32 v202, -v70, v70, s37
  v_mfma_f32_16x16x32_bf16 v[28:31], a[180:183], a[4:7], 0
  ds_read_b64_tr_b16 a[156:157], v205 offset:8192
  ds_read_b64_tr_b16 a[158:159], v205 offset:8448
  v_fma_f32 v203, -v71, v71, s37
  v_mfma_f32_16x16x32_bf16 v[28:31], a[184:187], a[12:15], v[28:31]
  buffer_load_dwordx4 v224, s[16:19], s35 offen sc1 lds
  v_mul_f32 v200, v68, v200
  v_mfma_f32_16x16x32_bf16 v[28:31], a[188:191], a[20:23], v[28:31]
  s_add_u32 m0, s30, 122880
  ds_read_b64_tr_b16 a[160:161], v205 offset:10240
  ds_read_b64_tr_b16 a[162:163], v205 offset:10496
  v_mul_f32 v201, v69, v201
  v_mfma_f32_16x16x32_bf16 v[0:3], a[192:195], a[24:27], v[0:3]
  s_add_u32 s35, s44, 0
  ds_read_b64_tr_b16 a[164:165], v205 offset:18432
  v_mul_f32 v202, v70, v202
  v_mul_f32 v203, v71, v203
  v_mfma_f32_16x16x32_bf16 v[0:3], a[196:199], a[32:35], v[0:3]
  s_waitcnt lgkmcnt(9)
  ds_read_b64_tr_b16 a[166:167], v205 offset:18688
  ds_read_b64_tr_b16 a[168:169], v205 offset:20480
  v_exp_f32 v200, v200
  v_mfma_f32_16x16x32_bf16 v[0:3], a[200:203], a[40:43], v[0:3]
  v_exp_f32 v201, v201
  v_exp_f32 v202, v202
  v_mfma_f32_16x16x32_bf16 v[4:7], a[192:195], a[28:31], v[4:7]
  ds_read_b64_tr_b16 a[170:171], v205 offset:20736
  ds_read_b64_tr_b16 a[172:173], v205 offset:22528
  v_exp_f32 v203, v203
  v_mfma_f32_16x16x32_bf16 v[4:7], a[196:199], a[36:39], v[4:7]
  v_mul_f32 v76, v68, v76
  v_mul_f32 v77, v69, v77
  v_mul_f32 v78, v70, v78
  v_mfma_f32_16x16x32_bf16 v[4:7], a[200:203], a[44:47], v[4:7]
  buffer_load_dwordx4 v209, s[16:19], s35 offen sc1 lds
  v_mul_f32 v79, v71, v79
  v_mfma_f32_16x16x32_bf16 v[8:11], a[204:207], a[24:27], v[8:11]
  s_waitcnt vmcnt(7)
  buffer_store_dword v252, off, s[60:63], s100 sc1
  v_add_f32 v200, 1.0, v200
  v_mfma_f32_16x16x32_bf16 v[8:11], a[144:147], a[32:35], v[8:11]
L_st24:
  s_waitcnt lgkmcnt(5)
  ds_read_b64_tr_b16 a[174:175], v205 offset:22784
  ds_read_b64_tr_b16 a[176:177], v204 offset:24576
  v_add_f32 v201, 1.0, v201
  v_mfma_f32_16x16x32_bf16 v[8:11], a[148:151], a[40:43], v[8:11]
  s_add_u32 m0, s30, 126976
  ds_read_b64_tr_b16 a[178:179], v204 offset:24832
  v_add_f32 v202, 1.0, v202
  v_add_f32 v203, 1.0, v203
  v_mfma_f32_16x16x32_bf16 v[12:15], a[204:207], a[28:31], v[12:15]
  s_add_u32 s35, s44, 73728
  ds_read_b64_tr_b16 a[180:181], v204 offset:26624
  ds_read_b64_tr_b16 a[182:183], v204 offset:26880
  v_rcp_f32 v200, v200
  v_mfma_f32_16x16x32_bf16 v[12:15], a[144:147], a[36:39], v[12:15]
  v_rcp_f32 v201, v201
  v_rcp_f32 v202, v202
  v_mfma_f32_16x16x32_bf16 v[12:15], a[148:151], a[44:47], v[12:15]
  buffer_load_dwordx4 v209, s[16:19], s35 offen sc1 lds
  v_rcp_f32 v203, v203
  v_mfma_f32_16x16x32_bf16 v[16:19], a[152:155], a[24:27], v[16:19]
  s_add_u32 m0, s30, 131072
  ds_read_b64_tr_b16 a[184:185], v204 offset:28672
  ds_read_b64_tr_b16 a[186:187], v204 offset:28928
  v_mul_f32 v76, v76, v200
  v_mfma_f32_16x16x32_bf16 v[16:19], a[156:159], a[32:35], v[16:19]
  s_add_u32 s35, s44, 147456
  ds_read_b64_tr_b16 a[188:189], v204 offset:36864
  v_mul_f32 v77, v77, v201
  v_mul_f32 v78, v78, v202
  v_mfma_f32_16x16x32_bf16 v[16:19], a[160:163], a[40:43], v[16:19]
  ds_read_b64_tr_b16 a[190:191], v204 offset:37120
  v_mul_f32 v79, v79, v203
  v_cvt_pk_bf16_f32 v180, v76, v77
  v_mfma_f32_16x16x32_bf16 v[20:23], a[152:155], a[28:31], v[20:23]
  ds_read_b64_tr_b16 a[192:193], v204 offset:38912
  ds_read_b64_tr_b16 a[194:195], v204 offset:39168
  v_cvt_pk_bf16_f32 v181, v78, v79
  v_mfma_f32_16x16x32_bf16 v[20:23], a[156:159], a[36:39], v[20:23]
  ds_read_b64_tr_b16 a[196:197], v204 offset:40960
  v_fma_f32 v200, -v80, v80, s37
  v_fma_f32 v201, -v81, v81, s37
  v_mfma_f32_16x16x32_bf16 v[20:23], a[160:163], a[44:47], v[20:23]
  s_waitcnt lgkmcnt(7)
  ds_read_b64_tr_b16 a[198:199], v204 offset:41216
  v_fma_f32 v202, -v82, v82, s37
  v_fma_f32 v203, -v83, v83, s37
  v_mfma_f32_16x16x32_bf16 v[24:27], a[164:167], a[24:27], v[24:27]
  buffer_load_dwordx4 v209, s[16:19], s35 offen sc1 lds
  v_mul_f32 v200, v80, v200
  v_mfma_f32_16x16x32_bf16 v[24:27], a[168:171], a[32:35], v[24:27]
  s_add_u32 m0, s30, 135168
  ds_read_b64_tr_b16 a[200:201], v205 offset:24576
  ds_read_b64_tr_b16 a[202:203], v205 offset:24832
  v_mul_f32 v201, v81, v201
  v_mfma_f32_16x16x32_bf16 v[24:27], a[172:175], a[40:43], v[24:27]
  s_add_u32 s35, s33, 256
  ds_read_b64_tr_b16 a[204:205], v205 offset:26624
  v_mul_f32 v202, v82, v202
  v_mul_f32 v203, v83, v203
  v_mfma_f32_16x16x32_bf16 v[28:31], a[164:167], a[28:31], v[28:31]
  ds_read_b64_tr_b16 a[206:207], v205 offset:26880
  ds_read_b64_tr_b16 a[144:145], v205 offset:28672
  v_exp_f32 v200, v200
  v_mfma_f32_16x16x32_bf16 v[28:31], a[168:171], a[36:39], v[28:31]
  v_exp_f32 v201, v201
  v_exp_f32 v202, v202
  v_mfma_f32_16x16x32_bf16 v[28:31], a[172:175], a[44:47], v[28:31]
  ds_read_b64_tr_b16 a[146:147], v205 offset:28928
  ds_read_b64_tr_b16 a[148:149], v205 offset:36864
  v_exp_f32 v203, v203
  v_mfma_f32_16x16x32_bf16 v[0:3], a[176:179], a[48:51], v[0:3]
  ds_read_b64_tr_b16 a[150:151], v205 offset:37120
  v_mul_f32 v88, v80, v88
  v_mul_f32 v89, v81, v89
  v_mfma_f32_16x16x32_bf16 v[0:3], a[180:183], a[56:59], v[0:3]
  s_waitcnt lgkmcnt(8)
  ds_read_b64_tr_b16 a[152:153], v205 offset:38912
  ds_read_b64_tr_b16 a[154:155], v205 offset:39168
  v_mul_f32 v90, v82, v90
  v_mfma_f32_16x16x32_bf16 v[0:3], a[184:187], a[64:67], v[0:3]
  buffer_load_dwordx4 v224, s[16:19], s35 offen sc1 lds
  v_mul_f32 v91, v83, v91
  v_mfma_f32_16x16x32_bf16 v[4:7], a[176:179], a[52:55], v[4:7]
  s_add_u32 m0, s30, 139264
  ds_read_b64_tr_b16 a[156:157], v205 offset:40960
  v_add_f32 v200, 1.0, v200
  v_add_f32 v201, 1.0, v201
  v_mfma_f32_16x16x32_bf16 v[4:7], a[180:183], a[60:63], v[4:7]
  s_add_u32 s35, s33, 37120
  ds_read_b64_tr_b16 a[158:159], v205 offset:41216
  ds_read_b64_tr_b16 a[160:161], v204 offset:30720
  v_add_f32 v202, 1.0, v202
  v_mfma_f32_16x16x32_bf16 v[4:7], a[184:187], a[68:71], v[4:7]
  ds_read_b64_tr_b16 a[162:163], v204 offset:30976
  v_add_f32 v203, 1.0, v203
  v_rcp_f32 v200, v200
  v_mfma_f32_16x16x32_bf16 v[8:11], a[188:191], a[48:51], v[8:11]
  ds_read_b64_tr_b16 a[164:165], v204 offset:32768
  ds_read_b64_tr_b16 a[166:167], v204 offset:33024
  v_rcp_f32 v201, v201
  v_mfma_f32_16x16x32_bf16 v[8:11], a[192:195], a[56:59], v[8:11]
  buffer_load_dwordx4 v224, s[16:19], s35 offen sc1 lds
  v_rcp_f32 v202, v202
  v_mfma_f32_16x16x32_bf16 v[8:11], a[196:199], a[64:67], v[8:11]
  s_add_u32 m0, s30, 143360
  ds_read_b64_tr_b16 a[168:169], v204 offset:34816
  ds_read_b64_tr_b16 a[170:171], v204 offset:35072
  v_rcp_f32 v203, v203
  v_mfma_f32_16x16x32_bf16 v[12:15], a[188:191], a[52:55], v[12:15]
  s_add_u32 s35, s33, 73984
  v_mul_f32 v88, v88, v200
  v_mul_f32 v89, v89, v201
  v_mul_f32 v90, v90, v202
  v_mfma_f32_16x16x32_bf16 v[12:15], a[192:195], a[60:63], v[12:15]
  ds_read_b64_tr_b16 a[172:173], v204 offset:43008
  v_mul_f32 v91, v91, v203
  v_cvt_pk_bf16_f32 v178, v88, v89
  v_mfma_f32_16x16x32_bf16 v[12:15], a[196:199], a[68:71], v[12:15]
  s_waitcnt lgkmcnt(9)
  ds_read_b64_tr_b16 a[174:175], v204 offset:43264
  ds_read_b64_tr_b16 a[176:177], v204 offset:45056
  v_cvt_pk_bf16_f32 v179, v90, v91
  v_mfma_f32_16x16x32_bf16 v[16:19], a[200:203], a[48:51], v[16:19]
  s_add_u32 s28, s76, 12288
  ds_read_b64_tr_b16 a[178:179], v204 offset:45312
  ds_read_b64_tr_b16 a[180:181], v204 offset:47104
  buffer_store_dwordx4 v[176:179], v225, s[56:59], s28 offen sc1
  v_mfma_f32_16x16x32_bf16 v[16:19], a[204:207], a[56:59], v[16:19]
  v_fma_f32 v200, -v84, v84, s37
  v_fma_f32 v201, -v85, v85, s37
  v_fma_f32 v202, -v86, v86, s37
  v_mfma_f32_16x16x32_bf16 v[16:19], a[144:147], a[64:67], v[16:19]
  buffer_load_dwordx4 v224, s[16:19], s35 offen sc1 lds
  v_fma_f32 v203, -v87, v87, s37
  v_mfma_f32_16x16x32_bf16 v[20:23], a[200:203], a[52:55], v[20:23]
  ds_read_b64_tr_b16 a[182:183], v204 offset:47360
  ds_read_b64_tr_b16 a[184:185], v205 offset:30720
  v_mul_f32 v200, v84, v200
  v_mfma_f32_16x16x32_bf16 v[20:23], a[204:207], a[60:63], v[20:23]
  ds_read_b64_tr_b16 a[186:187], v205 offset:30976
  v_mul_f32 v201, v85, v201
  v_mul_f32 v202, v86, v202
  v_mfma_f32_16x16x32_bf16 v[20:23], a[144:147], a[68:71], v[20:23]
  ds_read_b64_tr_b16 a[188:189], v205 offset:32768
  v_mul_f32 v203, v87, v203
  v_exp_f32 v200, v200
  v_mfma_f32_16x16x32_bf16 v[24:27], a[148:151], a[48:51], v[24:27]
  ds_read_b64_tr_b16 a[190:191], v205 offset:33024
  ds_read_b64_tr_b16 a[192:193], v205 offset:34816
  v_exp_f32 v201, v201
  v_mfma_f32_16x16x32_bf16 v[24:27], a[152:155], a[56:59], v[24:27]
  s_waitcnt lgkmcnt(9)
  ds_read_b64_tr_b16 a[194:195], v205 offset:35072
  ds_read_b64_tr_b16 a[196:197], v205 offset:43008
  v_exp_f32 v202, v202
  v_mfma_f32_16x16x32_bf16 v[24:27], a[156:159], a[64:67], v[24:27]
  v_exp_f32 v203, v203
  v_mul_f32 v92, v84, v92
  v_mfma_f32_16x16x32_bf16 v[28:31], a[148:151], a[52:55], v[28:31]
  ds_read_b64_tr_b16 a[198:199], v205 offset:43264
  v_mul_f32 v93, v85, v93
  v_mul_f32 v94, v86, v94
  v_mfma_f32_16x16x32_bf16 v[28:31], a[152:155], a[60:63], v[28:31]
  ds_read_b64_tr_b16 a[200:201], v205 offset:45056
  ds_read_b64_tr_b16 a[202:203], v205 offset:45312
  v_mul_f32 v95, v87, v95
  v_mfma_f32_16x16x32_bf16 v[28:31], a[156:159], a[68:71], v[28:31]
  ds_read_b64_tr_b16 a[204:205], v205 offset:47104
  v_add_f32 v200, 1.0, v200
  v_add_f32 v201, 1.0, v201
  v_mfma_f32_16x16x32_bf16 v[0:3], a[160:163], a[72:75], v[0:3]
  ds_read_b64_tr_b16 a[206:207], v205 offset:47360
  v_add_f32 v202, 1.0, v202
  v_add_f32 v203, 1.0, v203
  v_mfma_f32_16x16x32_bf16 v[0:3], a[164:167], a[80:83], v[0:3]
  v_rcp_f32 v200, v200
  v_rcp_f32 v201, v201
  v_mfma_f32_16x16x32_bf16 v[0:3], a[168:171], a[88:91], v[0:3]
  v_rcp_f32 v202, v202
  v_rcp_f32 v203, v203
  v_mfma_f32_16x16x32_bf16 v[4:7], a[160:163], a[76:79], v[4:7]
  v_mul_f32 v92, v92, v200
  v_mul_f32 v93, v93, v201
  v_mul_f32 v94, v94, v202
  v_mfma_f32_16x16x32_bf16 v[4:7], a[164:167], a[84:87], v[4:7]
  v_mul_f32 v95, v95, v203
  v_cvt_pk_bf16_f32 v182, v92, v93
  v_cvt_pk_bf16_f32 v183, v94, v95
  v_mfma_f32_16x16x32_bf16 v[4:7], a[168:171], a[92:95], v[4:7]
  buffer_store_dwordx4 v[180:183], v225, s[56:59], s28 offen offset:1024 sc1
  v_fma_f32 v200, -v96, v96, s37
  v_mfma_f32_16x16x32_bf16 v[8:11], a[172:175], a[72:75], v[8:11]
  s_waitcnt lgkmcnt(4)
  v_fma_f32 v201, -v97, v97, s37
  v_fma_f32 v202, -v98, v98, s37
  v_fma_f32 v203, -v99, v99, s37
  v_mfma_f32_16x16x32_bf16 v[8:11], a[176:179], a[80:83], v[8:11]
L_st25:
  s_waitcnt vmcnt(16) lgkmcnt(0)
  s_barrier
  ds_read_b64_tr_b16 a[144:145], v206 offset:0
  v_mul_f32 v200, v96, v200
  v_mul_f32 v201, v97, v201
  v_mfma_f32_16x16x32_bf16 v[8:11], a[180:183], a[88:91], v[8:11]
  s_add_u32 m0, s30, 0
  ds_read_b64_tr_b16 a[146:147], v206 offset:256
  v_mul_f32 v202, v98, v202
  v_mul_f32 v203, v99, v203
  v_mfma_f32_16x16x32_bf16 v[12:15], a[172:175], a[76:79], v[12:15]
  s_add_u32 s35, s33, 110848
  ds_read_b64_tr_b16 a[148:149], v206 offset:2048
  ds_read_b64_tr_b16 a[150:151], v206 offset:2304
  v_exp_f32 v200, v200
  v_mfma_f32_16x16x32_bf16 v[12:15], a[176:179], a[84:87], v[12:15]
  v_exp_f32 v201, v201
  v_exp_f32 v202, v202
  v_mfma_f32_16x16x32_bf16 v[12:15], a[180:183], a[92:95], v[12:15]
  ds_read_b64_tr_b16 a[152:153], v206 offset:4096
  ds_read_b64_tr_b16 a[154:155], v206 offset:4352
  v_exp_f32 v203, v203
  v_mfma_f32_16x16x32_bf16 v[16:19], a[184:187], a[72:75], v[16:19]
  v_mul_f32 v104, v96, v104
  v_mul_f32 v105, v97, v105
  v_mul_f32 v106, v98, v106
  v_mfma_f32_16x16x32_bf16 v[16:19], a[188:191], a[80:83], v[16:19]
  buffer_load_dwordx4 v224, s[16:19], s35 offen sc1 lds
  v_mul_f32 v107, v99, v107
  v_mfma_f32_16x16x32_bf16 v[16:19], a[192:195], a[88:91], v[16:19]
  s_add_u32 m0, s30, 4096
  ds_read_b64_tr_b16 a[156:157], v206 offset:12288
  ds_read_b64_tr_b16 a[158:159], v206 offset:12544
  v_add_f32 v200, 1.0, v200
  v_mfma_f32_16x16x32_bf16 v[20:23], a[184:187], a[76:79], v[20:23]
  s_add_u32 s35, s33, 147712
  ds_read_b64_tr_b16 a[160:161], v206 offset:14336
  v_add_f32 v201, 1.0, v201
  v_add_f32 v202, 1.0, v202
  v_mfma_f32_16x16x32_bf16 v[20:23], a[188:191], a[84:87], v[20:23]
  ds_read_b64_tr_b16 a[162:163], v206 offset:14592
  v_add_f32 v203, 1.0, v203
  v_rcp_f32 v200, v200
  v_mfma_f32_16x16x32_bf16 v[20:23], a[192:195], a[92:95], v[20:23]
  ds_read_b64_tr_b16 a[164:165], v206 offset:16384
  ds_read_b64_tr_b16 a[166:167], v206 offset:16640
  v_rcp_f32 v201, v201
  v_mfma_f32_16x16x32_bf16 v[24:27], a[196:199], a[72:75], v[24:27]
  v_rcp_f32 v202, v202
  v_rcp_f32 v203, v203
  v_mfma_f32_16x16x32_bf16 v[24:27], a[200:203], a[80:83], v[24:27]
  buffer_load_dwordx4 v224, s[16:19], s35 offen sc1 lds
  v_mul_f32 v104, v104, v200
  v_mfma_f32_16x16x32_bf16 v[24:27], a[204:207], a[88:91], v[24:27]
  s_add_u32 m0, s30, 8192
  ds_read_b64_tr_b16 a[168:169], v207 offset:0
  ds_read_b64_tr_b16 a[170:171], v207 offset:256
  v_mul_f32 v105, v105, v201
  v_mfma_f32_16x16x32_bf16 v[28:31], a[196:199], a[76:79], v[28:31]
  s_add_u32 s35, s33, 184576
  ds_read_b64_tr_b16 a[172:173], v207 offset:2048
  v_mul_f32 v106, v106, v202
  v_mul_f32 v107, v107, v203
  v_mfma_f32_16x16x32_bf16 v[28:31], a[200:203], a[84:87], v[28:31]
  ds_read_b64_tr_b16 a[174:175], v207 offset:2304
  v_cvt_pk_bf16_f32 v184, v104, v105
  v_cvt_pk_bf16_f32 v185, v106, v107
  v_mfma_f32_16x16x32_bf16 v[28:31], a[204:207], a[92:95], v[28:31]
  s_waitcnt lgkmcnt(8)
  ds_read_b64_tr_b16 a[176:177], v207 offset:4096
  v_fma_f32 v200, -v100, v100, s37
  v_fma_f32 v201, -v101, v101, s37
  v_mfma_f32_16x16x32_bf16 v[0:3], a[144:147], a[96:99], v[0:3]
  ds_read_b64_tr_b16 a[178:179], v207 offset:4352
  v_fma_f32 v202, -v102, v102, s37
  v_fma_f32 v203, -v103, v103, s37
  v_mfma_f32_16x16x32_bf16 v[0:3], a[148:151], a[104:107], v[0:3]
  ds_read_b64_tr_b16 a[180:181], v207 offset:12288
  v_mul_f32 v200, v100, v200
  v_mul_f32 v201, v101, v201
  v_mfma_f32_16x16x32_bf16 v[0:3], a[152:155], a[112:115], v[0:3]
  buffer_load_dwordx4 v224, s[16:19], s35 offen sc1 lds
  v_mul_f32 v202, v102, v202
  v_mfma_f32_16x16x32_bf16 v[4:7], a[144:147], a[100:103], v[4:7]
  s_add_u32 m0, s30, 12288
  ds_read_b64_tr_b16 a[182:183], v207 offset:12544
  ds_read_b64_tr_b16 a[184:185], v207 offset:14336
  v_mul_f32 v203, v103, v203
  v_mfma_f32_16x16x32_bf16 v[4:7], a[148:151], a[108:111], v[4:7]
  s_add_u32 s35, s33, 384
  ds_read_b64_tr_b16 a[186:187], v207 offset:14592
  ds_read_b64_tr_b16 a[188:189], v207 offset:16384
  v_exp_f32 v200, v200
  v_mfma_f32_16x16x32_bf16 v[4:7], a[152:155], a[116:119], v[4:7]
  v_exp_f32 v201, v201
  v_exp_f32 v202, v202
  v_mfma_f32_16x16x32_bf16 v[8:11], a[156:159], a[96:99], v[8:11]
  s_waitcnt lgkmcnt(7)
  ds_read_b64_tr_b16 a[190:191], v207 offset:16640
  ds_read_b64_tr_b16 a[192:193], v206 offset:6144
  v_exp_f32 v203, v203
  v_mfma_f32_16x16x32_bf16 v[8:11], a[160:163], a[104:107], v[8:11]
  v_mul_f32 v108, v100, v108
  v_mul_f32 v109, v101, v109
  v_mul_f32 v110, v102, v110
  v_mfma_f32_16x16x32_bf16 v[8:11], a[164:167], a[112:115], v[8:11]
  ds_read_b64_tr_b16 a[194:195], v206 offset:6400
  v_mul_f32 v111, v103, v111
  v_add_f32 v200, 1.0, v200
  v_mfma_f32_16x16x32_bf16 v[12:15], a[156:159], a[100:103], v[12:15]
  buffer_load_dwordx4 v224, s[16:19], s35 offen sc1 lds
  v_add_f32 v201, 1.0, v201
  v_mfma_f32_16x16x32_bf16 v[12:15], a[160:163], a[108:111], v[12:15]
  s_add_u32 m0, s30, 16384
  ds_read_b64_tr_b16 a[196:197], v206 offset:8192
  ds_read_b64_tr_b16 a[198:199], v206 offset:8448
  v_add_f32 v202, 1.0, v202
  v_mfma_f32_16x16x32_bf16 v[12:15], a[164:167], a[116:119], v[12:15]
  s_add_u32 s35, s33, 37248
  ds_read_b64_tr_b16 a[200:201], v206 offset:10240
  v_add_f32 v203, 1.0, v203
  v_rcp_f32 v200, v200
  v_mfma_f32_16x16x32_bf16 v[16:19], a[168:171], a[96:99], v[16:19]
  ds_read_b64_tr_b16 a[202:203], v206 offset:10496
  ds_read_b64_tr_b16 a[204:205], v206 offset:18432
  v_rcp_f32 v201, v201
  v_mfma_f32_16x16x32_bf16 v[16:19], a[172:175], a[104:107], v[16:19]
  s_waitcnt lgkmcnt(9)
  v_rcp_f32 v202, v202
  v_rcp_f32 v203, v203
  v_mfma_f32_16x16x32_bf16 v[16:19], a[176:179], a[112:115], v[16:19]
  ds_read_b64_tr_b16 a[206:207], v206 offset:18688
  v_mul_f32 v108, v108, v200
  v_mul_f32 v109, v109, v201
  v_mfma_f32_16x16x32_bf16 v[20:23], a[168:171], a[100:103], v[20:23]
  buffer_load_dwordx4 v224, s[16:19], s35 offen sc1 lds
  v_mul_f32 v110, v110, v202
  v_mfma_f32_16x16x32_bf16 v[20:23], a[172:175], a[108:111], v[20:23]
  s_add_u32 m0, s30, 20480
  ds_read_b64_tr_b16 a[144:145], v206 offset:20480
  ds_read_b64_tr_b16 a[146:147], v206 offset:20736
  v_mul_f32 v111, v111, v203
  v_mfma_f32_16x16x32_bf16 v[20:23], a[176:179], a[116:119], v[20:23]
  s_add_u32 s35, s33, 74112
  ds_read_b64_tr_b16 a[148:149], v206 offset:22528
  v_cvt_pk_bf16_f32 v188, v108, v109
  v_cvt_pk_bf16_f32 v189, v110, v111
  v_mfma_f32_16x16x32_bf16 v[24:27], a[180:183], a[96:99], v[24:27]
  ds_read_b64_tr_b16 a[150:151], v206 offset:22784
  v_fma_f32 v200, -v112, v112, s37
  v_fma_f32 v201, -v113, v113, s37
  v_mfma_f32_16x16x32_bf16 v[24:27], a[184:187], a[104:107], v[24:27]
  s_waitcnt lgkmcnt(8)
  ds_read_b64_tr_b16 a[152:153], v207 offset:6144
  v_fma_f32 v202, -v114, v114, s37
  v_fma_f32 v203, -v115, v115, s37
  v_mfma_f32_16x16x32_bf16 v[24:27], a[188:191], a[112:115], v[24:27]
  ds_read_b64_tr_b16 a[154:155], v207 offset:6400
  v_mul_f32 v200, v112, v200
  v_mul_f32 v201, v113, v201
  v_mfma_f32_16x16x32_bf16 v[28:31], a[180:183], a[100:103], v[28:31]
  ds_read_b64_tr_b16 a[156:157], v207 offset:8192
  ds_read_b64_tr_b16 a[158:159], v207 offset:8448
  v_mul_f32 v202, v114, v202
  v_mfma_f32_16x16x32_bf16 v[28:31], a[184:187], a[108:111], v[28:31]
  buffer_load_dwordx4 v224, s[16:19], s35 offen sc1 lds
  v_mul_f32 v203, v115, v203
  v_mfma_f32_16x16x32_bf16 v[28:31], a[188:191], a[116:119], v[28:31]
  s_add_u32 m0, s30, 24576
  ds_read_b64_tr_b16 a[160:161], v207 offset:10240
  ds_read_b64_tr_b16 a[162:163], v207 offset:10496
  v_exp_f32 v200, v200
  v_mfma_f32_16x16x32_bf16 v[0:3], a[192:195], a[120:123], v[0:3]
  s_add_u32 s35, s33, 110976
  ds_read_b64_tr_b16 a[164:165], v207 offset:18432
  ds_read_b64_tr_b16 a[166:167], v207 offset:18688
  v_exp_f32 v201, v201
  v_mfma_f32_16x16x32_bf16 v[0:3], a[196:199], a[128:131], v[0:3]
  s_waitcnt lgkmcnt(10)
  v_exp_f32 v202, v202
  v_exp_f32 v203, v203
  v_mfma_f32_16x16x32_bf16 v[0:3], a[200:203], a[136:139], v[0:3]
  ds_read_b64_tr_b16 a[168:169], v207 offset:20480
  v_mul_f32 v120, v112, v120
  v_mul_f32 v121, v113, v121
  v_mfma_f32_16x16x32_bf16 v[4:7], a[192:195], a[124:127], v[4:7]
  ds_read_b64_tr_b16 a[170:171], v207 offset:20736
  v_mul_f32 v122, v114, v122
  v_mul_f32 v123, v115, v123
  v_mfma_f32_16x16x32_bf16 v[4:7], a[196:199], a[132:135], v[4:7]
  ds_read_b64_tr_b16 a[172:173], v207 offset:22528
  v_add_f32 v200, 1.0, v200
  v_add_f32 v201, 1.0, v201
  v_mfma_f32_16x16x32_bf16 v[4:7], a[200:203], a[140:143], v[4:7]
  buffer_load_dwordx4 v224, s[16:19], s35 offen sc1 lds
  v_add_f32 v202, 1.0, v202
  v_mfma_f32_16x16x32_bf16 v[8:11], a[204:207], a[120:123], v[8:11]
  s_add_u32 m0, s30, 28672
  ds_read_b64_tr_b16 a[174:175], v207 offset:22784
  ds_read_b64_tr_b16 a[176:177], v230 offset:24576
  v_add_f32 v203, 1.0, v203
  v_mfma_f32_16x16x32_bf16 v[8:11], a[144:147], a[128:131], v[8:11]
L_st26:
  s_waitcnt lgkmcnt(7)
  ds_read_b64_tr_b16 a[178:179], v230 offset:26624
  ds_read_b64_tr_b16 a[180:181], v230 offset:28672
  v_rcp_f32 v200, v200
  v_mfma_f32_16x16x32_bf16 v[8:11], a[148:151], a[136:139], v[8:11]
  s_add_u32 s35, s33, 147840
  v_rcp_f32 v201, v201
  v_rcp_f32 v202, v202
  v_mfma_f32_16x16x32_bf16 v[12:15], a[204:207], a[124:127], v[12:15]
  ds_read_b64_tr_b16 a[182:183], v230 offset:30720
  ds_read_b64_tr_b16 a[184:185], v230 offset:32768
  v_rcp_f32 v203, v203
  v_mfma_f32_16x16x32_bf16 v[12:15], a[144:147], a[132:135], v[12:15]
  v_mul_f32 v120, v120, v200
  v_mul_f32 v121, v121, v201
  v_mul_f32 v122, v122, v202
  v_mfma_f32_16x16x32_bf16 v[12:15], a[148:151], a[140:143], v[12:15]
  buffer_load_dwordx4 v224, s[16:19], s35 offen sc1 lds
  v_mul_f32 v123, v123, v203
  v_mfma_f32_16x16x32_bf16 v[16:19], a[152:155], a[120:123], v[16:19]
  s_add_u32 m0, s30, 32768
  ds_read_b64_tr_b16 a[186:187], v230 offset:34816
  ds_read_b64_tr_b16 a[188:189], v231 offset:24576
  v_cvt_pk_bf16_f32 v186, v120, v121
  v_mfma_f32_16x16x32_bf16 v[16:19], a[156:159], a[128:131], v[16:19]
  s_add_u32 s35, s33, 184704
  ds_read_b64_tr_b16 a[190:191], v231 offset:26624
  v_cvt_pk_bf16_f32 v187, v122, v123
  buffer_store_dwordx4 v[184:187], v225, s[56:59], s28 offen offset:2048 sc1
  v_mfma_f32_16x16x32_bf16 v[16:19], a[160:163], a[136:139], v[16:19]
  ds_read_b64_tr_b16 a[192:193], v231 offset:28672
  v_fma_f32 v200, -v116, v116, s37
  v_fma_f32 v201, -v117, v117, s37
  v_mfma_f32_16x16x32_bf16 v[20:23], a[152:155], a[124:127], v[20:23]
  ds_read_b64_tr_b16 a[194:195], v231 offset:30720
  v_fma_f32 v202, -v118, v118, s37
  v_fma_f32 v203, -v119, v119, s37
  v_mfma_f32_16x16x32_bf16 v[20:23], a[156:159], a[132:135], v[20:23]
  ds_read_b64_tr_b16 a[196:197], v231 offset:32768
  ds_read_b64_tr_b16 a[198:199], v231 offset:34816
  v_mul_f32 v200, v116, v200
  v_mfma_f32_16x16x32_bf16 v[20:23], a[160:163], a[140:143], v[20:23]
  s_waitcnt lgkmcnt(8)
  ds_read_b64_tr_b16 a[200:201], v232 offset:24576
  v_mul_f32 v201, v117, v201
  v_mul_f32 v202, v118, v202
  v_mfma_f32_16x16x32_bf16 v[24:27], a[164:167], a[120:123], v[24:27]
  buffer_load_dwordx4 v224, s[16:19], s35 offen sc1 lds
  v_mul_f32 v203, v119, v203
  v_mfma_f32_16x16x32_bf16 v[24:27], a[168:171], a[128:131], v[24:27]
  s_add_u32 m0, s30, 36864
  ds_read_b64_tr_b16 a[202:203], v232 offset:26624
  ds_read_b64_tr_b16 a[204:205], v232 offset:28672
  v_exp_f32 v200, v200
  v_mfma_f32_16x16x32_bf16 v[24:27], a[172:175], a[136:139], v[24:27]
  s_add_u32 s35, s33, 221184
  ds_read_b64_tr_b16 a[206:207], v232 offset:30720
  ds_read_b64_tr_b16 a[144:145], v232 offset:32768
  v_exp_f32 v201, v201
  v_mfma_f32_16x16x32_bf16 v[28:31], a[164:167], a[124:127], v[28:31]
  v_exp_f32 v202, v202
  v_exp_f32 v203, v203
  v_mfma_f32_16x16x32_bf16 v[28:31], a[168:171], a[132:135], v[28:31]
  ds_read_b64_tr_b16 a[146:147], v232 offset:34816
  v_mul_f32 v124, v116, v124
  v_mul_f32 v125, v117, v125
  v_mfma_f32_16x16x32_bf16 v[28:31], a[172:175], a[140:143], v[28:31]
  ds_read_b64_tr_b16 a[148:149], v233 offset:24576
  ds_read_b64_tr_b16 a[150:151], v233 offset:26624
  v_mul_f32 v126, v118, v126
  v_mfma_f32_16x16x32_bf16 v[32:35], a[176:179], v[128:131], 0
  ds_read_b64_tr_b16 a[152:153], v233 offset:28672
  v_mul_f32 v127, v119, v127
  v_add_f32 v200, 1.0, v200
  v_mfma_f32_16x16x32_bf16 v[32:35], a[180:183], v[136:139], v[32:35]
  s_waitcnt lgkmcnt(9)
  ds_read_b64_tr_b16 a[154:155], v233 offset:30720
  ds_read_b64_tr_b16 a[156:157], v233 offset:32768
  v_add_f32 v201, 1.0, v201
  v_mfma_f32_16x16x32_bf16 v[32:35], a[184:187], v[144:147], v[32:35]
  buffer_load_dwordx4 v224, s[16:19], s35 offen sc1 lds
  v_add_f32 v202, 1.0, v202
  v_mfma_f32_16x16x32_bf16 v[48:51], a[176:179], v[132:135], 0
  s_add_u32 m0, s30, 40960
  ds_read_b64_tr_b16 a[158:159], v233 offset:34816
  v_add_f32 v203, 1.0, v203
  v_rcp_f32 v200, v200
  v_mfma_f32_16x16x32_bf16 v[48:51], a[180:183], v[140:143], v[48:51]
  s_add_u32 s35, s33, 258048
  ds_read_b64_tr_b16 a[160:161], v230 offset:36864
  ds_read_b64_tr_b16 a[162:163], v230 offset:38912
  v_rcp_f32 v201, v201
  v_mfma_f32_16x16x32_bf16 v[48:51], a[184:187], v[148:151], v[48:51]
  v_rcp_f32 v202, v202
  v_rcp_f32 v203, v203
  v_mfma_f32_16x16x32_bf16 v[36:39], a[188:191], v[128:131], 0
  ds_read_b64_tr_b16 a[164:165], v230 offset:40960
  v_mul_f32 v124, v124, v200
  v_mul_f32 v125, v125, v201
  v_mfma_f32_16x16x32_bf16 v[36:39], a[192:195], v[136:139], v[36:39]
  buffer_load_dwordx4 v224, s[16:19], s35 offen sc1 lds
  v_mul_f32 v126, v126, v202
  v_mfma_f32_16x16x32_bf16 v[36:39], a[196:199], v[144:147], v[36:39]
  s_add_u32 m0, s30, 45056
  ds_read_b64_tr_b16 a[166:167], v230 offset:43008
  ds_read_b64_tr_b16 a[168:169], v230 offset:45056
  v_mul_f32 v127, v127, v203
  v_mfma_f32_16x16x32_bf16 v[52:55], a[188:191], v[132:135], 0
  s_add_u32 s35, s34, 0
  ds_read_b64_tr_b16 a[170:171], v230 offset:47104
  v_cvt_pk_bf16_f32 v190, v124, v125
  v_cvt_pk_bf16_f32 v191, v126, v127
  v_mfma_f32_16x16x32_bf16 v[52:55], a[192:195], v[140:143], v[52:55]
  ds_read_b64_tr_b16 a[172:173], v231 offset:36864
  ds_read_b64_tr_b16 a[174:175], v231 offset:38912
  buffer_store_dwordx4 v[188:191], v225, s[56:59], s28 offen offset:3072 sc1
  v_mfma_f32_16x16x32_bf16 v[52:55], a[196:199], v[148:151], v[52:55]
  s_waitcnt lgkmcnt(8)
  ds_read_b64_tr_b16 a[176:177], v231 offset:40960
  v_fma_f32 v200, -v0, v0, s37
  v_fma_f32 v201, -v1, v1, s37
  v_mfma_f32_16x16x32_bf16 v[40:43], a[200:203], v[128:131], 0
  ds_read_b64_tr_b16 a[178:179], v231 offset:43008
  v_fma_f32 v202, -v2, v2, s37
  v_fma_f32 v203, -v3, v3, s37
  v_mfma_f32_16x16x32_bf16 v[40:43], a[204:207], v[136:139], v[40:43]
  ds_read_b64_tr_b16 a[180:181], v231 offset:45056
  v_mul_f32 v200, v0, v200
  v_mul_f32 v201, v1, v201
  v_mfma_f32_16x16x32_bf16 v[40:43], a[144:147], v[144:147], v[40:43]
  buffer_load_dwordx4 v224, s[16:19], s35 offen sc1 lds
  v_mul_f32 v202, v2, v202
  v_mfma_f32_16x16x32_bf16 v[56:59], a[200:203], v[132:135], 0
  ds_read_b64_tr_b16 a[182:183], v231 offset:47104
  ds_read_b64_tr_b16 a[184:185], v232 offset:36864
  v_mul_f32 v203, v3, v203
  v_mfma_f32_16x16x32_bf16 v[56:59], a[204:207], v[140:143], v[56:59]
  ds_read_b64_tr_b16 a[186:187], v232 offset:38912
  ds_read_b64_tr_b16 a[188:189], v232 offset:40960
  v_exp_f32 v200, v200
  v_mfma_f32_16x16x32_bf16 v[56:59], a[144:147], v[148:151], v[56:59]
  v_exp_f32 v201, v201
  v_exp_f32 v202, v202
  v_mfma_f32_16x16x32_bf16 v[44:47], a[148:151], v[128:131], 0
  ds_read_b64_tr_b16 a[190:191], v232 offset:43008
  ds_read_b64_tr_b16 a[192:193], v232 offset:45056
  v_exp_f32 v203, v203
  v_mfma_f32_16x16x32_bf16 v[44:47], a[152:155], v[136:139], v[44:47]
  ds_read_b64_tr_b16 a[194:195], v232 offset:47104
  v_mul_f32 v8, v0, v8
  v_mul_f32 v9, v1, v9
  v_mfma_f32_16x16x32_bf16 v[44:47], a[156:159], v[144:147], v[44:47]
  ds_read_b64_tr_b16 a[196:197], v233 offset:36864
  v_mul_f32 v10, v2, v10
  v_mul_f32 v11, v3, v11
  v_mfma_f32_16x16x32_bf16 v[60:63], a[148:151], v[132:135], 0
  ds_read_b64_tr_b16 a[198:199], v233 offset:38912
  v_add_f32 v200, 1.0, v200
  v_add_f32 v201, 1.0, v201
  v_mfma_f32_16x16x32_bf16 v[60:63], a[152:155], v[140:143], v[60:63]
  ds_read_b64_tr_b16 a[200:201], v233 offset:40960
  ds_read_b64_tr_b16 a[202:203], v233 offset:43008
  v_add_f32 v202, 1.0, v202
  v_mfma_f32_16x16x32_bf16 v[60:63], a[156:159], v[148:151], v[60:63]
  s_waitcnt lgkmcnt(10)
  ds_read_b64_tr_b16 a[204:205], v233 offset:45056
  v_add_f32 v203, 1.0, v203
  v_rcp_f32 v200, v200
  v_mfma_f32_16x16x32_bf16 v[32:35], a[160:163], v[152:155], v[32:35]
  ds_read_b64_tr_b16 a[206:207], v233 offset:47104
  v_rcp_f32 v201, v201
  v_mfma_f32_16x16x32_bf16 v[32:35], a[164:167], v[160:163], v[32:35]
  v_rcp_f32 v202, v202
  v_rcp_f32 v203, v203
  v_mfma_f32_16x16x32_bf16 v[32:35], a[168:171], v[168:171], v[32:35]
  v_mul_f32 v8, v8, v200
  v_mul_f32 v9, v9, v201
  v_mul_f32 v10, v10, v202
  v_mfma_f32_16x16x32_bf16 v[48:51], a[160:163], v[156:159], v[48:51]
  v_mul_f32 v11, v11, v203
  v_cvt_pk_bf16_f32 v192, v8, v9
  v_cvt_pk_bf16_f32 v193, v10, v11
  v_mfma_f32_16x16x32_bf16 v[48:51], a[164:167], v[164:167], v[48:51]
  v_fma_f32 v200, -v4, v4, s37
  v_fma_f32 v201, -v5, v5, s37
  v_fma_f32 v202, -v6, v6, s37
  v_mfma_f32_16x16x32_bf16 v[48:51], a[168:171], v[172:175], v[48:51]
  v_fma_f32 v203, -v7, v7, s37
  v_mul_f32 v200, v4, v200
  v_mul_f32 v201, v5, v201
  v_mfma_f32_16x16x32_bf16 v[36:39], a[172:175], v[152:155], v[36:39]
  v_mul_f32 v202, v6, v202
  v_mul_f32 v203, v7, v203
  v_exp_f32 v200, v200
  v_mfma_f32_16x16x32_bf16 v[36:39], a[176:179], v[160:163], v[36:39]
L_st27:
  s_waitcnt vmcnt(15) lgkmcnt(0)
  s_barrier
  ds_read_b64_tr_b16 a[144:145], v234 offset:0
  v_add_u32 v204, 0, v208
  v_xor_b32 v205, 32, v204
  v_mfma_f32_16x16x32_bf16 v[36:39], a[180:183], v[168:171], v[36:39]
  s_add_u32 m0, s30, 49152
  ds_read_b64_tr_b16 a[146:147], v234 offset:2048
  v_add_u32 v206, 49152, v208
  v_xor_b32 v207, 32, v206
  v_mfma_f32_16x16x32_bf16 v[52:55], a[172:175], v[156:159], v[52:55]
  s_add_u32 s35, s33, 221312
  ds_read_b64_tr_b16 a[148:149], v234 offset:4096
  v_add_u32 v212, 98304, v208
  v_xor_b32 v213, 32, v212
  v_mfma_f32_16x16x32_bf16 v[52:55], a[176:179], v[164:167], v[52:55]
  ds_read_b64_tr_b16 a[150:151], v234 offset:6144
  ds_read_b64_tr_b16 a[152:153], v234 offset:8192
  v_exp_f32 v201, v201
  v_mfma_f32_16x16x32_bf16 v[52:55], a[180:183], v[172:175], v[52:55]
  v_exp_f32 v202, v202
  v_exp_f32 v203, v203
  v_mfma_f32_16x16x32_bf16 v[40:43], a[184:187], v[152:155], v[40:43]
  ds_read_b64_tr_b16 a[154:155], v234 offset:10240
  v_mul_f32 v12, v4, v12
  v_mul_f32 v13, v5, v13
  v_mfma_f32_16x16x32_bf16 v[40:43], a[188:191], v[160:163], v[40:43]
  buffer_load_dwordx4 v224, s[16:19], s35 offen sc1 lds
  v_mul_f32 v14, v6, v14
  v_mfma_f32_16x16x32_bf16 v[40:43], a[192:195], v[168:171], v[40:43]
  s_add_u32 m0, s30, 53248
  ds_read_b64_tr_b16 a[156:157], v235 offset:0
  ds_read_b64_tr_b16 a[158:159], v235 offset:2048
  v_mul_f32 v15, v7, v15
  v_mfma_f32_16x16x32_bf16 v[56:59], a[184:187], v[156:159], v[56:59]
  s_add_u32 s35, s33, 258176
  ds_read_b64_tr_b16 a[160:161], v235 offset:4096
  v_add_f32 v200, 1.0, v200
  v_add_f32 v201, 1.0, v201
  v_mfma_f32_16x16x32_bf16 v[56:59], a[188:191], v[164:167], v[56:59]
  buffer_load_dword v211, off, s[60:63], s101 sc1
  v_add_f32 v202, 1.0, v202
  v_mfma_f32_16x16x32_bf16 v[56:59], a[192:195], v[172:175], v[56:59]
  ds_read_b64_tr_b16 a[162:163], v235 offset:6144
  ds_read_b64_tr_b16 a[164:165], v235 offset:8192
  v_add_f32 v203, 1.0, v203
  v_mfma_f32_16x16x32_bf16 v[44:47], a[196:199], v[152:155], v[44:47]
  ds_read_b64_tr_b16 a[166:167], v235 offset:10240
  ds_read_b64_tr_b16 a[168:169], v236 offset:0
  v_rcp_f32 v200, v200
  v_mfma_f32_16x16x32_bf16 v[44:47], a[200:203], v[160:163], v[44:47]
  buffer_load_dwordx4 v224, s[16:19], s35 offen sc1 lds
  v_rcp_f32 v201, v201
  v_mfma_f32_16x16x32_bf16 v[44:47], a[204:207], v[168:171], v[44:47]
  s_add_u32 m0, s30, 57344
  ds_read_b64_tr_b16 a[170:171], v236 offset:2048
  ds_read_b64_tr_b16 a[172:173], v236 offset:4096
  v_rcp_f32 v202, v202
  v_mfma_f32_16x16x32_bf16 v[60:63], a[196:199], v[156:159], v[60:63]
  s_add_u32 s35, s34, 128
  v_rcp_f32 v203, v203
  v_mul_f32 v12, v12, v200
  v_mfma_f32_16x16x32_bf16 v[60:63], a[200:203], v[164:167], v[60:63]
  ds_read_b64_tr_b16 a[174:175], v236 offset:6144
  v_mul_f32 v13, v13, v201
  v_mul_f32 v14, v14, v202
  v_mfma_f32_16x16x32_bf16 v[60:63], a[204:207], v[172:175], v[60:63]
  s_waitcnt lgkmcnt(8)
  ds_read_b64_tr_b16 a[176:177], v236 offset:8192
  v_mul_f32 v15, v15, v203
  v_cvt_pk_bf16_f32 v196, v12, v13
  v_mfma_f32_16x16x32_bf16 v[64:67], a[144:147], v[128:131], 0
  ds_read_b64_tr_b16 a[178:179], v236 offset:10240
  ds_read_b64_tr_b16 a[180:181], v237 offset:0
  v_cvt_pk_bf16_f32 v197, v14, v15
  v_mfma_f32_16x16x32_bf16 v[64:67], a[148:151], v[136:139], v[64:67]
  ds_read_b64_tr_b16 a[182:183], v237 offset:2048
  v_fma_f32 v200, -v16, v16, s37
  v_fma_f32 v201, -v17, v17, s37
  v_mfma_f32_16x16x32_bf16 v[64:67], a[152:155], v[144:147], v[64:67]
  buffer_load_dwordx4 v224, s[16:19], s35 offen sc1 lds
  v_fma_f32 v202, -v18, v18, s37
  v_mfma_f32_16x16x32_bf16 v[80:83], a[144:147], v[132:135], 0
  s_add_u32 m0, s30, 61440
  ds_read_b64_tr_b16 a[184:185], v237 offset:4096
  ds_read_b64_tr_b16 a[186:187], v237 offset:6144
  v_fma_f32 v203, -v19, v19, s37
  v_mfma_f32_16x16x32_bf16 v[80:83], a[148:151], v[140:143], v[80:83]
  s_add_u32 s35, s33, 221440
  ds_read_b64_tr_b16 a[188:189], v237 offset:8192
  v_mul_f32 v200, v16, v200
  v_mul_f32 v201, v17, v201
  v_mfma_f32_16x16x32_bf16 v[80:83], a[152:155], v[148:151], v[80:83]
  ds_read_b64_tr_b16 a[190:191], v237 offset:10240
  v_mul_f32 v202, v18, v202
  v_mul_f32 v203, v19, v203
  v_mfma_f32_16x16x32_bf16 v[68:71], a[156:159], v[128:131], 0
  s_waitcnt lgkmcnt(8)
  ds_read_b64_tr_b16 a[192:193], v234 offset:12288
  ds_read_b64_tr_b16 a[194:195], v234 offset:14336
  v_exp_f32 v200, v200
  v_mfma_f32_16x16x32_bf16 v[68:71], a[160:163], v[136:139], v[68:71]
  v_exp_f32 v201, v201
  v_exp_f32 v202, v202
  v_mfma_f32_16x16x32_bf16 v[68:71], a[164:167], v[144:147], v[68:71]
  ds_read_b64_tr_b16 a[196:197], v234 offset:16384
  ds_read_b64_tr_b16 a[198:199], v234 offset:18432
  v_exp_f32 v203, v203
  v_mfma_f32_16x16x32_bf16 v[84:87], a[156:159], v[132:135], 0
  buffer_load_dwordx4 v224, s[16:19], s35 offen sc1 lds
  v_mul_f32 v24, v16, v24
  v_mfma_f32_16x16x32_bf16 v[84:87], a[160:163], v[140:143], v[84:87]
  s_add_u32 m0, s30, 65536
  ds_read_b64_tr_b16 a[200:201], v234 offset:20480
  v_mul_f32 v25, v17, v25
  v_mul_f32 v26, v18, v26
  v_mfma_f32_16x16x32_bf16 v[84:87], a[164:167], v[148:151], v[84:87]
  s_add_u32 s35, s33, 258304
  ds_read_b64_tr_b16 a[202:203], v234 offset:22528
  v_mul_f32 v27, v19, v27
  v_add_f32 v200, 1.0, v200
  v_mfma_f32_16x16x32_bf16 v[72:75], a[168:171], v[128:131], 0
  ds_read_b64_tr_b16 a[204:205], v235 offset:12288
  v_add_f32 v201, 1.0, v201
  v_add_f32 v202, 1.0, v202
  v_mfma_f32_16x16x32_bf16 v[72:75], a[172:175], v[136:139], v[72:75]
  s_waitcnt lgkmcnt(7)
  ds_read_b64_tr_b16 a[206:207], v235 offset:14336
  v_add_f32 v203, 1.0, v203
  v_rcp_f32 v200, v200
  v_mfma_f32_16x16x32_bf16 v[72:75], a[176:179], v[144:147], v[72:75]
  ds_read_b64_tr_b16 a[144:145], v235 offset:16384
  ds_read_b64_tr_b16 a[146:147], v235 offset:18432
  v_rcp_f32 v201, v201
  v_mfma_f32_16x16x32_bf16 v[88:91], a[168:171], v[132:135], 0
  buffer_load_dwordx4 v224, s[16:19], s35 offen sc1 lds
  v_rcp_f32 v202, v202
  v_mfma_f32_16x16x32_bf16 v[88:91], a[172:175], v[140:143], v[88:91]
  s_add_u32 m0, s30, 69632
  ds_read_b64_tr_b16 a[148:149], v235 offset:20480
  ds_read_b64_tr_b16 a[150:151], v235 offset:22528
  v_rcp_f32 v203, v203
  v_mfma_f32_16x16x32_bf16 v[88:91], a[176:179], v[148:151], v[88:91]
  s_add_u32 s35, s34, 256
  ds_read_b64_tr_b16 a[152:153], v236 offset:12288
  v_mul_f32 v24, v24, v200
  v_mul_f32 v25, v25, v201
  v_mfma_f32_16x16x32_bf16 v[76:79], a[180:183], v[128:131], 0
  ds_read_b64_tr_b16 a[154:155], v236 offset:14336
  v_mul_f32 v26, v26, v202
  v_mul_f32 v27, v27, v203
  v_mfma_f32_16x16x32_bf16 v[76:79], a[184:187], v[136:139], v[76:79]
  ds_read_b64_tr_b16 a[156:157], v236 offset:16384
  v_cvt_pk_bf16_f32 v194, v24, v25
  v_cvt_pk_bf16_f32 v195, v26, v27
  v_mfma_f32_16x16x32_bf16 v[76:79], a[188:191], v[144:147], v[76:79]
  s_add_u32 s28, s76, 16384
  ds_read_b64_tr_b16 a[158:159], v236 offset:18432
  ds_read_b64_tr_b16 a[160:161], v236 offset:20480
  buffer_store_dwordx4 v[192:195], v225, s[56:59], s28 offen sc1
  v_mfma_f32_16x16x32_bf16 v[92:95], a[180:183], v[132:135], 0
  v_fma_f32 v200, -v20, v20, s37
  v_fma_f32 v201, -v21, v21, s37
  v_fma_f32 v202, -v22, v22, s37
  v_mfma_f32_16x16x32_bf16 v[92:95], a[184:187], v[140:143], v[92:95]
  buffer_load_dwordx4 v224, s[16:19], s35 offen sc1 lds
  v_fma_f32 v203, -v23, v23, s37
  v_mfma_f32_16x16x32_bf16 v[92:95], a[188:191], v[148:151], v[92:95]
  s_waitcnt lgkmcnt(7)
  ds_read_b64_tr_b16 a[162:163], v236 offset:22528
  ds_read_b64_tr_b16 a[164:165], v237 offset:12288
  v_mul_f32 v200, v20, v200
  v_mfma_f32_16x16x32_bf16 v[64:67], a[192:195], v[152:155], v[64:67]
  s_add_u32 m0, s30, 73728
  ds_read_b64_tr_b16 a[166:167], v237 offset:14336
  v_mul_f32 v201, v21, v201
  v_mul_f32 v202, v22, v202
  v_mfma_f32_16x16x32_bf16 v[64:67], a[196:199], v[160:163], v[64:67]
  s_add_u32 s35, s33, 221568
  ds_read_b64_tr_b16 a[168:169], v237 offset:16384
  v_mul_f32 v203, v23, v203
  v_exp_f32 v200, v200
  v_mfma_f32_16x16x32_bf16 v[64:67], a[200:203], v[168:171], v[64:67]
  ds_read_b64_tr_b16 a[170:171], v237 offset:18432
  ds_read_b64_tr_b16 a[172:173], v237 offset:20480
  v_exp_f32 v201, v201
  v_mfma_f32_16x16x32_bf16 v[80:83], a[192:195], v[156:159], v[80:83]
  v_exp_f32 v202, v202
  v_exp_f32 v203, v203
  v_mfma_f32_16x16x32_bf16 v[80:83], a[196:199], v[164:167], v[80:83]
  ds_read_b64_tr_b16 a[174:175], v237 offset:22528
  v_mul_f32 v28, v20, v28
  v_mul_f32 v29, v21, v29
  v_mfma_f32_16x16x32_bf16 v[80:83], a[200:203], v[172:175], v[80:83]
  buffer_load_dwordx4 v224, s[16:19], s35 offen sc1 lds
  v_mul_f32 v30, v22, v30
  v_mfma_f32_16x16x32_bf16 v[68:71], a[204:207], v[152:155], v[68:71]
  s_add_u32 m0, s30, 77824
  ds_read_b64_tr_b16 a[176:177], v212 offset:24576
  ds_read_b64_tr_b16 a[178:179], v212 offset:25600
  v_mul_f32 v31, v23, v31
  v_mfma_f32_16x16x32_bf16 v[68:71], a[144:147], v[160:163], v[68:71]
L_st28:
  s_waitcnt lgkmcnt(8)
  ds_read_b64_tr_b16 a[180:181], v212 offset:26624
  v_add_f32 v200, 1.0, v200
  v_add_f32 v201, 1.0, v201
  v_mfma_f32_16x16x32_bf16 v[68:71], a[148:151], v[168:171], v[68:71]
  s_add_u32 s35, s33, 258432
  ds_read_b64_tr_b16 a[182:183], v212 offset:27648
  v_add_f32 v202, 1.0, v202
  v_add_f32 v203, 1.0, v203
  v_mfma_f32_16x16x32_bf16 v[84:87], a[204:207], v[156:159], v[84:87]
  ds_read_b64_tr_b16 a[184:185], v213 offset:24576
  ds_read_b64_tr_b16 a[186:187], v213 offset:25600
  v_rcp_f32 v200, v200
  v_mfma_f32_16x16x32_bf16 v[84:87], a[144:147], v[164:167], v[84:87]
  v_rcp_f32 v201, v201
  v_rcp_f32 v202, v202
  v_mfma_f32_16x16x32_bf16 v[84:87], a[148:151], v[172:175], v[84:87]
  buffer_load_dwordx4 v224, s[16:19], s35 offen sc1 lds
  v_rcp_f32 v203, v203
  v_mfma_f32_16x16x32_bf16 v[72:75], a[152:155], v[152:155], v[72:75]
  s_add_u32 m0, s30, 81920
  ds_read_b64_tr_b16 a[188:189], v213 offset:26624
  ds_read_b64_tr_b16 a[190:191], v213 offset:27648
  v_mul_f32 v28, v28, v200
  v_mfma_f32_16x16x32_bf16 v[72:75], a[156:159], v[160:163], v[72:75]
  s_add_u32 s35, s34, 384
  ds_read_b64_tr_b16 a[192:193], v212 offset:28672
  v_mul_f32 v29, v29, v201
  v_mul_f32 v30, v30, v202
  v_mfma_f32_16x16x32_bf16 v[72:75], a[160:163], v[168:171], v[72:75]
  ds_read_b64_tr_b16 a[194:195], v212 offset:29696
  v_mul_f32 v31, v31, v203
  v_cvt_pk_bf16_f32 v198, v28, v29
  v_mfma_f32_16x16x32_bf16 v[88:91], a[152:155], v[156:159], v[88:91]
  ds_read_b64_tr_b16 a[196:197], v212 offset:30720
  v_cvt_pk_bf16_f32 v199, v30, v31
  buffer_store_dwordx4 v[196:199], v225, s[56:59], s28 offen offset:1024 sc1
  v_mfma_f32_16x16x32_bf16 v[88:91], a[156:159], v[164:167], v[88:91]
  s_waitcnt vmcnt(9)
  v_cmp_ne_u32 vcc, s94, v211
  s_cbranch_vccnz L_xslow0
L_xok0:
  v_mfma_f32_16x16x32_bf16 v[88:91], a[160:163], v[172:175], v[88:91]
  s_waitcnt lgkmcnt(5)
  ds_read_b64_tr_b16 a[198:199], v212 offset:31744
  ds_read_b64_tr_b16 a[200:201], v213 offset:28672
  v_mfma_f32_16x16x32_bf16 v[76:79], a[164:167], v[152:155], v[76:79]
  s_add_u32 s39, s77, 0
  ds_read_b64_tr_b16 a[202:203], v213 offset:29696
  ds_read_b64_tr_b16 a[204:205], v213 offset:30720
  v_mfma_f32_16x16x32_bf16 v[76:79], a[168:171], v[160:163], v[76:79]
  buffer_load_dwordx4 v224, s[16:19], s35 offen sc1 lds
  v_mfma_f32_16x16x32_bf16 v[76:79], a[172:175], v[168:171], v[76:79]
  s_add_u32 m0, s30, 86016
  ds_read_b64_tr_b16 a[206:207], v213 offset:31744
  v_mfma_f32_16x16x32_bf16 v[92:95], a[164:167], v[156:159], v[92:95]
  s_add_u32 s35, s44, 221184
  ds_read_b64_tr_b16 a[144:145], v212 offset:32768
  ds_read_b64_tr_b16 a[146:147], v212 offset:33792
  v_mfma_f32_16x16x32_bf16 v[92:95], a[168:171], v[164:167], v[92:95]
  buffer_load_dwordx4 a[0:3], v225, s[56:59], s39 offen sc1
  v_mfma_f32_16x16x32_bf16 v[92:95], a[172:175], v[172:175], v[92:95]
  ds_read_b64_tr_b16 a[148:149], v212 offset:34816
  ds_read_b64_tr_b16 a[150:151], v212 offset:35840
  v_mfma_f32_16x16x32_bf16 v[216:219], a[176:179], v[128:131], 0
  ds_read_b64_tr_b16 a[152:153], v213 offset:32768
  v_mfma_f32_16x16x32_bf16 v[216:219], a[180:183], v[136:139], v[216:219]
  buffer_load_dwordx4 v209, s[16:19], s35 offen sc1 lds
  v_mfma_f32_16x16x32_bf16 v[240:243], a[176:179], v[132:135], 0
  s_add_u32 m0, s30, 90112
  ds_read_b64_tr_b16 a[154:155], v213 offset:33792
  ds_read_b64_tr_b16 a[156:157], v213 offset:34816
  v_mfma_f32_16x16x32_bf16 v[240:243], a[180:183], v[140:143], v[240:243]
  s_add_u32 s35, s42, 0
  ds_read_b64_tr_b16 a[158:159], v213 offset:35840
  v_mfma_f32_16x16x32_bf16 v[220:223], a[184:187], v[128:131], 0
  s_waitcnt lgkmcnt(8)
  ds_read_b64_tr_b16 a[160:161], v234 offset:36864
  v_mfma_f32_16x16x32_bf16 v[220:223], a[188:191], v[136:139], v[220:223]
  buffer_load_dwordx4 a[4:7], v225, s[56:59], s39 offen offset:1024 sc1
  v_mfma_f32_16x16x32_bf16 v[244:247], a[184:187], v[132:135], 0
  ds_read_b64_tr_b16 a[162:163], v234 offset:38912
  ds_read_b64_tr_b16 a[164:165], v234 offset:40960
  v_mfma_f32_16x16x32_bf16 v[244:247], a[188:191], v[140:143], v[244:247]
  buffer_load_dwordx4 v224, s[16:19], s35 offen sc1 lds
  v_mfma_f32_16x16x32_bf16 v[216:219], a[192:195], v[144:147], v[216:219]
  s_add_u32 m0, s30, 94208
  ds_read_b64_tr_b16 a[166:167], v234 offset:43008
  ds_read_b64_tr_b16 a[168:169], v234 offset:45056
  v_mfma_f32_16x16x32_bf16 v[216:219], a[196:199], v[152:155], v[216:219]
  s_add_u32 s35, s42, 36864
  ds_read_b64_tr_b16 a[170:171], v234 offset:47104
  v_mfma_f32_16x16x32_bf16 v[240:243], a[192:195], v[148:151], v[240:243]
  buffer_load_dwordx4 a[8:11], v225, s[56:59], s39 offen offset:2048 sc1
  v_mfma_f32_16x16x32_bf16 v[240:243], a[196:199], v[156:159], v[240:243]
  ds_read_b64_tr_b16 a[172:173], v235 offset:36864
  ds_read_b64_tr_b16 a[174:175], v235 offset:38912
  v_mfma_f32_16x16x32_bf16 v[220:223], a[200:203], v[144:147], v[220:223]
  ds_read_b64_tr_b16 a[176:177], v235 offset:40960
  v_mfma_f32_16x16x32_bf16 v[220:223], a[204:207], v[152:155], v[220:223]
  ds_read_b64_tr_b16 a[178:179], v235 offset:43008
  v_mfma_f32_16x16x32_bf16 v[244:247], a[200:203], v[148:151], v[244:247]
  buffer_load_dwordx4 v224, s[16:19], s35 offen sc1 lds
  v_mfma_f32_16x16x32_bf16 v[244:247], a[204:207], v[156:159], v[244:247]
  s_waitcnt lgkmcnt(8)
  ds_read_b64_tr_b16 a[180:181], v235 offset:45056
  ds_read_b64_tr_b16 a[182:183], v235 offset:47104
  v_mfma_f32_16x16x32_bf16 v[216:219], a[144:147], v[160:163], v[216:219]
  buffer_load_dwordx4 a[12:15], v225, s[56:59], s39 offen offset:3072 sc1
  v_mfma_f32_16x16x32_bf16 v[216:219], a[148:151], v[168:171], v[216:219]
  s_add_u32 s39, s77, 4096
  ds_read_b64_tr_b16 a[184:185], v236 offset:36864
  ds_read_b64_tr_b16 a[186:187], v236 offset:38912
  v_mfma_f32_16x16x32_bf16 v[240:243], a[144:147], v[164:167], v[240:243]
  ds_read_b64_tr_b16 a[188:189], v236 offset:40960
  v_mfma_f32_16x16x32_bf16 v[240:243], a[148:151], v[172:175], v[240:243]
  ds_read_b64_tr_b16 a[190:191], v236 offset:43008
  ds_read_b64_tr_b16 a[192:193], v236 offset:45056
  v_mfma_f32_16x16x32_bf16 v[220:223], a[152:155], v[160:163], v[220:223]
  buffer_load_dwordx4 a[16:19], v225, s[56:59], s39 offen sc1
  v_mfma_f32_16x16x32_bf16 v[220:223], a[156:159], v[168:171], v[220:223]
  ds_read_b64_tr_b16 a[194:195], v236 offset:47104
  ds_read_b64_tr_b16 a[196:197], v237 offset:36864
  v_mfma_f32_16x16x32_bf16 v[244:247], a[152:155], v[164:167], v[244:247]
  ds_read_b64_tr_b16 a[198:199], v237 offset:38912
  ds_read_b64_tr_b16 a[200:201], v237 offset:40960
  v_mfma_f32_16x16x32_bf16 v[244:247], a[156:159], v[172:175], v[244:247]
  ds_read_b64_tr_b16 a[202:203], v237 offset:43008
  v_mfma_f32_16x16x32_bf16 v[96:99], a[160:163], v[128:131], 0
  s_waitcnt lgkmcnt(10)
  ds_read_b64_tr_b16 a[204:205], v237 offset:45056
  ds_read_b64_tr_b16 a[206:207], v237 offset:47104
  v_mfma_f32_16x16x32_bf16 v[96:99], a[164:167], v[136:139], v[96:99]
  buffer_load_dwordx4 a[20:23], v225, s[56:59], s39 offen offset:1024 sc1
  v_mfma_f32_16x16x32_bf16 v[96:99], a[168:171], v[144:147], v[96:99]
  v_mfma_f32_16x16x32_bf16 v[112:115], a[160:163], v[132:135], 0
  v_mfma_f32_16x16x32_bf16 v[112:115], a[164:167], v[140:143], v[112:115]
  v_mfma_f32_16x16x32_bf16 v[112:115], a[168:171], v[148:151], v[112:115]
  buffer_load_dwordx4 a[24:27], v225, s[56:59], s39 offen offset:2048 sc1
  v_mfma_f32_16x16x32_bf16 v[100:103], a[172:175], v[128:131], 0
  v_mfma_f32_16x16x32_bf16 v[100:103], a[176:179], v[136:139], v[100:103]
L_st29:
  s_waitcnt vmcnt(22) lgkmcnt(0)
  s_barrier
  ds_read_b64_tr_b16 a[144:145], v226 offset:0
  v_mfma_f32_16x16x32_bf16 v[100:103], a[180:183], v[144:147], v[100:103]
  s_add_u32 m0, s30, 98304
  ds_read_b64_tr_b16 a[146:147], v226 offset:2048
  v_mfma_f32_16x16x32_bf16 v[116:119], a[172:175], v[132:135], 0
  s_add_u32 s35, s42, 73728
  ds_read_b64_tr_b16 a[148:149], v226 offset:4096
  v_mfma_f32_16x16x32_bf16 v[116:119], a[176:179], v[140:143], v[116:119]
  buffer_load_dwordx4 a[28:31], v225, s[56:59], s39 offen offset:3072 sc1
  v_mfma_f32_16x16x32_bf16 v[116:119], a[180:183], v[148:151], v[116:119]
  s_add_u32 s39, s77, 8192
  ds_read_b64_tr_b16 a[150:151], v226 offset:6144
  ds_read_b64_tr_b16 a[152:153], v226 offset:8192
  v_mfma_f32_16x16x32_bf16 v[104:107], a[184:187], v[128:131], 0
  ds_read_b64_tr_b16 a[154:155], v226 offset:10240
  v_mfma_f32_16x16x32_bf16 v[104:107], a[188:191], v[136:139], v[104:107]
  buffer_load_dwordx4 v224, s[16:19], s35 offen sc1 lds
  v_mfma_f32_16x16x32_bf16 v[104:107], a[192:195], v[144:147], v[104:107]
  s_add_u32 m0, s30, 102400
  ds_read_b64_tr_b16 a[156:157], v227 offset:0
  ds_read_b64_tr_b16 a[158:159], v227 offset:2048
  v_mfma_f32_16x16x32_bf16 v[120:123], a[184:187], v[132:135], 0
  s_waitcnt vmcnt(13)
  buffer_store_dword v252, off, s[60:63], s100 offset:128 sc1
  v_mfma_f32_16x16x32_bf16 v[120:123], a[188:191], v[140:143], v[120:123]
  s_add_u32 s35, s42, 110592
  ds_read_b64_tr_b16 a[160:161], v227 offset:4096
  ds_read_b64_tr_b16 a[162:163], v227 offset:6144
  v_mfma_f32_16x16x32_bf16 v[120:123], a[192:195], v[148:151], v[120:123]
  buffer_load_dwordx4 a[32:35], v225, s[56:59], s39 offen sc1
  v_mfma_f32_16x16x32_bf16 v[108:111], a[196:199], v[128:131], 0
  ds_read_b64_tr_b16 a[164:165], v227 offset:8192
  ds_read_b64_tr_b16 a[166:167], v227 offset:10240
  v_mfma_f32_16x16x32_bf16 v[108:111], a[200:203], v[136:139], v[108:111]
  buffer_load_dwordx4 v224, s[16:19], s35 offen sc1 lds
  v_mfma_f32_16x16x32_bf16 v[108:111], a[204:207], v[144:147], v[108:111]
  s_add_u32 m0, s30, 106496
  ds_read_b64_tr_b16 a[168:169], v228 offset:0
  ds_read_b64_tr_b16 a[170:171], v228 offset:2048
  v_mfma_f32_16x16x32_bf16 v[124:127], a[196:199], v[132:135], 0
  s_add_u32 s35, s42, 147456
  ds_read_b64_tr_b16 a[172:173], v228 offset:4096
  v_mfma_f32_16x16x32_bf16 v[124:127], a[200:203], v[140:143], v[124:127]
  buffer_load_dwordx4 a[36:39], v225, s[56:59], s39 offen offset:1024 sc1
  v_mfma_f32_16x16x32_bf16 v[124:127], a[204:207], v[148:151], v[124:127]
  s_waitcnt lgkmcnt(7)
  ds_read_b64_tr_b16 a[174:175], v228 offset:6144
  ds_read_b64_tr_b16 a[176:177], v228 offset:8192
  v_mfma_f32_16x16x32_bf16 v[96:99], a[144:147], v[152:155], v[96:99]
  ds_read_b64_tr_b16 a[178:179], v228 offset:10240
  v_mfma_f32_16x16x32_bf16 v[96:99], a[148:151], v[160:163], v[96:99]
  ds_read_b64_tr_b16 a[180:181], v229 offset:0
  v_mfma_f32_16x16x32_bf16 v[96:99], a[152:155], v[168:171], v[96:99]
  buffer_load_dwordx4 v224, s[16:19], s35 offen sc1 lds
  v_mfma_f32_16x16x32_bf16 v[112:115], a[144:147], v[156:159], v[112:115]
  s_add_u32 m0, s30, 110592
  ds_read_b64_tr_b16 a[182:183], v229 offset:2048
  ds_read_b64_tr_b16 a[184:185], v229 offset:4096
  v_mfma_f32_16x16x32_bf16 v[112:115], a[148:151], v[164:167], v[112:115]
  s_add_u32 s35, s42, 184320
  ds_read_b64_tr_b16 a[186:187], v229 offset:6144
  v_mfma_f32_16x16x32_bf16 v[112:115], a[152:155], v[172:175], v[112:115]
  buffer_load_dwordx4 a[40:43], v225, s[56:59], s39 offen offset:2048 sc1
  v_mfma_f32_16x16x32_bf16 v[100:103], a[156:159], v[152:155], v[100:103]
  s_waitcnt lgkmcnt(8)
  ds_read_b64_tr_b16 a[188:189], v229 offset:8192
  ds_read_b64_tr_b16 a[190:191], v229 offset:10240
  v_mfma_f32_16x16x32_bf16 v[100:103], a[160:163], v[160:163], v[100:103]
  ds_read_b64_tr_b16 a[192:193], v226 offset:12288
  v_mfma_f32_16x16x32_bf16 v[100:103], a[164:167], v[168:171], v[100:103]
  ds_read_b64_tr_b16 a[194:195], v226 offset:14336
  v_mfma_f32_16x16x32_bf16 v[116:119], a[156:159], v[156:159], v[116:119]
  buffer_load_dwordx4 v224, s[16:19], s35 offen sc1 lds
  v_mfma_f32_16x16x32_bf16 v[116:119], a[160:163], v[164:167], v[116:119]
  s_add_u32 m0, s30, 114688
  ds_read_b64_tr_b16 a[196:197], v226 offset:16384
  ds_read_b64_tr_b16 a[198:199], v226 offset:18432
  v_mfma_f32_16x16x32_bf16 v[116:119], a[164:167], v[172:175], v[116:119]
  s_add_u32 s35, s42, 221184
  ds_read_b64_tr_b16 a[200:201], v226 offset:20480
  v_mfma_f32_16x16x32_bf16 v[104:107], a[168:171], v[152:155], v[104:107]
  s_waitcnt lgkmcnt(7)
  ds_read_b64_tr_b16 a[202:203], v226 offset:22528
  v_mfma_f32_16x16x32_bf16 v[104:107], a[172:175], v[160:163], v[104:107]
  buffer_load_dwordx4 a[44:47], v225, s[56:59], s39 offen offset:3072 sc1
  v_mfma_f32_16x16x32_bf16 v[104:107], a[176:179], v[168:171], v[104:107]
  ds_read_b64_tr_b16 a[204:205], v227 offset:12288
  ds_read_b64_tr_b16 a[206:207], v227 offset:14336
  v_mfma_f32_16x16x32_bf16 v[120:123], a[168:171], v[156:159], v[120:123]
  buffer_load_dwordx4 v224, s[16:19], s35 offen sc1 lds
  v_mfma_f32_16x16x32_bf16 v[120:123], a[172:175], v[164:167], v[120:123]
  s_add_u32 m0, s30, 118784
  ds_read_b64_tr_b16 a[144:145], v227 offset:16384
  ds_read_b64_tr_b16 a[146:147], v227 offset:18432
  v_mfma_f32_16x16x32_bf16 v[120:123], a[176:179], v[172:175], v[120:123]
  s_add_u32 s35, s42, 258048
  ds_read_b64_tr_b16 a[148:149], v227 offset:20480
  v_mfma_f32_16x16x32_bf16 v[108:111], a[180:183], v[152:155], v[108:111]
  ds_read_b64_tr_b16 a[150:151], v227 offset:22528
  v_mfma_f32_16x16x32_bf16 v[108:111], a[184:187], v[160:163], v[108:111]
  s_waitcnt lgkmcnt(8)
  ds_read_b64_tr_b16 a[152:153], v228 offset:12288
  v_mfma_f32_16x16x32_bf16 v[108:111], a[188:191], v[168:171], v[108:111]
  ds_read_b64_tr_b16 a[154:155], v228 offset:14336
  v_mfma_f32_16x16x32_bf16 v[124:127], a[180:183], v[156:159], v[124:127]
  ds_read_b64_tr_b16 a[156:157], v228 offset:16384
  ds_read_b64_tr_b16 a[158:159], v228 offset:18432
  v_mfma_f32_16x16x32_bf16 v[124:127], a[184:187], v[164:167], v[124:127]
  buffer_load_dwordx4 v224, s[16:19], s35 offen sc1 lds
  v_mfma_f32_16x16x32_bf16 v[124:127], a[188:191], v[172:175], v[124:127]
  s_add_u32 m0, s30, 122880
  ds_read_b64_tr_b16 a[160:161], v228 offset:20480
  ds_read_b64_tr_b16 a[162:163], v228 offset:22528
  v_mfma_f32_16x16x32_bf16 v[0:3], a[192:195], v[128:131], 0
  s_add_u32 s35, s43, 0
  ds_read_b64_tr_b16 a[164:165], v229 offset:12288
  v_mfma_f32_16x16x32_bf16 v[0:3], a[196:199], v[136:139], v[0:3]
  s_waitcnt lgkmcnt(9)
  ds_read_b64_tr_b16 a[166:167], v229 offset:14336
  v_mfma_f32_16x16x32_bf16 v[0:3], a[200:203], v[144:147], v[0:3]
  ds_read_b64_tr_b16 a[168:169], v229 offset:16384
  v_mfma_f32_16x16x32_bf16 v[16:19], a[192:195], v[132:135], 0
  ds_read_b64_tr_b16 a[170:171], v229 offset:18432
  v_mfma_f32_16x16x32_bf16 v[16:19], a[196:199], v[140:143], v[16:19]
  ds_read_b64_tr_b16 a[172:173], v229 offset:20480
  v_mfma_f32_16x16x32_bf16 v[16:19], a[200:203], v[148:151], v[16:19]
  buffer_load_dwordx4 v224, s[16:19], s35 offen sc1 lds
  v_mfma_f32_16x16x32_bf16 v[4:7], a[204:207], v[128:131], 0
  s_add_u32 m0, s30, 126976
  ds_read_b64_tr_b16 a[174:175], v229 offset:22528
  ds_read_b64_tr_b16 a[176:177], v226 offset:24576
  v_mfma_f32_16x16x32_bf16 v[4:7], a[144:147], v[136:139], v[4:7]
L_st30:
  s_waitcnt lgkmcnt(7)
  ds_read_b64_tr_b16 a[178:179], v226 offset:26624
  v_mfma_f32_16x16x32_bf16 v[4:7], a[148:151], v[144:147], v[4:7]
  s_add_u32 s35, s42, 128
  ds_read_b64_tr_b16 a[180:181], v226 offset:28672
  v_mfma_f32_16x16x32_bf16 v[20:23], a[204:207], v[132:135], 0
  ds_read_b64_tr_b16 a[182:183], v226 offset:30720
  v_mfma_f32_16x16x32_bf16 v[20:23], a[144:147], v[140:143], v[20:23]
  ds_read_b64_tr_b16 a[184:185], v226 offset:32768
  v_mfma_f32_16x16x32_bf16 v[20:23], a[148:151], v[148:151], v[20:23]
  buffer_load_dwordx4 v224, s[16:19], s35 offen sc1 lds
  v_mfma_f32_16x16x32_bf16 v[8:11], a[152:155], v[128:131], 0
  s_add_u32 m0, s30, 131072
  ds_read_b64_tr_b16 a[186:187], v226 offset:34816
  ds_read_b64_tr_b16 a[188:189], v227 offset:24576
  v_mfma_f32_16x16x32_bf16 v[8:11], a[156:159], v[136:139], v[8:11]
  s_add_u32 s35, s42, 36992
  ds_read_b64_tr_b16 a[190:191], v227 offset:26624
  v_mfma_f32_16x16x32_bf16 v[8:11], a[160:163], v[144:147], v[8:11]
  ds_read_b64_tr_b16 a[192:193], v227 offset:28672
  v_mfma_f32_16x16x32_bf16 v[24:27], a[152:155], v[132:135], 0
  ds_read_b64_tr_b16 a[194:195], v227 offset:30720
  v_mfma_f32_16x16x32_bf16 v[24:27], a[156:159], v[140:143], v[24:27]
  ds_read_b64_tr_b16 a[196:197], v227 offset:32768
  ds_read_b64_tr_b16 a[198:199], v227 offset:34816
  v_mfma_f32_16x16x32_bf16 v[24:27], a[160:163], v[148:151], v[24:27]
  s_waitcnt lgkmcnt(8)
  ds_read_b64_tr_b16 a[200:201], v228 offset:24576
  v_mfma_f32_16x16x32_bf16 v[12:15], a[164:167], v[128:131], 0
  buffer_load_dwordx4 v224, s[16:19], s35 offen sc1 lds
  v_mfma_f32_16x16x32_bf16 v[12:15], a[168:171], v[136:139], v[12:15]
  s_add_u32 m0, s30, 135168
  ds_read_b64_tr_b16 a[202:203], v228 offset:26624
  ds_read_b64_tr_b16 a[204:205], v228 offset:28672
  v_mfma_f32_16x16x32_bf16 v[12:15], a[172:175], v[144:147], v[12:15]
  s_add_u32 s35, s42, 73856
  ds_read_b64_tr_b16 a[206:207], v228 offset:30720
  v_mfma_f32_16x16x32_bf16 v[28:31], a[164:167], v[132:135], 0
  ds_read_b64_tr_b16 a[144:145], v228 offset:32768
  v_mfma_f32_16x16x32_bf16 v[28:31], a[168:171], v[140:143], v[28:31]
  ds_read_b64_tr_b16 a[146:147], v228 offset:34816
  v_mfma_f32_16x16x32_bf16 v[28:31], a[172:175], v[148:151], v[28:31]
  ds_read_b64_tr_b16 a[148:149], v229 offset:24576
  ds_read_b64_tr_b16 a[150:151], v229 offset:26624
  v_mfma_f32_16x16x32_bf16 v[0:3], a[176:179], v[152:155], v[0:3]
  ds_read_b64_tr_b16 a[152:153], v229 offset:28672
  v_mfma_f32_16x16x32_bf16 v[0:3], a[180:183], v[160:163], v[0:3]
  s_waitcnt lgkmcnt(9)
  ds_read_b64_tr_b16 a[154:155], v229 offset:30720
  ds_read_b64_tr_b16 a[156:157], v229 offset:32768
  v_mfma_f32_16x16x32_bf16 v[0:3], a[184:187], v[168:171], v[0:3]
  buffer_load_dwordx4 v224, s[16:19], s35 offen sc1 lds
  v_mfma_f32_16x16x32_bf16 v[16:19], a[176:179], v[156:159], v[16:19]
  s_add_u32 m0, s30, 139264
  ds_read_b64_tr_b16 a[158:159], v229 offset:34816
  v_mfma_f32_16x16x32_bf16 v[16:19], a[180:183], v[164:167], v[16:19]
  s_add_u32 s35, s42, 110720
  ds_read_b64_tr_b16 a[160:161], v226 offset:36864
  v_mfma_f32_16x16x32_bf16 v[16:19], a[184:187], v[172:175], v[16:19]
  ds_read_b64_tr_b16 a[162:163], v226 offset:38912
  v_mfma_f32_16x16x32_bf16 v[4:7], a[188:191], v[152:155], v[4:7]
  ds_read_b64_tr_b16 a[164:165], v226 offset:40960
  ds_read_b64_tr_b16 a[166:167], v226 offset:43008
  v_mfma_f32_16x16x32_bf16 v[4:7], a[192:195], v[160:163], v[4:7]
  buffer_load_dwordx4 v224, s[16:19], s35 offen sc1 lds
  v_mfma_f32_16x16x32_bf16 v[4:7], a[196:199], v[168:171], v[4:7]
  s_add_u32 m0, s30, 143360
  ds_read_b64_tr_b16 a[168:169], v226 offset:45056
  ds_read_b64_tr_b16 a[170:171], v226 offset:47104
  v_mfma_f32_16x16x32_bf16 v[20:23], a[188:191], v[156:159], v[20:23]
  s_add_u32 s35, s42, 147584
  ds_read_b64_tr_b16 a[172:173], v227 offset:36864
  v_mfma_f32_16x16x32_bf16 v[20:23], a[192:195], v[164:167], v[20:23]
  ds_read_b64_tr_b16 a[174:175], v227 offset:38912
  v_mfma_f32_16x16x32_bf16 v[20:23], a[196:199], v[172:175], v[20:23]
  s_waitcnt lgkmcnt(8)
  ds_read_b64_tr_b16 a[176:177], v227 offset:40960
  v_mfma_f32_16x16x32_bf16 v[8:11], a[200:203], v[152:155], v[8:11]
  ds_read_b64_tr_b16 a[178:179], v227 offset:43008
  v_mfma_f32_16x16x32_bf16 v[8:11], a[204:207], v[160:163], v[8:11]
  ds_read_b64_tr_b16 a[180:181], v227 offset:45056
  ds_read_b64_tr_b16 a[182:183], v227 offset:47104
  v_mfma_f32_16x16x32_bf16 v[8:11], a[144:147], v[168:171], v[8:11]
  buffer_load_dwordx4 v224, s[16:19], s35 offen sc1 lds
  v_mfma_f32_16x16x32_bf16 v[24:27], a[200:203], v[156:159], v[24:27]
  ds_read_b64_tr_b16 a[184:185], v228 offset:36864
  ds_read_b64_tr_b16 a[186:187], v228 offset:38912
  v_mfma_f32_16x16x32_bf16 v[24:27], a[204:207], v[164:167], v[24:27]
  ds_read_b64_tr_b16 a[188:189], v228 offset:40960
  v_mfma_f32_16x16x32_bf16 v[24:27], a[144:147], v[172:175], v[24:27]
  ds_read_b64_tr_b16 a[190:191], v228 offset:43008
  v_mfma_f32_16x16x32_bf16 v[12:15], a[148:151], v[152:155], v[12:15]
  ds_read_b64_tr_b16 a[192:193], v228 offset:45056
  v_mfma_f32_16x16x32_bf16 v[12:15], a[152:155], v[160:163], v[12:15]
  ds_read_b64_tr_b16 a[194:195], v228 offset:47104
  v_mfma_f32_16x16x32_bf16 v[12:15], a[156:159], v[168:171], v[12:15]
  ds_read_b64_tr_b16 a[196:197], v229 offset:36864
  ds_read_b64_tr_b16 a[198:199], v229 offset:38912
  v_mfma_f32_16x16x32_bf16 v[28:31], a[148:151], v[156:159], v[28:31]
  ds_read_b64_tr_b16 a[200:201], v229 offset:40960
  v_mfma_f32_16x16x32_bf16 v[28:31], a[152:155], v[164:167], v[28:31]
  ds_read_b64_tr_b16 a[202:203], v229 offset:43008
  v_mfma_f32_16x16x32_bf16 v[28:31], a[156:159], v[172:175], v[28:31]
  s_waitcnt lgkmcnt(10)
  ds_read_b64_tr_b16 a[204:205], v229 offset:45056
  v_mfma_f32_16x16x32_bf16 v[32:35], a[160:163], v[176:179], v[32:35]
  ds_read_b64_tr_b16 a[206:207], v229 offset:47104
  v_mfma_f32_16x16x32_bf16 v[32:35], a[164:167], v[184:187], v[32:35]
  v_mfma_f32_16x16x32_bf16 v[32:35], a[168:171], v[192:195], v[32:35]
  v_mfma_f32_16x16x32_bf16 v[48:51], a[160:163], v[180:183], v[48:51]
  v_mfma_f32_16x16x32_bf16 v[48:51], a[164:167], v[188:191], v[48:51]
  v_mfma_f32_16x16x32_bf16 v[48:51], a[168:171], v[196:199], v[48:51]
  v_mfma_f32_16x16x32_bf16 v[36:39], a[172:175], v[176:179], v[36:39]
  v_mfma_f32_16x16x32_bf16 v[36:39], a[176:179], v[184:187], v[36:39]
L_st31:
  s_waitcnt vmcnt(22) lgkmcnt(0)
  s_barrier
  ds_read_b64_tr_b16 a[144:145], v230 offset:0
  v_mfma_f32_16x16x32_bf16 v[36:39], a[180:183], v[192:195], v[36:39]
  s_add_u32 m0, s30, 0
  ds_read_b64_tr_b16 a[146:147], v230 offset:2048
  v_mfma_f32_16x16x32_bf16 v[52:55], a[172:175], v[180:183], v[52:55]
  s_add_u32 s35, s42, 184448
  ds_read_b64_tr_b16 a[148:149], v230 offset:4096
  v_mfma_f32_16x16x32_bf16 v[52:55], a[176:179], v[188:191], v[52:55]
  ds_read_b64_tr_b16 a[150:151], v230 offset:6144
  v_mfma_f32_16x16x32_bf16 v[52:55], a[180:183], v[196:199], v[52:55]
  ds_read_b64_tr_b16 a[152:153], v230 offset:8192
  v_mfma_f32_16x16x32_bf16 v[40:43], a[184:187], v[176:179], v[40:43]
  ds_read_b64_tr_b16 a[154:155], v230 offset:10240
  v_mfma_f32_16x16x32_bf16 v[40:43], a[188:191], v[184:187], v[40:43]
  buffer_load_dwordx4 v224, s[16:19], s35 offen sc1 lds
  v_mfma_f32_16x16x32_bf16 v[40:43], a[192:195], v[192:195], v[40:43]
  s_add_u32 m0, s30, 4096
  ds_read_b64_tr_b16 a[156:157], v231 offset:0
  ds_read_b64_tr_b16 a[158:159], v231 offset:2048
  v_mfma_f32_16x16x32_bf16 v[56:59], a[184:187], v[180:183], v[56:59]
  s_add_u32 s35, s42, 221312
  ds_read_b64_tr_b16 a[160:161], v231 offset:4096
  v_mfma_f32_16x16x32_bf16 v[56:59], a[188:191], v[188:191], v[56:59]
  ds_read_b64_tr_b16 a[162:163], v231 offset:6144
  v_mfma_f32_16x16x32_bf16 v[56:59], a[192:195], v[196:199], v[56:59]
  ds_read_b64_tr_b16 a[164:165], v231 offset:8192
  v_mfma_f32_16x16x32_bf16 v[44:47], a[196:199], v[176:179], v[44:47]
  ds_read_b64_tr_b16 a[166:167], v231 offset:10240
  v_mfma_f32_16x16x32_bf16 v[44:47], a[200:203], v[184:187], v[44:47]
  buffer_load_dwordx4 v224, s[16:19], s35 offen sc1 lds
  v_mfma_f32_16x16x32_bf16 v[44:47], a[204:207], v[192:195], v[44:47]
  s_add_u32 m0, s30, 8192
  ds_read_b64_tr_b16 a[168:169], v232 offset:0
  ds_read_b64_tr_b16 a[170:171], v232 offset:2048
  v_mfma_f32_16x16x32_bf16 v[60:63], a[196:199], v[180:183], v[60:63]
  s_add_u32 s35, s42, 258176
  ds_read_b64_tr_b16 a[172:173], v232 offset:4096
  v_mfma_f32_16x16x32_bf16 v[60:63], a[200:203], v[188:191], v[60:63]
  ds_read_b64_tr_b16 a[174:175], v232 offset:6144
  v_mfma_f32_16x16x32_bf16 v[60:63], a[204:207], v[196:199], v[60:63]
  s_waitcnt lgkmcnt(8)
  ds_read_b64_tr_b16 a[176:177], v232 offset:8192
  v_mfma_f32_16x16x32_bf16 v[64:67], a[144:147], v[176:179], v[64:67]
  ds_read_b64_tr_b16 a[178:179], v232 offset:10240
  v_mfma_f32_16x16x32_bf16 v[64:67], a[148:151], v[184:187], v[64:67]
  ds_read_b64_tr_b16 a[180:181], v233 offset:0
  v_mfma_f32_16x16x32_bf16 v[64:67], a[152:155], v[192:195], v[64:67]
  buffer_load_dwordx4 v224, s[16:19], s35 offen sc1 lds
  v_mfma_f32_16x16x32_bf16 v[80:83], a[144:147], v[180:183], v[80:83]
  s_add_u32 m0, s30, 12288
  ds_read_b64_tr_b16 a[182:183], v233 offset:2048
  ds_read_b64_tr_b16 a[184:185], v233 offset:4096
  v_mfma_f32_16x16x32_bf16 v[80:83], a[148:151], v[188:191], v[80:83]
  s_add_u32 s35, s43, 128
  ds_read_b64_tr_b16 a[186:187], v233 offset:6144
  v_mfma_f32_16x16x32_bf16 v[80:83], a[152:155], v[196:199], v[80:83]
  ds_read_b64_tr_b16 a[188:189], v233 offset:8192
  v_mfma_f32_16x16x32_bf16 v[68:71], a[156:159], v[176:179], v[68:71]
  s_waitcnt lgkmcnt(7)
  ds_read_b64_tr_b16 a[190:191], v233 offset:10240
  v_mfma_f32_16x16x32_bf16 v[68:71], a[160:163], v[184:187], v[68:71]
  ds_read_b64_tr_b16 a[192:193], v230 offset:12288
  v_mfma_f32_16x16x32_bf16 v[68:71], a[164:167], v[192:195], v[68:71]
  ds_read_b64_tr_b16 a[194:195], v230 offset:14336
  v_mfma_f32_16x16x32_bf16 v[84:87], a[156:159], v[180:183], v[84:87]
  buffer_load_dwordx4 v224, s[16:19], s35 offen sc1 lds
  v_mfma_f32_16x16x32_bf16 v[84:87], a[160:163], v[188:191], v[84:87]
  s_add_u32 m0, s30, 16384
  ds_read_b64_tr_b16 a[196:197], v230 offset:16384
  ds_read_b64_tr_b16 a[198:199], v230 offset:18432
  v_mfma_f32_16x16x32_bf16 v[84:87], a[164:167], v[196:199], v[84:87]
  s_add_u32 s35, s42, 256
  ds_read_b64_tr_b16 a[200:201], v230 offset:20480
  v_mfma_f32_16x16x32_bf16 v[72:75], a[168:171], v[176:179], v[72:75]
  ds_read_b64_tr_b16 a[202:203], v230 offset:22528
  v_mfma_f32_16x16x32_bf16 v[72:75], a[172:175], v[184:187], v[72:75]
  s_waitcnt lgkmcnt(8)
  ds_read_b64_tr_b16 a[204:205], v231 offset:12288
  v_mfma_f32_16x16x32_bf16 v[72:75], a[176:179], v[192:195], v[72:75]
  ds_read_b64_tr_b16 a[206:207], v231 offset:14336
  v_mfma_f32_16x16x32_bf16 v[88:91], a[168:171], v[180:183], v[88:91]
  buffer_load_dwordx4 v224, s[16:19], s35 offen sc1 lds
  v_mfma_f32_16x16x32_bf16 v[88:91], a[172:175], v[188:191], v[88:91]
  s_add_u32 m0, s30, 20480
  ds_read_b64_tr_b16 a[144:145], v231 offset:16384
  ds_read_b64_tr_b16 a[146:147], v231 offset:18432
  v_mfma_f32_16x16x32_bf16 v[88:91], a[176:179], v[196:199], v[88:91]
  s_add_u32 s35, s42, 37120
  ds_read_b64_tr_b16 a[148:149], v231 offset:20480
  v_mfma_f32_16x16x32_bf16 v[76:79], a[180:183], v[176:179], v[76:79]
  ds_read_b64_tr_b16 a[150:151], v231 offset:22528
  v_mfma_f32_16x16x32_bf16 v[76:79], a[184:187], v[184:187], v[76:79]
  s_waitcnt lgkmcnt(8)
  ds_read_b64_tr_b16 a[152:153], v232 offset:12288
  v_mfma_f32_16x16x32_bf16 v[76:79], a[188:191], v[192:195], v[76:79]
  buffer_load_dword v211, off, s[60:63], s101 offset:128 sc1
  v_mfma_f32_16x16x32_bf16 v[92:95], a[180:183], v[180:183], v[92:95]
  ds_read_b64_tr_b16 a[154:155], v232 offset:14336
  ds_read_b64_tr_b16 a[156:157], v232 offset:16384
  v_mfma_f32_16x16x32_bf16 v[92:95], a[184:187], v[188:191], v[92:95]
  buffer_load_dwordx4 v224, s[16:19], s35 offen sc1 lds
  v_mfma_f32_16x16x32_bf16 v[92:95], a[188:191], v[196:199], v[92:95]
  s_add_u32 m0, s30, 24576
  ds_read_b64_tr_b16 a[158:159], v232 offset:18432
  ds_read_b64_tr_b16 a[160:161], v232 offset:20480
  v_mfma_f32_16x16x32_bf16 v[96:99], a[192:195], v[176:179], v[96:99]
  s_add_u32 s35, s42, 73984
  ds_read_b64_tr_b16 a[162:163], v232 offset:22528
  v_mfma_f32_16x16x32_bf16 v[96:99], a[196:199], v[184:187], v[96:99]
  s_waitcnt lgkmcnt(8)
  ds_read_b64_tr_b16 a[164:165], v233 offset:12288
  v_mfma_f32_16x16x32_bf16 v[96:99], a[200:203], v[192:195], v[96:99]
  ds_read_b64_tr_b16 a[166:167], v233 offset:14336
  v_mfma_f32_16x16x32_bf16 v[112:115], a[192:195], v[180:183], v[112:115]
  ds_read_b64_tr_b16 a[168:169], v233 offset:16384
  ds_read_b64_tr_b16 a[170:171], v233 offset:18432
  v_mfma_f32_16x16x32_bf16 v[112:115], a[196:199], v[188:191], v[112:115]
  ds_read_b64_tr_b16 a[172:173], v233 offset:20480
  v_mfma_f32_16x16x32_bf16 v[112:115], a[200:203], v[196:199], v[112:115]
  buffer_load_dwordx4 v224, s[16:19], s35 offen sc1 lds
  v_mfma_f32_16x16x32_bf16 v[100:103], a[204:207], v[176:179], v[100:103]
  s_add_u32 m0, s30, 28672
  ds_read_b64_tr_b16 a[174:175], v233 offset:22528
  ds_read_b64_tr_b16 a[176:177], v230 offset:24576
  v_mfma_f32_16x16x32_bf16 v[100:103], a[144:147], v[184:187], v[100:103]
L_st32:
  s_waitcnt lgkmcnt(9)
  ds_read_b64_tr_b16 a[178:179], v230 offset:26624
  v_mfma_f32_16x16x32_bf16 v[100:103], a[148:151], v[192:195], v[100:103]
  s_add_u32 s35, s42, 110848
  ds_read_b64_tr_b16 a[180:181], v230 offset:28672
  v_mfma_f32_16x16x32_bf16 v[116:119], a[204:207], v[180:183], v[116:119]
  ds_read_b64_tr_b16 a[182:183], v230 offset:30720
  v_mfma_f32_16x16x32_bf16 v[116:119], a[144:147], v[188:191], v[116:119]
  ds_read_b64_tr_b16 a[184:185], v230 offset:32768
  v_mfma_f32_16x16x32_bf16 v[116:119], a[148:151], v[196:199], v[116:119]
  buffer_load_dwordx4 v224, s[16:19], s35 offen sc1 lds
  v_mfma_f32_16x16x32_bf16 v[104:107], a[152:155], v[176:179], v[104:107]
  s_add_u32 m0, s30, 32768
  ds_read_b64_tr_b16 a[186:187], v230 offset:34816
  ds_read_b64_tr_b16 a[188:189], v231 offset:24576
  v_mfma_f32_16x16x32_bf16 v[104:107], a[156:159], v[184:187], v[104:107]
  s_waitcnt lgkmcnt(9)
  ds_read_b64_tr_b16 a[190:191], v231 offset:26624
  v_mfma_f32_16x16x32_bf16 v[104:107], a[160:163], v[192:195], v[104:107]
  s_add_u32 s35, s42, 147712
  ds_read_b64_tr_b16 a[192:193], v231 offset:28672
  v_mfma_f32_16x16x32_bf16 v[120:123], a[152:155], v[180:183], v[120:123]
  ds_read_b64_tr_b16 a[194:195], v231 offset:30720
  v_mfma_f32_16x16x32_bf16 v[120:123], a[156:159], v[188:191], v[120:123]
  ds_read_b64_tr_b16 a[196:197], v231 offset:32768
  ds_read_b64_tr_b16 a[198:199], v231 offset:34816
  v_mfma_f32_16x16x32_bf16 v[120:123], a[160:163], v[196:199], v[120:123]
  ds_read_b64_tr_b16 a[200:201], v232 offset:24576
  v_mfma_f32_16x16x32_bf16 v[108:111], a[164:167], v[176:179], v[108:111]
  buffer_load_dwordx4 v224, s[16:19], s35 offen sc1 lds
  v_mfma_f32_16x16x32_bf16 v[108:111], a[168:171], v[184:187], v[108:111]
  s_waitcnt lgkmcnt(9)
  ds_read_b64_tr_b16 a[202:203], v232 offset:26624
  ds_read_b64_tr_b16 a[204:205], v232 offset:28672
  v_mfma_f32_16x16x32_bf16 v[108:111], a[172:175], v[192:195], v[108:111]
  s_add_u32 m0, s30, 36864
  ds_read_b64_tr_b16 a[206:207], v232 offset:30720
  v_mfma_f32_16x16x32_bf16 v[124:127], a[164:167], v[180:183], v[124:127]
  s_add_u32 s35, s42, 184576
  ds_read_b64_tr_b16 a[144:145], v232 offset:32768
  v_mfma_f32_16x16x32_bf16 v[124:127], a[168:171], v[188:191], v[124:127]
  ds_read_b64_tr_b16 a[146:147], v232 offset:34816
  v_mfma_f32_16x16x32_bf16 v[124:127], a[172:175], v[196:199], v[124:127]
  ds_read_b64_tr_b16 a[148:149], v233 offset:24576
  ds_read_b64_tr_b16 a[150:151], v233 offset:26624
  v_mfma_f32_16x16x32_bf16 v[0:3], a[176:179], v[176:179], v[0:3]
  ds_read_b64_tr_b16 a[152:153], v233 offset:28672
  v_mfma_f32_16x16x32_bf16 v[0:3], a[180:183], v[184:187], v[0:3]
  s_waitcnt lgkmcnt(9)
  ds_read_b64_tr_b16 a[154:155], v233 offset:30720
  ds_read_b64_tr_b16 a[156:157], v233 offset:32768
  v_mfma_f32_16x16x32_bf16 v[0:3], a[184:187], v[192:195], v[0:3]
  buffer_load_dwordx4 v224, s[16:19], s35 offen sc1 lds
  v_mfma_f32_16x16x32_bf16 v[16:19], a[176:179], v[180:183], v[16:19]
  s_add_u32 m0, s30, 40960
  ds_read_b64_tr_b16 a[158:159], v233 offset:34816
  v_mfma_f32_16x16x32_bf16 v[16:19], a[180:183], v[188:191], v[16:19]
  s_add_u32 s35, s42, 221440
  ds_read_b64_tr_b16 a[160:161], v206 offset:36864
  v_mfma_f32_16x16x32_bf16 v[16:19], a[184:187], v[196:199], v[16:19]
  ds_read_b64_tr_b16 a[162:163], v206 offset:37888
  v_mfma_f32_16x16x32_bf16 v[4:7], a[188:191], v[176:179], v[4:7]
  ds_read_b64_tr_b16 a[164:165], v206 offset:38912
  ds_read_b64_tr_b16 a[166:167], v206 offset:39936
  v_mfma_f32_16x16x32_bf16 v[4:7], a[192:195], v[184:187], v[4:7]
  buffer_load_dwordx4 v224, s[16:19], s35 offen sc1 lds
  v_mfma_f32_16x16x32_bf16 v[4:7], a[196:199], v[192:195], v[4:7]
  s_add_u32 m0, s30, 45056
  ds_read_b64_tr_b16 a[168:169], v207 offset:36864
  ds_read_b64_tr_b16 a[170:171], v207 offset:37888
  v_mfma_f32_16x16x32_bf16 v[20:23], a[188:191], v[180:183], v[20:23]
  s_add_u32 s35, s42, 258304
  ds_read_b64_tr_b16 a[172:173], v207 offset:38912
  v_mfma_f32_16x16x32_bf16 v[20:23], a[192:195], v[188:191], v[20:23]
  ds_read_b64_tr_b16 a[174:175], v207 offset:39936
  v_mfma_f32_16x16x32_bf16 v[20:23], a[196:199], v[196:199], v[20:23]
  s_waitcnt lgkmcnt(8)
  ds_read_b64_tr_b16 a[176:177], v230 offset:40960
  v_mfma_f32_16x16x32_bf16 v[8:11], a[200:203], v[176:179], v[8:11]
  ds_read_b64_tr_b16 a[178:179], v230 offset:43008
  v_mfma_f32_16x16x32_bf16 v[8:11], a[204:207], v[184:187], v[8:11]
  ds_read_b64_tr_b16 a[180:181], v230 offset:45056
  ds_read_b64_tr_b16 a[182:183], v230 offset:47104
  v_mfma_f32_16x16x32_bf16 v[8:11], a[144:147], v[192:195], v[8:11]
  buffer_load_dwordx4 v224, s[16:19], s35 offen sc1 lds
  v_mfma_f32_16x16x32_bf16 v[24:27], a[200:203], v[180:183], v[24:27]
  ds_read_b64_tr_b16 a[184:185], v231 offset:40960
  ds_read_b64_tr_b16 a[186:187], v231 offset:43008
  v_mfma_f32_16x16x32_bf16 v[24:27], a[204:207], v[188:191], v[24:27]
  ds_read_b64_tr_b16 a[188:189], v231 offset:45056
  v_mfma_f32_16x16x32_bf16 v[24:27], a[144:147], v[196:199], v[24:27]
  ds_read_b64_tr_b16 a[190:191], v231 offset:47104
  v_mfma_f32_16x16x32_bf16 v[12:15], a[148:151], v[176:179], v[12:15]
  ds_read_b64_tr_b16 a[192:193], v232 offset:40960
  v_mfma_f32_16x16x32_bf16 v[12:15], a[152:155], v[184:187], v[12:15]
  ds_read_b64_tr_b16 a[194:195], v232 offset:43008
  v_mfma_f32_16x16x32_bf16 v[12:15], a[156:159], v[192:195], v[12:15]
  s_waitcnt vmcnt(7)
  v_cmp_ne_u32 vcc, s94, v211
  s_cbranch_vccnz L_xslow1
L_xok1:
  v_mfma_f32_16x16x32_bf16 v[28:31], a[148:151], v[180:183], v[28:31]
  s_add_u32 s39, s77, 12288
  ds_read_b64_tr_b16 a[196:197], v232 offset:45056
  ds_read_b64_tr_b16 a[198:199], v232 offset:47104
  v_mfma_f32_16x16x32_bf16 v[28:31], a[152:155], v[188:191], v[28:31]
  buffer_load_dwordx4 a[48:51], v225, s[56:59], s39 offen sc1
  v_mfma_f32_16x16x32_bf16 v[28:31], a[156:159], v[196:199], v[28:31]
  s_waitcnt lgkmcnt(8)
  ds_read_b64_tr_b16 a[200:201], v233 offset:40960
  ds_read_b64_tr_b16 a[202:203], v233 offset:43008
  v_mfma_f32_16x16x32_bf16 v[216:219], a[160:163], v[176:179], v[216:219]
  ds_read_b64_tr_b16 a[204:205], v233 offset:45056
  ds_read_b64_tr_b16 a[206:207], v233 offset:47104
  v_mfma_f32_16x16x32_bf16 v[216:219], a[164:167], v[184:187], v[216:219]
  v_mfma_f32_16x16x32_bf16 v[240:243], a[160:163], v[180:183], v[240:243]
  buffer_load_dwordx4 a[52:55], v225, s[56:59], s39 offen offset:1024 sc1
  v_mfma_f32_16x16x32_bf16 v[240:243], a[164:167], v[188:191], v[240:243]
  v_mfma_f32_16x16x32_bf16 v[220:223], a[168:171], v[176:179], v[220:223]
  v_mfma_f32_16x16x32_bf16 v[220:223], a[172:175], v[184:187], v[220:223]
  v_mfma_f32_16x16x32_bf16 v[244:247], a[168:171], v[180:183], v[244:247]
  buffer_load_dwordx4 a[56:59], v225, s[56:59], s39 offen offset:2048 sc1
  v_mfma_f32_16x16x32_bf16 v[244:247], a[172:175], v[188:191], v[244:247]
L_st33:
  s_waitcnt vmcnt(16) lgkmcnt(0)
  s_barrier
  ds_read_b64_tr_b16 a[144:145], v234 offset:0
  v_mfma_f32_16x16x32_bf16 v[32:35], a[176:179], a[0:3], v[32:35]
  s_add_u32 m0, s30, 49152
  ds_read_b64_tr_b16 a[146:147], v234 offset:2048
  v_mfma_f32_16x16x32_bf16 v[32:35], a[180:183], a[8:11], v[32:35]
  s_add_u32 s35, s43, 256
  ds_read_b64_tr_b16 a[148:149], v234 offset:4096
  v_mfma_f32_16x16x32_bf16 v[48:51], a[176:179], a[4:7], v[48:51]
  buffer_load_dwordx4 a[60:63], v225, s[56:59], s39 offen offset:3072 sc1
  v_mfma_f32_16x16x32_bf16 v[48:51], a[180:183], a[12:15], v[48:51]
  s_add_u32 s39, s77, 16384
  ds_read_b64_tr_b16 a[150:151], v234 offset:6144
  ds_read_b64_tr_b16 a[152:153], v234 offset:8192
  v_mfma_f32_16x16x32_bf16 v[36:39], a[184:187], a[0:3], v[36:39]
  ds_read_b64_tr_b16 a[154:155], v234 offset:10240
  v_mfma_f32_16x16x32_bf16 v[36:39], a[188:191], a[8:11], v[36:39]
  buffer_load_dwordx4 v224, s[16:19], s35 offen sc1 lds
  v_mfma_f32_16x16x32_bf16 v[52:55], a[184:187], a[4:7], v[52:55]
  s_add_u32 m0, s30, 53248
  ds_read_b64_tr_b16 a[156:157], v235 offset:0
  ds_read_b64_tr_b16 a[158:159], v235 offset:2048
  v_mfma_f32_16x16x32_bf16 v[52:55], a[188:191], a[12:15], v[52:55]
  s_add_u32 s35, s42, 384
  ds_read_b64_tr_b16 a[160:161], v235 offset:4096
  v_mfma_f32_16x16x32_bf16 v[40:43], a[192:195], a[0:3], v[40:43]
  buffer_load_dwordx4 a[64:67], v225, s[56:59], s39 offen sc1
  v_mfma_f32_16x16x32_bf16 v[40:43], a[196:199], a[8:11], v[40:43]
  ds_read_b64_tr_b16 a[162:163], v235 offset:6144
  ds_read_b64_tr_b16 a[164:165], v235 offset:8192
  v_mfma_f32_16x16x32_bf16 v[56:59], a[192:195], a[4:7], v[56:59]
  ds_read_b64_tr_b16 a[166:167], v235 offset:10240
  v_mfma_f32_16x16x32_bf16 v[56:59], a[196:199], a[12:15], v[56:59]
  buffer_load_dwordx4 v224, s[16:19], s35 offen sc1 lds
  v_mfma_f32_16x16x32_bf16 v[44:47], a[200:203], a[0:3], v[44:47]
  s_add_u32 m0, s30, 57344
  ds_read_b64_tr_b16 a[168:169], v236 offset:0
  ds_read_b64_tr_b16 a[170:171], v236 offset:2048
  v_mfma_f32_16x16x32_bf16 v[44:47], a[204:207], a[8:11], v[44:47]
  s_add_u32 s35, s42, 37248
  ds_read_b64_tr_b16 a[172:173], v236 offset:4096
  v_mfma_f32_16x16x32_bf16 v[60:63], a[200:203], a[4:7], v[60:63]
  buffer_load_dwordx4 a[68:71], v225, s[56:59], s39 offen offset:1024 sc1
  v_mfma_f32_16x16x32_bf16 v[60:63], a[204:207], a[12:15], v[60:63]
  s_waitcnt lgkmcnt(7)
  ds_read_b64_tr_b16 a[174:175], v236 offset:6144
  ds_read_b64_tr_b16 a[176:177], v236 offset:8192
  v_mfma_f32_16x16x32_bf16 v[32:35], a[144:147], a[16:19], v[32:35]
  ds_read_b64_tr_b16 a[178:179], v236 offset:10240
  v_mfma_f32_16x16x32_bf16 v[32:35], a[148:151], a[24:27], v[32:35]
  ds_read_b64_tr_b16 a[180:181], v237 offset:0
  v_mfma_f32_16x16x32_bf16 v[32:35], a[152:155], a[32:35], v[32:35]
  buffer_load_dwordx4 v224, s[16:19], s35 offen sc1 lds
  v_mfma_f32_16x16x32_bf16 v[48:51], a[144:147], a[20:23], v[48:51]
  s_add_u32 m0, s30, 61440
  ds_read_b64_tr_b16 a[182:183], v237 offset:2048
  ds_read_b64_tr_b16 a[184:185], v237 offset:4096
  v_mfma_f32_16x16x32_bf16 v[48:51], a[148:151], a[28:31], v[48:51]
  s_add_u32 s35, s42, 74112
  ds_read_b64_tr_b16 a[186:187], v237 offset:6144
  v_mfma_f32_16x16x32_bf16 v[48:51], a[152:155], a[36:39], v[48:51]
  ds_read_b64_tr_b16 a[188:189], v237 offset:8192
  v_mfma_f32_16x16x32_bf16 v[36:39], a[156:159], a[16:19], v[36:39]
  s_waitcnt lgkmcnt(9)
  ds_read_b64_tr_b16 a[190:191], v237 offset:10240
  v_mfma_f32_16x16x32_bf16 v[36:39], a[160:163], a[24:27], v[36:39]
  ds_read_b64_tr_b16 a[192:193], v234 offset:12288
  v_mfma_f32_16x16x32_bf16 v[36:39], a[164:167], a[32:35], v[36:39]
  ds_read_b64_tr_b16 a[194:195], v234 offset:14336
  v_mfma_f32_16x16x32_bf16 v[52:55], a[156:159], a[20:23], v[52:55]
  buffer_load_dwordx4 v224, s[16:19], s35 offen sc1 lds
  v_mfma_f32_16x16x32_bf16 v[52:55], a[160:163], a[28:31], v[52:55]
  s_add_u32 m0, s30, 65536
  ds_read_b64_tr_b16 a[196:197], v234 offset:16384
  ds_read_b64_tr_b16 a[198:199], v234 offset:18432
  v_mfma_f32_16x16x32_bf16 v[52:55], a[164:167], a[36:39], v[52:55]
  s_add_u32 s35, s42, 110976
  ds_read_b64_tr_b16 a[200:201], v234 offset:20480
  v_mfma_f32_16x16x32_bf16 v[40:43], a[168:171], a[16:19], v[40:43]
  s_waitcnt lgkmcnt(7)
  ds_read_b64_tr_b16 a[202:203], v234 offset:22528
  v_mfma_f32_16x16x32_bf16 v[40:43], a[172:175], a[24:27], v[40:43]
  ds_read_b64_tr_b16 a[204:205], v235 offset:12288
  v_mfma_f32_16x16x32_bf16 v[40:43], a[176:179], a[32:35], v[40:43]
  ds_read_b64_tr_b16 a[206:207], v235 offset:14336
  v_mfma_f32_16x16x32_bf16 v[56:59], a[168:171], a[20:23], v[56:59]
  buffer_load_dwordx4 v224, s[16:19], s35 offen sc1 lds
  v_mfma_f32_16x16x32_bf16 v[56:59], a[172:175], a[28:31], v[56:59]
  s_add_u32 m0, s30, 69632
  ds_read_b64_tr_b16 a[144:145], v235 offset:16384
  ds_read_b64_tr_b16 a[146:147], v235 offset:18432
  v_mfma_f32_16x16x32_bf16 v[56:59], a[176:179], a[36:39], v[56:59]
  s_add_u32 s35, s42, 147840
  ds_read_b64_tr_b16 a[148:149], v235 offset:20480
  v_mfma_f32_16x16x32_bf16 v[44:47], a[180:183], a[16:19], v[44:47]
  ds_read_b64_tr_b16 a[150:151], v235 offset:22528
  v_mfma_f32_16x16x32_bf16 v[44:47], a[184:187], a[24:27], v[44:47]
  s_waitcnt lgkmcnt(8)
  ds_read_b64_tr_b16 a[152:153], v236 offset:12288
  v_mfma_f32_16x16x32_bf16 v[44:47], a[188:191], a[32:35], v[44:47]
  ds_read_b64_tr_b16 a[154:155], v236 offset:14336
  v_mfma_f32_16x16x32_bf16 v[60:63], a[180:183], a[20:23], v[60:63]
  ds_read_b64_tr_b16 a[156:157], v236 offset:16384
  ds_read_b64_tr_b16 a[158:159], v236 offset:18432
  v_mfma_f32_16x16x32_bf16 v[60:63], a[184:187], a[28:31], v[60:63]
  buffer_load_dwordx4 v224, s[16:19], s35 offen sc1 lds
  v_mfma_f32_16x16x32_bf16 v[60:63], a[188:191], a[36:39], v[60:63]
  s_add_u32 m0, s30, 73728
  ds_read_b64_tr_b16 a[160:161], v236 offset:20480
  ds_read_b64_tr_b16 a[162:163], v236 offset:22528
  v_mfma_f32_16x16x32_bf16 v[32:35], a[192:195], a[40:43], v[32:35]
  s_waitcnt vmcnt(11)
  ds_read_b64_tr_b16 a[164:165], v237 offset:12288
  v_mfma_f32_16x16x32_bf16 v[32:35], a[196:199], a[48:51], v[32:35]
  s_waitcnt lgkmcnt(9)
  s_waitcnt vmcnt(9)
  ds_read_b64_tr_b16 a[166:167], v237 offset:14336
  v_mfma_f32_16x16x32_bf16 v[32:35], a[200:203], a[56:59], v[32:35]
  s_add_u32 s35, s42, 184704
  ds_read_b64_tr_b16 a[168:169], v237 offset:16384
  v_mfma_f32_16x16x32_bf16 v[48:51], a[192:195], a[44:47], v[48:51]
  ds_read_b64_tr_b16 a[170:171], v237 offset:18432
  v_mfma_f32_16x16x32_bf16 v[48:51], a[196:199], a[52:55], v[48:51]
  s_waitcnt vmcnt(8)
  ds_read_b64_tr_b16 a[172:173], v237 offset:20480
  v_mfma_f32_16x16x32_bf16 v[48:51], a[200:203], a[60:63], v[48:51]
  buffer_load_dwordx4 v224, s[16:19], s35 offen sc1 lds
  v_mfma_f32_16x16x32_bf16 v[36:39], a[204:207], a[40:43], v[36:39]
  s_add_u32 m0, s30, 77824
  ds_read_b64_tr_b16 a[174:175], v237 offset:22528
  ds_read_b64_tr_b16 a[176:177], v234 offset:24576
  v_mfma_f32_16x16x32_bf16 v[36:39], a[144:147], a[48:51], v[36:39]
L_st34:
  s_waitcnt lgkmcnt(7)
  ds_read_b64_tr_b16 a[178:179], v234 offset:26624
  v_mfma_f32_16x16x32_bf16 v[36:39], a[148:151], a[56:59], v[36:39]
  s_add_u32 s35, s42, 221568
  ds_read_b64_tr_b16 a[180:181], v235 offset:24576
  v_mfma_f32_16x16x32_bf16 v[52:55], a[204:207], a[44:47], v[52:55]
  ds_read_b64_tr_b16 a[182:183], v235 offset:26624
  v_mfma_f32_16x16x32_bf16 v[52:55], a[144:147], a[52:55], v[52:55]
  ds_read_b64_tr_b16 a[184:185], v236 offset:24576
  v_mfma_f32_16x16x32_bf16 v[52:55], a[148:151], a[60:63], v[52:55]
  buffer_load_dwordx4 v224, s[16:19], s35 offen sc1 lds
  v_mfma_f32_16x16x32_bf16 v[40:43], a[152:155], a[40:43], v[40:43]
  s_add_u32 m0, s30, 81920
  ds_read_b64_tr_b16 a[186:187], v236 offset:26624
  ds_read_b64_tr_b16 a[188:189], v237 offset:24576
  v_mfma_f32_16x16x32_bf16 v[40:43], a[156:159], a[48:51], v[40:43]
  s_add_u32 s35, s42, 258432
  ds_read_b64_tr_b16 a[190:191], v237 offset:26624
  v_mfma_f32_16x16x32_bf16 v[40:43], a[160:163], a[56:59], v[40:43]
  ds_read_b64_tr_b16 a[192:193], v234 offset:28672
  v_mfma_f32_16x16x32_bf16 v[56:59], a[152:155], a[44:47], v[56:59]
  ds_read_b64_tr_b16 a[194:195], v234 offset:30720
  v_mfma_f32_16x16x32_bf16 v[56:59], a[156:159], a[52:55], v[56:59]
  ds_read_b64_tr_b16 a[196:197], v234 offset:32768
  ds_read_b64_tr_b16 a[198:199], v234 offset:34816
  v_mfma_f32_16x16x32_bf16 v[56:59], a[160:163], a[60:63], v[56:59]
  s_waitcnt lgkmcnt(8)
  ds_read_b64_tr_b16 a[200:201], v234 offset:36864
  v_mfma_f32_16x16x32_bf16 v[44:47], a[164:167], a[40:43], v[44:47]
  buffer_load_dwordx4 v224, s[16:19], s35 offen sc1 lds
  v_mfma_f32_16x16x32_bf16 v[44:47], a[168:171], a[48:51], v[44:47]
  s_add_u32 m0, s30, 86016
  ds_read_b64_tr_b16 a[202:203], v234 offset:38912
  ds_read_b64_tr_b16 a[204:205], v235 offset:28672
  v_mfma_f32_16x16x32_bf16 v[44:47], a[172:175], a[56:59], v[44:47]
  s_add_u32 s35, s43, 384
  ds_read_b64_tr_b16 a[206:207], v235 offset:30720
  v_mfma_f32_16x16x32_bf16 v[60:63], a[164:167], a[44:47], v[60:63]
  ds_read_b64_tr_b16 a[144:145], v235 offset:32768
  v_mfma_f32_16x16x32_bf16 v[60:63], a[168:171], a[52:55], v[60:63]
  ds_read_b64_tr_b16 a[146:147], v235 offset:34816
  v_mfma_f32_16x16x32_bf16 v[60:63], a[172:175], a[60:63], v[60:63]
  s_waitcnt vmcnt(9)
  ds_read_b64_tr_b16 a[148:149], v235 offset:36864
  ds_read_b64_tr_b16 a[150:151], v235 offset:38912
  v_mfma_f32_16x16x32_bf16 v[32:35], a[176:179], a[64:67], v[32:35]
  s_waitcnt vmcnt(7)
  ds_read_b64_tr_b16 a[152:153], v236 offset:28672
  v_mfma_f32_16x16x32_bf16 v[48:51], a[176:179], a[68:71], v[48:51]
  buffer_load_dwordx4 v224, s[16:19], s35 offen sc1 lds
  v_mfma_f32_16x16x32_bf16 v[36:39], a[180:183], a[64:67], v[36:39]
  s_add_u32 m0, s30, 90112
  ds_read_b64_tr_b16 a[154:155], v236 offset:30720
  ds_read_b64_tr_b16 a[156:157], v236 offset:32768
  v_mfma_f32_16x16x32_bf16 v[52:55], a[180:183], a[68:71], v[52:55]
  s_waitcnt lgkmcnt(9)
  ds_read_b64_tr_b16 a[158:159], v236 offset:34816
  v_mfma_f32_16x16x32_bf16 v[40:43], a[184:187], a[64:67], v[40:43]
  s_add_u32 s35, s45, 0
  ds_read_b64_tr_b16 a[160:161], v236 offset:36864
  v_cvt_pk_bf16_f32 v32, v32, v33
  v_mfma_f32_16x16x32_bf16 v[56:59], a[184:187], a[68:71], v[56:59]
  ds_read_b64_tr_b16 a[162:163], v236 offset:38912
  v_cvt_pk_bf16_f32 v33, v34, v35
  v_mfma_f32_16x16x32_bf16 v[44:47], a[188:191], a[64:67], v[44:47]
  ds_read_b64_tr_b16 a[164:165], v237 offset:28672
  ds_read_b64_tr_b16 a[166:167], v237 offset:30720
  v_mfma_f32_16x16x32_bf16 v[60:63], a[188:191], a[68:71], v[60:63]
  buffer_load_dwordx4 v209, s[16:19], s35 offen sc1 lds
  v_mfma_f32_16x16x32_bf16 v[64:67], a[192:195], a[0:3], v[64:67]
  s_add_u32 m0, s30, 94208
  ds_read_b64_tr_b16 a[168:169], v237 offset:32768
  ds_read_b64_tr_b16 a[170:171], v237 offset:34816
  v_mfma_f32_16x16x32_bf16 v[64:67], a[196:199], a[8:11], v[64:67]
  s_add_u32 s35, s45, 73728
  ds_read_b64_tr_b16 a[172:173], v237 offset:36864
  v_cvt_pk_bf16_f32 v34, v36, v37
  v_mfma_f32_16x16x32_bf16 v[64:67], a[200:203], a[16:19], v[64:67]
  ds_read_b64_tr_b16 a[174:175], v237 offset:38912
  v_cvt_pk_bf16_f32 v35, v38, v39
  v_mfma_f32_16x16x32_bf16 v[80:83], a[192:195], a[4:7], v[80:83]
  s_add_u32 s48, s36, 0
  ds_read_b64_tr_b16 a[176:177], v234 offset:40960
  ds_read_b64_tr_b16 a[178:179], v234 offset:43008
  v_mfma_f32_16x16x32_bf16 v[80:83], a[196:199], a[12:15], v[80:83]
  buffer_store_dwordx4 v[32:35], v225, s[24:27], s48 offen sc1
  v_mfma_f32_16x16x32_bf16 v[80:83], a[200:203], a[20:23], v[80:83]
  s_waitcnt lgkmcnt(8)
  ds_read_b64_tr_b16 a[180:181], v234 offset:45056
  ds_read_b64_tr_b16 a[182:183], v234 offset:47104
  v_mfma_f32_16x16x32_bf16 v[68:71], a[204:207], a[0:3], v[68:71]
  buffer_load_dwordx4 v209, s[16:19], s35 offen sc1 lds
  v_mfma_f32_16x16x32_bf16 v[68:71], a[144:147], a[8:11], v[68:71]
  ds_read_b64_tr_b16 a[184:185], v235 offset:40960
  ds_read_b64_tr_b16 a[186:187], v235 offset:43008
  v_mfma_f32_16x16x32_bf16 v[68:71], a[148:151], a[16:19], v[68:71]
  ds_read_b64_tr_b16 a[188:189], v235 offset:45056
  v_cvt_pk_bf16_f32 v48, v48, v49
  v_mfma_f32_16x16x32_bf16 v[84:87], a[204:207], a[4:7], v[84:87]
  ds_read_b64_tr_b16 a[190:191], v235 offset:47104
  v_cvt_pk_bf16_f32 v49, v50, v51
  v_mfma_f32_16x16x32_bf16 v[84:87], a[144:147], a[12:15], v[84:87]
  ds_read_b64_tr_b16 a[192:193], v236 offset:40960
  v_cvt_pk_bf16_f32 v50, v52, v53
  v_mfma_f32_16x16x32_bf16 v[84:87], a[148:151], a[20:23], v[84:87]
  ds_read_b64_tr_b16 a[194:195], v236 offset:43008
  v_cvt_pk_bf16_f32 v51, v54, v55
  v_mfma_f32_16x16x32_bf16 v[72:75], a[152:155], a[0:3], v[72:75]
  ds_read_b64_tr_b16 a[196:197], v236 offset:45056
  ds_read_b64_tr_b16 a[198:199], v236 offset:47104
  v_mfma_f32_16x16x32_bf16 v[72:75], a[156:159], a[8:11], v[72:75]
  ds_read_b64_tr_b16 a[200:201], v237 offset:40960
  ds_read_b64_tr_b16 a[202:203], v237 offset:43008
  v_mfma_f32_16x16x32_bf16 v[72:75], a[160:163], a[16:19], v[72:75]
  buffer_store_dwordx4 v[48:51], v225, s[24:27], s48 offen offset:1024 sc1
  v_mfma_f32_16x16x32_bf16 v[88:91], a[152:155], a[4:7], v[88:91]
  v_cvt_pk_bf16_f32 v40, v40, v41
  v_cvt_pk_bf16_f32 v41, v42, v43
  v_mfma_f32_16x16x32_bf16 v[88:91], a[156:159], a[12:15], v[88:91]
  ds_read_b64_tr_b16 a[204:205], v237 offset:45056
  ds_read_b64_tr_b16 a[206:207], v237 offset:47104
  v_mfma_f32_16x16x32_bf16 v[88:91], a[160:163], a[20:23], v[88:91]
  s_waitcnt lgkmcnt(10)
  v_cvt_pk_bf16_f32 v42, v44, v45
  v_cvt_pk_bf16_f32 v43, v46, v47
  v_mfma_f32_16x16x32_bf16 v[76:79], a[164:167], a[0:3], v[76:79]
  buffer_store_dwordx4 v[40:43], v225, s[24:27], s48 offen offset:2048 sc1
  v_mfma_f32_16x16x32_bf16 v[76:79], a[168:171], a[8:11], v[76:79]
  v_cvt_pk_bf16_f32 v56, v56, v57
  v_cvt_pk_bf16_f32 v57, v58, v59
  v_mfma_f32_16x16x32_bf16 v[76:79], a[172:175], a[16:19], v[76:79]
  v_cvt_pk_bf16_f32 v58, v60, v61
  v_cvt_pk_bf16_f32 v59, v62, v63
  v_mfma_f32_16x16x32_bf16 v[92:95], a[164:167], a[4:7], v[92:95]
  buffer_store_dwordx4 v[56:59], v225, s[24:27], s48 offen offset:3072 sc1
  v_mfma_f32_16x16x32_bf16 v[92:95], a[168:171], a[12:15], v[92:95]
  v_mfma_f32_16x16x32_bf16 v[92:95], a[172:175], a[20:23], v[92:95]
L_st35:
  s_waitcnt vmcnt(22) lgkmcnt(0)
  s_barrier
  ds_read_b64_tr_b16 a[144:145], v226 offset:0
  v_mfma_f32_16x16x32_bf16 v[64:67], a[176:179], a[24:27], v[64:67]
  s_add_u32 m0, s30, 98304
  ds_read_b64_tr_b16 a[146:147], v226 offset:2048
  v_mfma_f32_16x16x32_bf16 v[64:67], a[180:183], a[32:35], v[64:67]
  s_add_u32 s35, s45, 147456
  ds_read_b64_tr_b16 a[148:149], v226 offset:4096
  v_mfma_f32_16x16x32_bf16 v[80:83], a[176:179], a[28:31], v[80:83]
  ds_read_b64_tr_b16 a[150:151], v226 offset:6144
  v_mfma_f32_16x16x32_bf16 v[80:83], a[180:183], a[36:39], v[80:83]
  ds_read_b64_tr_b16 a[152:153], v226 offset:8192
  v_mfma_f32_16x16x32_bf16 v[68:71], a[184:187], a[24:27], v[68:71]
  ds_read_b64_tr_b16 a[154:155], v226 offset:10240
  v_mfma_f32_16x16x32_bf16 v[68:71], a[188:191], a[32:35], v[68:71]
  ds_read_b64_tr_b16 a[156:157], v227 offset:0
  v_mfma_f32_16x16x32_bf16 v[84:87], a[184:187], a[28:31], v[84:87]
  ds_read_b64_tr_b16 a[158:159], v227 offset:2048
  ds_read_b64_tr_b16 a[160:161], v227 offset:4096
  v_mfma_f32_16x16x32_bf16 v[84:87], a[188:191], a[36:39], v[84:87]
  ds_read_b64_tr_b16 a[162:163], v227 offset:6144
  v_mfma_f32_16x16x32_bf16 v[72:75], a[192:195], a[24:27], v[72:75]
  ds_read_b64_tr_b16 a[164:165], v227 offset:8192
  v_mfma_f32_16x16x32_bf16 v[72:75], a[196:199], a[32:35], v[72:75]
  ds_read_b64_tr_b16 a[166:167], v227 offset:10240
  v_mfma_f32_16x16x32_bf16 v[88:91], a[192:195], a[28:31], v[88:91]
  ds_read_b64_tr_b16 a[168:169], v228 offset:0
  v_mfma_f32_16x16x32_bf16 v[88:91], a[196:199], a[36:39], v[88:91]
  ds_read_b64_tr_b16 a[170:171], v228 offset:2048
  v_mfma_f32_16x16x32_bf16 v[76:79], a[200:203], a[24:27], v[76:79]
  ds_read_b64_tr_b16 a[172:173], v228 offset:4096
  v_mfma_f32_16x16x32_bf16 v[76:79], a[204:207], a[32:35], v[76:79]
  ds_read_b64_tr_b16 a[174:175], v228 offset:6144
  v_mfma_f32_16x16x32_bf16 v[92:95], a[200:203], a[28:31], v[92:95]
  ds_read_b64_tr_b16 a[176:177], v228 offset:8192
  v_mfma_f32_16x16x32_bf16 v[92:95], a[204:207], a[36:39], v[92:95]
  s_waitcnt lgkmcnt(7)
  ds_read_b64_tr_b16 a[178:179], v228 offset:10240
  v_mfma_f32_16x16x32_bf16 v[64:67], a[144:147], a[40:43], v[64:67]
  ds_read_b64_tr_b16 a[180:181], v229 offset:0
  v_mfma_f32_16x16x32_bf16 v[64:67], a[148:151], a[48:51], v[64:67]
  ds_read_b64_tr_b16 a[182:183], v229 offset:2048
  v_mfma_f32_16x16x32_bf16 v[64:67], a[152:155], a[56:59], v[64:67]
  ds_read_b64_tr_b16 a[184:185], v229 offset:4096
  v_mfma_f32_16x16x32_bf16 v[80:83], a[144:147], a[44:47], v[80:83]
  ds_read_b64_tr_b16 a[186:187], v229 offset:6144
  v_mfma_f32_16x16x32_bf16 v[80:83], a[148:151], a[52:55], v[80:83]
  ds_read_b64_tr_b16 a[188:189], v229 offset:8192
  v_mfma_f32_16x16x32_bf16 v[80:83], a[152:155], a[60:63], v[80:83]
  ds_read_b64_tr_b16 a[190:191], v229 offset:10240
  ds_read_b64_tr_b16 a[192:193], v226 offset:12288
  v_mfma_f32_16x16x32_bf16 v[68:71], a[156:159], a[40:43], v[68:71]
  ds_read_b64_tr_b16 a[194:195], v226 offset:14336
  v_mfma_f32_16x16x32_bf16 v[68:71], a[160:163], a[48:51], v[68:71]
  s_waitcnt lgkmcnt(8)
  ds_read_b64_tr_b16 a[196:197], v227 offset:12288
  ds_read_b64_tr_b16 a[198:199], v227 offset:14336
  v_mfma_f32_16x16x32_bf16 v[68:71], a[164:167], a[56:59], v[68:71]
  buffer_load_dwordx4 v209, s[16:19], s35 offen sc1 lds
  v_mfma_f32_16x16x32_bf16 v[84:87], a[156:159], a[44:47], v[84:87]
  s_add_u32 m0, s30, 102400
  ds_read_b64_tr_b16 a[200:201], v228 offset:12288
  v_mfma_f32_16x16x32_bf16 v[84:87], a[160:163], a[52:55], v[84:87]
  s_add_u32 s35, s45, 221184
  ds_read_b64_tr_b16 a[202:203], v228 offset:14336
  v_mfma_f32_16x16x32_bf16 v[84:87], a[164:167], a[60:63], v[84:87]
  ds_read_b64_tr_b16 a[204:205], v229 offset:12288
  v_mfma_f32_16x16x32_bf16 v[72:75], a[168:171], a[40:43], v[72:75]
  ds_read_b64_tr_b16 a[206:207], v229 offset:14336
  v_mfma_f32_16x16x32_bf16 v[72:75], a[172:175], a[48:51], v[72:75]
  ds_read_b64_tr_b16 a[144:145], v226 offset:16384
  v_mfma_f32_16x16x32_bf16 v[72:75], a[176:179], a[56:59], v[72:75]
  ds_read_b64_tr_b16 a[146:147], v226 offset:18432
  v_mfma_f32_16x16x32_bf16 v[88:91], a[168:171], a[44:47], v[88:91]
  ds_read_b64_tr_b16 a[148:149], v226 offset:20480
  v_mfma_f32_16x16x32_bf16 v[88:91], a[172:175], a[52:55], v[88:91]
  ds_read_b64_tr_b16 a[150:151], v226 offset:22528
  v_mfma_f32_16x16x32_bf16 v[88:91], a[176:179], a[60:63], v[88:91]
  s_waitcnt lgkmcnt(8)
  ds_read_b64_tr_b16 a[152:153], v227 offset:16384
  v_mfma_f32_16x16x32_bf16 v[76:79], a[180:183], a[40:43], v[76:79]
  ds_read_b64_tr_b16 a[154:155], v227 offset:18432
  v_mfma_f32_16x16x32_bf16 v[76:79], a[184:187], a[48:51], v[76:79]
  ds_read_b64_tr_b16 a[156:157], v227 offset:20480
  v_mfma_f32_16x16x32_bf16 v[76:79], a[188:191], a[56:59], v[76:79]
  ds_read_b64_tr_b16 a[158:159], v227 offset:22528
  ds_read_b64_tr_b16 a[160:161], v228 offset:16384
  v_mfma_f32_16x16x32_bf16 v[92:95], a[180:183], a[44:47], v[92:95]
  ds_read_b64_tr_b16 a[162:163], v228 offset:18432
  v_mfma_f32_16x16x32_bf16 v[92:95], a[184:187], a[52:55], v[92:95]
  ds_read_b64_tr_b16 a[164:165], v228 offset:20480
  v_mfma_f32_16x16x32_bf16 v[92:95], a[188:191], a[60:63], v[92:95]
  ds_read_b64_tr_b16 a[166:167], v228 offset:22528
  v_mfma_f32_16x16x32_bf16 v[64:67], a[192:195], a[64:67], v[64:67]
  ds_read_b64_tr_b16 a[168:169], v229 offset:16384
  v_mfma_f32_16x16x32_bf16 v[80:83], a[192:195], a[68:71], v[80:83]
  ds_read_b64_tr_b16 a[170:171], v229 offset:18432
  v_mfma_f32_16x16x32_bf16 v[68:71], a[196:199], a[64:67], v[68:71]
  ds_read_b64_tr_b16 a[172:173], v229 offset:20480
  v_mfma_f32_16x16x32_bf16 v[84:87], a[196:199], a[68:71], v[84:87]
  s_waitcnt lgkmcnt(9)
  ds_read_b64_tr_b16 a[174:175], v229 offset:22528
  v_mfma_f32_16x16x32_bf16 v[72:75], a[200:203], a[64:67], v[72:75]
  ds_read_b64_tr_b16 a[176:177], v226 offset:24576
  v_mfma_f32_16x16x32_bf16 v[88:91], a[200:203], a[68:71], v[88:91]
  ds_read_b64_tr_b16 a[178:179], v226 offset:26624
  v_mfma_f32_16x16x32_bf16 v[76:79], a[204:207], a[64:67], v[76:79]
  ds_read_b64_tr_b16 a[180:181], v226 offset:28672
  v_cvt_pk_bf16_f32 v64, v64, v65
  v_mfma_f32_16x16x32_bf16 v[92:95], a[204:207], a[68:71], v[92:95]
L_st36:
  ds_read_b64_tr_b16 a[182:183], v226 offset:30720
  v_cvt_pk_bf16_f32 v65, v66, v67
  v_mfma_f32_16x16x32_bf16 v[96:99], a[144:147], a[0:3], v[96:99]
  ds_read_b64_tr_b16 a[184:185], v226 offset:32768
  v_cvt_pk_bf16_f32 v66, v68, v69
  v_mfma_f32_16x16x32_bf16 v[96:99], a[148:151], a[8:11], v[96:99]
  ds_read_b64_tr_b16 a[186:187], v226 offset:34816
  v_cvt_pk_bf16_f32 v67, v70, v71
  v_mfma_f32_16x16x32_bf16 v[112:115], a[144:147], a[4:7], v[112:115]
  s_add_u32 s48, s36, 4096
  ds_read_b64_tr_b16 a[188:189], v227 offset:24576
  ds_read_b64_tr_b16 a[190:191], v227 offset:26624
  v_mfma_f32_16x16x32_bf16 v[112:115], a[148:151], a[12:15], v[112:115]
  buffer_load_dwordx4 v209, s[16:19], s35 offen sc1 lds
  v_mfma_f32_16x16x32_bf16 v[100:103], a[152:155], a[0:3], v[100:103]
  s_waitcnt lgkmcnt(8)
  ds_read_b64_tr_b16 a[192:193], v227 offset:28672
  ds_read_b64_tr_b16 a[194:195], v227 offset:30720
  v_mfma_f32_16x16x32_bf16 v[100:103], a[156:159], a[8:11], v[100:103]
  s_add_u32 m0, s30, 106496
  ds_read_b64_tr_b16 a[196:197], v227 offset:32768
  ds_read_b64_tr_b16 a[198:199], v227 offset:34816
  v_mfma_f32_16x16x32_bf16 v[116:119], a[152:155], a[4:7], v[116:119]
  s_add_u32 s35, s46, 0
  buffer_store_dwordx4 v[64:67], v225, s[24:27], s48 offen sc1
  v_mfma_f32_16x16x32_bf16 v[116:119], a[156:159], a[12:15], v[116:119]
  ds_read_b64_tr_b16 a[200:201], v228 offset:24576
  v_cvt_pk_bf16_f32 v80, v80, v81
  v_mfma_f32_16x16x32_bf16 v[104:107], a[160:163], a[0:3], v[104:107]
  ds_read_b64_tr_b16 a[202:203], v228 offset:26624
  v_cvt_pk_bf16_f32 v81, v82, v83
  v_mfma_f32_16x16x32_bf16 v[104:107], a[164:167], a[8:11], v[104:107]
  ds_read_b64_tr_b16 a[204:205], v228 offset:28672
  v_cvt_pk_bf16_f32 v82, v84, v85
  v_mfma_f32_16x16x32_bf16 v[120:123], a[160:163], a[4:7], v[120:123]
  ds_read_b64_tr_b16 a[206:207], v228 offset:30720
  v_cvt_pk_bf16_f32 v83, v86, v87
  v_mfma_f32_16x16x32_bf16 v[120:123], a[164:167], a[12:15], v[120:123]
  ds_read_b64_tr_b16 a[144:145], v228 offset:32768
  ds_read_b64_tr_b16 a[146:147], v228 offset:34816
  v_mfma_f32_16x16x32_bf16 v[108:111], a[168:171], a[0:3], v[108:111]
  buffer_store_dwordx4 v[80:83], v225, s[24:27], s48 offen offset:1024 sc1
  v_mfma_f32_16x16x32_bf16 v[108:111], a[172:175], a[8:11], v[108:111]
  ds_read_b64_tr_b16 a[148:149], v229 offset:24576
  v_cvt_pk_bf16_f32 v72, v72, v73
  v_mfma_f32_16x16x32_bf16 v[124:127], a[168:171], a[4:7], v[124:127]
  ds_read_b64_tr_b16 a[150:151], v229 offset:26624
  v_cvt_pk_bf16_f32 v73, v74, v75
  v_mfma_f32_16x16x32_bf16 v[124:127], a[172:175], a[12:15], v[124:127]
  s_waitcnt lgkmcnt(8)
  ds_read_b64_tr_b16 a[152:153], v229 offset:28672
  v_cvt_pk_bf16_f32 v74, v76, v77
  v_mfma_f32_16x16x32_bf16 v[96:99], a[176:179], a[16:19], v[96:99]
  ds_read_b64_tr_b16 a[154:155], v229 offset:30720
  v_cvt_pk_bf16_f32 v75, v78, v79
  v_mfma_f32_16x16x32_bf16 v[96:99], a[180:183], a[24:27], v[96:99]
  ds_read_b64_tr_b16 a[156:157], v229 offset:32768
  ds_read_b64_tr_b16 a[158:159], v229 offset:34816
  v_mfma_f32_16x16x32_bf16 v[96:99], a[184:187], a[32:35], v[96:99]
  buffer_store_dwordx4 v[72:75], v225, s[24:27], s48 offen offset:2048 sc1
  v_mfma_f32_16x16x32_bf16 v[112:115], a[176:179], a[20:23], v[112:115]
  ds_read_b64_tr_b16 a[160:161], v226 offset:36864
  ds_read_b64_tr_b16 a[162:163], v226 offset:38912
  v_mfma_f32_16x16x32_bf16 v[112:115], a[180:183], a[28:31], v[112:115]
  ds_read_b64_tr_b16 a[164:165], v226 offset:40960
  v_cvt_pk_bf16_f32 v88, v88, v89
  v_mfma_f32_16x16x32_bf16 v[112:115], a[184:187], a[36:39], v[112:115]
  ds_read_b64_tr_b16 a[166:167], v226 offset:43008
  v_cvt_pk_bf16_f32 v89, v90, v91
  v_mfma_f32_16x16x32_bf16 v[100:103], a[188:191], a[16:19], v[100:103]
  ds_read_b64_tr_b16 a[168:169], v226 offset:45056
  v_cvt_pk_bf16_f32 v90, v92, v93
  v_mfma_f32_16x16x32_bf16 v[100:103], a[192:195], a[24:27], v[100:103]
  ds_read_b64_tr_b16 a[170:171], v226 offset:47104
  v_cvt_pk_bf16_f32 v91, v94, v95
  v_mfma_f32_16x16x32_bf16 v[100:103], a[196:199], a[32:35], v[100:103]
  ds_read_b64_tr_b16 a[172:173], v227 offset:36864
  ds_read_b64_tr_b16 a[174:175], v227 offset:38912
  v_mfma_f32_16x16x32_bf16 v[116:119], a[188:191], a[20:23], v[116:119]
  buffer_store_dwordx4 v[88:91], v225, s[24:27], s48 offen offset:3072 sc1
  v_mfma_f32_16x16x32_bf16 v[116:119], a[192:195], a[28:31], v[116:119]
  ds_read_b64_tr_b16 a[176:177], v227 offset:40960
  v_mfma_f32_16x16x32_bf16 v[116:119], a[196:199], a[36:39], v[116:119]
  s_waitcnt lgkmcnt(9)
  ds_read_b64_tr_b16 a[178:179], v227 offset:43008
  v_mfma_f32_16x16x32_bf16 v[104:107], a[200:203], a[16:19], v[104:107]
  buffer_load_dwordx4 v209, s[16:19], s35 offen sc1 lds
  v_mfma_f32_16x16x32_bf16 v[104:107], a[204:207], a[24:27], v[104:107]
  ds_read_b64_tr_b16 a[180:181], v227 offset:45056
  ds_read_b64_tr_b16 a[182:183], v227 offset:47104
  v_mfma_f32_16x16x32_bf16 v[104:107], a[144:147], a[32:35], v[104:107]
  ds_read_b64_tr_b16 a[184:185], v228 offset:36864
  v_mfma_f32_16x16x32_bf16 v[120:123], a[200:203], a[20:23], v[120:123]
  ds_read_b64_tr_b16 a[186:187], v228 offset:38912
  v_mfma_f32_16x16x32_bf16 v[120:123], a[204:207], a[28:31], v[120:123]
  ds_read_b64_tr_b16 a[188:189], v228 offset:40960
  v_mfma_f32_16x16x32_bf16 v[120:123], a[144:147], a[36:39], v[120:123]
  ds_read_b64_tr_b16 a[190:191], v228 offset:43008
  v_mfma_f32_16x16x32_bf16 v[108:111], a[148:151], a[16:19], v[108:111]
  ds_read_b64_tr_b16 a[192:193], v228 offset:45056
  ds_read_b64_tr_b16 a[194:195], v228 offset:47104
  v_mfma_f32_16x16x32_bf16 v[108:111], a[152:155], a[24:27], v[108:111]
  ds_read_b64_tr_b16 a[196:197], v229 offset:36864
  v_mfma_f32_16x16x32_bf16 v[108:111], a[156:159], a[32:35], v[108:111]
  ds_read_b64_tr_b16 a[198:199], v229 offset:38912
  v_mfma_f32_16x16x32_bf16 v[124:127], a[148:151], a[20:23], v[124:127]
  ds_read_b64_tr_b16 a[200:201], v229 offset:40960
  v_mfma_f32_16x16x32_bf16 v[124:127], a[152:155], a[28:31], v[124:127]
  ds_read_b64_tr_b16 a[202:203], v229 offset:43008
  v_mfma_f32_16x16x32_bf16 v[124:127], a[156:159], a[36:39], v[124:127]
  s_waitcnt lgkmcnt(10)
  ds_read_b64_tr_b16 a[204:205], v229 offset:45056
  v_mfma_f32_16x16x32_bf16 v[96:99], a[160:163], a[40:43], v[96:99]
  ds_read_b64_tr_b16 a[206:207], v229 offset:47104
  v_mfma_f32_16x16x32_bf16 v[96:99], a[164:167], a[48:51], v[96:99]
  v_mfma_f32_16x16x32_bf16 v[96:99], a[168:171], a[56:59], v[96:99]
  v_mfma_f32_16x16x32_bf16 v[112:115], a[160:163], a[44:47], v[112:115]
  v_mfma_f32_16x16x32_bf16 v[112:115], a[164:167], a[52:55], v[112:115]
  v_mfma_f32_16x16x32_bf16 v[112:115], a[168:171], a[60:63], v[112:115]
  v_mfma_f32_16x16x32_bf16 v[100:103], a[172:175], a[40:43], v[100:103]
  v_mfma_f32_16x16x32_bf16 v[100:103], a[176:179], a[48:51], v[100:103]
L_st37:
  s_waitcnt vmcnt(10) lgkmcnt(0)
  s_barrier
  ds_read_b64_tr_b16 a[144:145], v230 offset:0
  v_mfma_f32_16x16x32_bf16 v[100:103], a[180:183], a[56:59], v[100:103]
  ds_read_b64_tr_b16 a[146:147], v230 offset:2048
  v_mfma_f32_16x16x32_bf16 v[116:119], a[172:175], a[44:47], v[116:119]
  ds_read_b64_tr_b16 a[148:149], v231 offset:0
  v_mfma_f32_16x16x32_bf16 v[116:119], a[176:179], a[52:55], v[116:119]
  ds_read_b64_tr_b16 a[150:151], v231 offset:2048
  v_mfma_f32_16x16x32_bf16 v[116:119], a[180:183], a[60:63], v[116:119]
  ds_read_b64_tr_b16 a[152:153], v232 offset:0
  v_mfma_f32_16x16x32_bf16 v[104:107], a[184:187], a[40:43], v[104:107]
  ds_read_b64_tr_b16 a[154:155], v232 offset:2048
  v_mfma_f32_16x16x32_bf16 v[104:107], a[188:191], a[48:51], v[104:107]
  ds_read_b64_tr_b16 a[156:157], v233 offset:0
  v_mfma_f32_16x16x32_bf16 v[104:107], a[192:195], a[56:59], v[104:107]
  ds_read_b64_tr_b16 a[158:159], v233 offset:2048
  v_mfma_f32_16x16x32_bf16 v[120:123], a[184:187], a[44:47], v[120:123]
  ds_read_b64_tr_b16 a[160:161], v230 offset:4096
  v_mfma_f32_16x16x32_bf16 v[120:123], a[188:191], a[52:55], v[120:123]
  ds_read_b64_tr_b16 a[162:163], v230 offset:6144
  v_mfma_f32_16x16x32_bf16 v[120:123], a[192:195], a[60:63], v[120:123]
  ds_read_b64_tr_b16 a[164:165], v230 offset:8192
  v_mfma_f32_16x16x32_bf16 v[108:111], a[196:199], a[40:43], v[108:111]
  ds_read_b64_tr_b16 a[166:167], v230 offset:10240
  v_mfma_f32_16x16x32_bf16 v[108:111], a[200:203], a[48:51], v[108:111]
  ds_read_b64_tr_b16 a[168:169], v230 offset:12288
  ds_read_b64_tr_b16 a[170:171], v230 offset:14336
  v_mfma_f32_16x16x32_bf16 v[108:111], a[204:207], a[56:59], v[108:111]
  ds_read_b64_tr_b16 a[172:173], v231 offset:4096
  v_mfma_f32_16x16x32_bf16 v[124:127], a[196:199], a[44:47], v[124:127]
  ds_read_b64_tr_b16 a[174:175], v231 offset:6144
  v_mfma_f32_16x16x32_bf16 v[124:127], a[200:203], a[52:55], v[124:127]
  ds_read_b64_tr_b16 a[176:177], v231 offset:8192
  v_mfma_f32_16x16x32_bf16 v[124:127], a[204:207], a[60:63], v[124:127]
  s_waitcnt lgkmcnt(9)
  ds_read_b64_tr_b16 a[178:179], v231 offset:10240
  v_mfma_f32_16x16x32_bf16 v[96:99], a[144:147], a[64:67], v[96:99]
  ds_read_b64_tr_b16 a[180:181], v231 offset:12288
  v_mfma_f32_16x16x32_bf16 v[112:115], a[144:147], a[68:71], v[112:115]
  ds_read_b64_tr_b16 a[182:183], v231 offset:14336
  v_mfma_f32_16x16x32_bf16 v[100:103], a[148:151], a[64:67], v[100:103]
  ds_read_b64_tr_b16 a[184:185], v232 offset:4096
  v_mfma_f32_16x16x32_bf16 v[116:119], a[148:151], a[68:71], v[116:119]
  ds_read_b64_tr_b16 a[186:187], v232 offset:6144
  v_mfma_f32_16x16x32_bf16 v[104:107], a[152:155], a[64:67], v[104:107]
  ds_read_b64_tr_b16 a[188:189], v232 offset:8192
  v_mfma_f32_16x16x32_bf16 v[120:123], a[152:155], a[68:71], v[120:123]
  ds_read_b64_tr_b16 a[190:191], v232 offset:10240
  v_mfma_f32_16x16x32_bf16 v[108:111], a[156:159], a[64:67], v[108:111]
  ds_read_b64_tr_b16 a[192:193], v232 offset:12288
  v_cvt_pk_bf16_f32 v96, v96, v97
  v_mfma_f32_16x16x32_bf16 v[124:127], a[156:159], a[68:71], v[124:127]
  s_waitcnt lgkmcnt(7)
  ds_read_b64_tr_b16 a[194:195], v232 offset:14336
  v_cvt_pk_bf16_f32 v97, v98, v99
  v_mfma_f32_16x16x32_bf16 v[0:3], a[160:163], a[0:3], v[0:3]
  ds_read_b64_tr_b16 a[196:197], v233 offset:4096
  v_cvt_pk_bf16_f32 v98, v100, v101
  v_mfma_f32_16x16x32_bf16 v[0:3], a[164:167], a[8:11], v[0:3]
  s_waitcnt vmcnt(1)
  buffer_store_dword v252, off, s[60:63], s90 sc1
  v_mfma_f32_16x16x32_bf16 v[0:3], a[168:171], a[16:19], v[0:3]
  ds_read_b64_tr_b16 a[198:199], v233 offset:6144
  ds_read_b64_tr_b16 a[200:201], v233 offset:8192
  v_mfma_f32_16x16x32_bf16 v[16:19], a[160:163], a[4:7], v[16:19]
  ds_read_b64_tr_b16 a[202:203], v233 offset:10240
  v_cvt_pk_bf16_f32 v99, v102, v103
  v_mfma_f32_16x16x32_bf16 v[16:19], a[164:167], a[12:15], v[16:19]
  s_add_u32 s48, s36, 8192
  ds_read_b64_tr_b16 a[204:205], v233 offset:12288
  ds_read_b64_tr_b16 a[206:207], v233 offset:14336
  v_mfma_f32_16x16x32_bf16 v[16:19], a[168:171], a[20:23], v[16:19]
  buffer_store_dwordx4 v[96:99], v225, s[24:27], s48 offen sc1
  v_mfma_f32_16x16x32_bf16 v[4:7], a[172:175], a[0:3], v[4:7]
  ds_read_b64_tr_b16 a[144:145], v230 offset:16384
  v_cvt_pk_bf16_f32 v112, v112, v113
  v_mfma_f32_16x16x32_bf16 v[4:7], a[176:179], a[8:11], v[4:7]
  s_waitcnt lgkmcnt(7)
  ds_read_b64_tr_b16 a[146:147], v230 offset:18432
  v_cvt_pk_bf16_f32 v113, v114, v115
  v_mfma_f32_16x16x32_bf16 v[4:7], a[180:183], a[16:19], v[4:7]
  ds_read_b64_tr_b16 a[148:149], v230 offset:20480
  v_cvt_pk_bf16_f32 v114, v116, v117
  v_mfma_f32_16x16x32_bf16 v[20:23], a[172:175], a[4:7], v[20:23]
  ds_read_b64_tr_b16 a[150:151], v230 offset:22528
  ds_read_b64_tr_b16 a[152:153], v231 offset:16384
  v_mfma_f32_16x16x32_bf16 v[20:23], a[176:179], a[12:15], v[20:23]
  ds_read_b64_tr_b16 a[154:155], v231 offset:18432
  v_cvt_pk_bf16_f32 v115, v118, v119
  v_mfma_f32_16x16x32_bf16 v[20:23], a[180:183], a[20:23], v[20:23]
  ds_read_b64_tr_b16 a[156:157], v231 offset:20480
  ds_read_b64_tr_b16 a[158:159], v231 offset:22528
  v_mfma_f32_16x16x32_bf16 v[8:11], a[184:187], a[0:3], v[8:11]
  buffer_store_dwordx4 v[112:115], v225, s[24:27], s48 offen offset:1024 sc1
  v_mfma_f32_16x16x32_bf16 v[8:11], a[188:191], a[8:11], v[8:11]
  ds_read_b64_tr_b16 a[160:161], v232 offset:16384
  v_cvt_pk_bf16_f32 v104, v104, v105
  v_mfma_f32_16x16x32_bf16 v[8:11], a[192:195], a[16:19], v[8:11]
  ds_read_b64_tr_b16 a[162:163], v232 offset:18432
  v_cvt_pk_bf16_f32 v105, v106, v107
  v_mfma_f32_16x16x32_bf16 v[24:27], a[184:187], a[4:7], v[24:27]
  ds_read_b64_tr_b16 a[164:165], v232 offset:20480
  v_cvt_pk_bf16_f32 v106, v108, v109
  v_mfma_f32_16x16x32_bf16 v[24:27], a[188:191], a[12:15], v[24:27]
  ds_read_b64_tr_b16 a[166:167], v232 offset:22528
  v_cvt_pk_bf16_f32 v107, v110, v111
  v_mfma_f32_16x16x32_bf16 v[24:27], a[192:195], a[20:23], v[24:27]
  s_waitcnt lgkmcnt(8)
  ds_read_b64_tr_b16 a[168:169], v233 offset:16384
  ds_read_b64_tr_b16 a[170:171], v233 offset:18432
  v_mfma_f32_16x16x32_bf16 v[12:15], a[196:199], a[0:3], v[12:15]
  buffer_store_dwordx4 v[104:107], v225, s[24:27], s48 offen offset:2048 sc1
  v_mfma_f32_16x16x32_bf16 v[12:15], a[200:203], a[8:11], v[12:15]
  ds_read_b64_tr_b16 a[172:173], v233 offset:20480
  v_cvt_pk_bf16_f32 v120, v120, v121
  v_mfma_f32_16x16x32_bf16 v[12:15], a[204:207], a[16:19], v[12:15]
  ds_read_b64_tr_b16 a[174:175], v233 offset:22528
  v_cvt_pk_bf16_f32 v121, v122, v123
  v_mfma_f32_16x16x32_bf16 v[28:31], a[196:199], a[4:7], v[28:31]
  ds_read_b64_tr_b16 a[176:177], v230 offset:24576
  ds_read_b64_tr_b16 a[178:179], v230 offset:26624
  v_mfma_f32_16x16x32_bf16 v[28:31], a[200:203], a[12:15], v[28:31]
  ds_read_b64_tr_b16 a[180:181], v230 offset:28672
  v_cvt_pk_bf16_f32 v122, v124, v125
  v_mfma_f32_16x16x32_bf16 v[28:31], a[204:207], a[20:23], v[28:31]
L_st38:
  ds_read_b64_tr_b16 a[182:183], v230 offset:30720
  v_cvt_pk_bf16_f32 v123, v126, v127
  v_mfma_f32_16x16x32_bf16 v[0:3], a[144:147], a[24:27], v[0:3]
  ds_read_b64_tr_b16 a[184:185], v230 offset:32768
  ds_read_b64_tr_b16 a[186:187], v230 offset:34816
  v_mfma_f32_16x16x32_bf16 v[0:3], a[148:151], a[32:35], v[0:3]
  buffer_store_dwordx4 v[120:123], v225, s[24:27], s48 offen offset:3072 sc1
  v_mfma_f32_16x16x32_bf16 v[16:19], a[144:147], a[28:31], v[16:19]
  ds_read_b64_tr_b16 a[188:189], v231 offset:24576
  v_mfma_f32_16x16x32_bf16 v[16:19], a[148:151], a[36:39], v[16:19]
  s_waitcnt lgkmcnt(9)
  ds_read_b64_tr_b16 a[190:191], v231 offset:26624
  v_mfma_f32_16x16x32_bf16 v[4:7], a[152:155], a[24:27], v[4:7]
  ds_read_b64_tr_b16 a[192:193], v231 offset:28672
  v_mfma_f32_16x16x32_bf16 v[4:7], a[156:159], a[32:35], v[4:7]
  ds_read_b64_tr_b16 a[194:195], v231 offset:30720
  v_mfma_f32_16x16x32_bf16 v[20:23], a[152:155], a[28:31], v[20:23]
  ds_read_b64_tr_b16 a[196:197], v231 offset:32768
  v_mfma_f32_16x16x32_bf16 v[20:23], a[156:159], a[36:39], v[20:23]
  ds_read_b64_tr_b16 a[198:199], v231 offset:34816
  v_mfma_f32_16x16x32_bf16 v[8:11], a[160:163], a[24:27], v[8:11]
  ds_read_b64_tr_b16 a[200:201], v232 offset:24576
  v_mfma_f32_16x16x32_bf16 v[8:11], a[164:167], a[32:35], v[8:11]
  ds_read_b64_tr_b16 a[202:203], v232 offset:26624
  v_mfma_f32_16x16x32_bf16 v[24:27], a[160:163], a[28:31], v[24:27]
  ds_read_b64_tr_b16 a[204:205], v232 offset:28672
  ds_read_b64_tr_b16 a[206:207], v232 offset:30720
  v_mfma_f32_16x16x32_bf16 v[24:27], a[164:167], a[36:39], v[24:27]
  ds_read_b64_tr_b16 a[144:145], v232 offset:32768
  v_mfma_f32_16x16x32_bf16 v[12:15], a[168:171], a[24:27], v[12:15]
  s_waitcnt lgkmcnt(9)
  ds_read_b64_tr_b16 a[146:147], v232 offset:34816
  v_mfma_f32_16x16x32_bf16 v[12:15], a[172:175], a[32:35], v[12:15]
  ds_read_b64_tr_b16 a[148:149], v233 offset:24576
  v_mfma_f32_16x16x32_bf16 v[28:31], a[168:171], a[28:31], v[28:31]
  ds_read_b64_tr_b16 a[150:151], v233 offset:26624
  v_mfma_f32_16x16x32_bf16 v[28:31], a[172:175], a[36:39], v[28:31]
  ds_read_b64_tr_b16 a[152:153], v233 offset:28672
  v_mfma_f32_16x16x32_bf16 v[0:3], a[176:179], a[40:43], v[0:3]
  ds_read_b64_tr_b16 a[154:155], v233 offset:30720
  v_mfma_f32_16x16x32_bf16 v[0:3], a[180:183], a[48:51], v[0:3]
  ds_read_b64_tr_b16 a[156:157], v233 offset:32768
  v_mfma_f32_16x16x32_bf16 v[0:3], a[184:187], a[56:59], v[0:3]
  ds_read_b64_tr_b16 a[158:159], v233 offset:34816
  v_mfma_f32_16x16x32_bf16 v[16:19], a[176:179], a[44:47], v[16:19]
  ds_read_b64_tr_b16 a[160:161], v230 offset:36864
  v_mfma_f32_16x16x32_bf16 v[16:19], a[180:183], a[52:55], v[16:19]
  ds_read_b64_tr_b16 a[162:163], v230 offset:38912
  v_mfma_f32_16x16x32_bf16 v[16:19], a[184:187], a[60:63], v[16:19]
  ds_read_b64_tr_b16 a[164:165], v231 offset:36864
  v_mfma_f32_16x16x32_bf16 v[4:7], a[188:191], a[40:43], v[4:7]
  s_waitcnt lgkmcnt(7)
  ds_read_b64_tr_b16 a[166:167], v231 offset:38912
  ds_read_b64_tr_b16 a[168:169], v232 offset:36864
  v_mfma_f32_16x16x32_bf16 v[4:7], a[192:195], a[48:51], v[4:7]
  ds_read_b64_tr_b16 a[170:171], v232 offset:38912
  v_mfma_f32_16x16x32_bf16 v[4:7], a[196:199], a[56:59], v[4:7]
  ds_read_b64_tr_b16 a[172:173], v233 offset:36864
  v_mfma_f32_16x16x32_bf16 v[20:23], a[188:191], a[44:47], v[20:23]
  ds_read_b64_tr_b16 a[174:175], v233 offset:38912
  v_mfma_f32_16x16x32_bf16 v[20:23], a[192:195], a[52:55], v[20:23]
  ds_read_b64_tr_b16 a[176:177], v206 offset:40960
  v_mfma_f32_16x16x32_bf16 v[20:23], a[196:199], a[60:63], v[20:23]
  ds_read_b64_tr_b16 a[178:179], v206 offset:41984
  v_mfma_f32_16x16x32_bf16 v[8:11], a[200:203], a[40:43], v[8:11]
  ds_read_b64_tr_b16 a[180:181], v206 offset:43008
  v_mfma_f32_16x16x32_bf16 v[8:11], a[204:207], a[48:51], v[8:11]
  ds_read_b64_tr_b16 a[182:183], v206 offset:44032
  v_mfma_f32_16x16x32_bf16 v[8:11], a[144:147], a[56:59], v[8:11]
  ds_read_b64_tr_b16 a[184:185], v207 offset:40960
  v_mfma_f32_16x16x32_bf16 v[24:27], a[200:203], a[44:47], v[24:27]
  ds_read_b64_tr_b16 a[186:187], v207 offset:41984
  v_mfma_f32_16x16x32_bf16 v[24:27], a[204:207], a[52:55], v[24:27]
  ds_read_b64_tr_b16 a[188:189], v207 offset:43008
  v_mfma_f32_16x16x32_bf16 v[24:27], a[144:147], a[60:63], v[24:27]
  ds_read_b64_tr_b16 a[190:191], v207 offset:44032
  v_mfma_f32_16x16x32_bf16 v[12:15], a[148:151], a[40:43], v[12:15]
  s_waitcnt lgkmcnt(8)
  ds_read_b64_tr_b16 a[192:193], v206 offset:45056
  ds_read_b64_tr_b16 a[194:195], v206 offset:46080
  v_mfma_f32_16x16x32_bf16 v[12:15], a[152:155], a[48:51], v[12:15]
  ds_read_b64_tr_b16 a[196:197], v206 offset:47104
  v_mfma_f32_16x16x32_bf16 v[12:15], a[156:159], a[56:59], v[12:15]
  ds_read_b64_tr_b16 a[198:199], v206 offset:48128
  v_mfma_f32_16x16x32_bf16 v[28:31], a[148:151], a[44:47], v[28:31]
  ds_read_b64_tr_b16 a[200:201], v207 offset:45056
  v_mfma_f32_16x16x32_bf16 v[28:31], a[152:155], a[52:55], v[28:31]
  ds_read_b64_tr_b16 a[202:203], v207 offset:46080
  v_mfma_f32_16x16x32_bf16 v[28:31], a[156:159], a[60:63], v[28:31]
  ds_read_b64_tr_b16 a[204:205], v207 offset:47104
  v_mfma_f32_16x16x32_bf16 v[0:3], a[160:163], a[64:67], v[0:3]
  ds_read_b64_tr_b16 a[206:207], v207 offset:48128
  v_mfma_f32_16x16x32_bf16 v[16:19], a[160:163], a[68:71], v[16:19]
  v_mfma_f32_16x16x32_bf16 v[4:7], a[164:167], a[64:67], v[4:7]
  v_mfma_f32_16x16x32_bf16 v[20:23], a[164:167], a[68:71], v[20:23]
  v_mfma_f32_16x16x32_bf16 v[8:11], a[168:171], a[64:67], v[8:11]
  v_mfma_f32_16x16x32_bf16 v[24:27], a[168:171], a[68:71], v[24:27]
  v_mfma_f32_16x16x32_bf16 v[12:15], a[172:175], a[64:67], v[12:15]
  v_mfma_f32_16x16x32_bf16 v[28:31], a[172:175], a[68:71], v[28:31]
L_st39:
  s_waitcnt vmcnt(5) lgkmcnt(0)
  s_barrier
  v_mfma_f32_16x16x32_bf16 v[216:219], a[176:179], a[0:3], v[216:219]
  ds_read_b64_tr_b16 a[144:145], v212 offset:0
  v_cvt_pk_bf16_f32 v0, v0, v1
  v_mfma_f32_16x16x32_bf16 v[216:219], a[180:183], a[8:11], v[216:219]
  ds_read_b64_tr_b16 a[146:147], v212 offset:1024
  v_cvt_pk_bf16_f32 v1, v2, v3
  v_mfma_f32_16x16x32_bf16 v[240:243], a[176:179], a[4:7], v[240:243]
  ds_read_b64_tr_b16 a[148:149], v212 offset:2048
  v_cvt_pk_bf16_f32 v2, v4, v5
  v_mfma_f32_16x16x32_bf16 v[240:243], a[180:183], a[12:15], v[240:243]
  ds_read_b64_tr_b16 a[150:151], v212 offset:3072
  v_cvt_pk_bf16_f32 v3, v6, v7
  v_mfma_f32_16x16x32_bf16 v[220:223], a[184:187], a[0:3], v[220:223]
  s_add_u32 s48, s36, 12288
  buffer_store_dwordx4 v[0:3], v225, s[24:27], s48 offen sc1
  v_mfma_f32_16x16x32_bf16 v[220:223], a[188:191], a[8:11], v[220:223]
  ds_read_b64_tr_b16 a[152:153], v213 offset:0
  v_cvt_pk_bf16_f32 v16, v16, v17
  v_mfma_f32_16x16x32_bf16 v[244:247], a[184:187], a[4:7], v[244:247]
  ds_read_b64_tr_b16 a[154:155], v213 offset:1024
  v_cvt_pk_bf16_f32 v17, v18, v19
  v_mfma_f32_16x16x32_bf16 v[244:247], a[188:191], a[12:15], v[244:247]
  ds_read_b64_tr_b16 a[156:157], v213 offset:2048
  v_cvt_pk_bf16_f32 v18, v20, v21
  v_mfma_f32_16x16x32_bf16 v[216:219], a[192:195], a[16:19], v[216:219]
  v_cvt_pk_bf16_f32 v19, v22, v23
  v_mfma_f32_16x16x32_bf16 v[216:219], a[196:199], a[24:27], v[216:219]
  ds_read_b64_tr_b16 a[158:159], v213 offset:3072
  ds_read_b64_tr_b16 a[160:161], v212 offset:4096
  v_mfma_f32_16x16x32_bf16 v[240:243], a[192:195], a[20:23], v[240:243]
  buffer_store_dwordx4 v[16:19], v225, s[24:27], s48 offen offset:1024 sc1
  v_mfma_f32_16x16x32_bf16 v[240:243], a[196:199], a[28:31], v[240:243]
  ds_read_b64_tr_b16 a[162:163], v212 offset:5120
  v_cvt_pk_bf16_f32 v8, v8, v9
  v_mfma_f32_16x16x32_bf16 v[220:223], a[200:203], a[16:19], v[220:223]
  ds_read_b64_tr_b16 a[164:165], v212 offset:6144
  v_cvt_pk_bf16_f32 v9, v10, v11
  v_mfma_f32_16x16x32_bf16 v[220:223], a[204:207], a[24:27], v[220:223]
  v_cvt_pk_bf16_f32 v10, v12, v13
  v_cvt_pk_bf16_f32 v11, v14, v15
  v_mfma_f32_16x16x32_bf16 v[244:247], a[200:203], a[20:23], v[244:247]
  ds_read_b64_tr_b16 a[166:167], v212 offset:7168
  ds_read_b64_tr_b16 a[168:169], v213 offset:4096
  v_mfma_f32_16x16x32_bf16 v[244:247], a[204:207], a[28:31], v[244:247]
  s_waitcnt lgkmcnt(7)
  buffer_store_dwordx4 v[8:11], v225, s[24:27], s48 offen offset:2048 sc1
  v_mfma_f32_16x16x32_bf16 v[216:219], a[144:147], a[32:35], v[216:219]
  ds_read_b64_tr_b16 a[170:171], v213 offset:5120
  v_cvt_pk_bf16_f32 v24, v24, v25
  v_mfma_f32_16x16x32_bf16 v[216:219], a[148:151], a[40:43], v[216:219]
  v_cvt_pk_bf16_f32 v25, v26, v27
  v_cvt_pk_bf16_f32 v26, v28, v29
  v_mfma_f32_16x16x32_bf16 v[240:243], a[144:147], a[36:39], v[240:243]
  ds_read_b64_tr_b16 a[172:173], v213 offset:6144
  v_cvt_pk_bf16_f32 v27, v30, v31
  v_mfma_f32_16x16x32_bf16 v[240:243], a[148:151], a[44:47], v[240:243]
  ds_read_b64_tr_b16 a[174:175], v213 offset:7168
  ds_read_b64_tr_b16 a[176:177], v212 offset:8192
  v_mfma_f32_16x16x32_bf16 v[220:223], a[152:155], a[32:35], v[220:223]
  s_waitcnt lgkmcnt(7)
  buffer_store_dwordx4 v[24:27], v225, s[24:27], s48 offen offset:3072 sc1
  v_mfma_f32_16x16x32_bf16 v[220:223], a[156:159], a[40:43], v[220:223]
  ds_read_b64_tr_b16 a[178:179], v212 offset:9216
  v_mfma_f32_16x16x32_bf16 v[244:247], a[152:155], a[36:39], v[244:247]
  ds_read_b64_tr_b16 a[180:181], v212 offset:10240
  v_mfma_f32_16x16x32_bf16 v[244:247], a[156:159], a[44:47], v[244:247]
L_st40:
  ds_read_b64_tr_b16 a[182:183], v212 offset:11264
  v_mfma_f32_16x16x32_bf16 v[216:219], a[160:163], a[48:51], v[216:219]
  s_waitcnt lgkmcnt(6)
  ds_read_b64_tr_b16 a[184:185], v213 offset:8192
  v_mfma_f32_16x16x32_bf16 v[216:219], a[164:167], a[56:59], v[216:219]
  ds_read_b64_tr_b16 a[186:187], v213 offset:9216
  v_mfma_f32_16x16x32_bf16 v[240:243], a[160:163], a[52:55], v[240:243]
  ds_read_b64_tr_b16 a[188:189], v213 offset:10240
  v_mfma_f32_16x16x32_bf16 v[240:243], a[164:167], a[60:63], v[240:243]
  ds_read_b64_tr_b16 a[190:191], v213 offset:11264
  v_mfma_f32_16x16x32_bf16 v[220:223], a[168:171], a[48:51], v[220:223]
  s_waitcnt lgkmcnt(8)
  v_mfma_f32_16x16x32_bf16 v[220:223], a[172:175], a[56:59], v[220:223]
  v_mfma_f32_16x16x32_bf16 v[244:247], a[168:171], a[52:55], v[244:247]
  v_mfma_f32_16x16x32_bf16 v[244:247], a[172:175], a[60:63], v[244:247]
  s_waitcnt lgkmcnt(4)
  v_mfma_f32_16x16x32_bf16 v[216:219], a[176:179], v[192:195], v[216:219]
  v_mfma_f32_16x16x32_bf16 v[216:219], a[180:183], a[64:67], v[216:219]
  v_mfma_f32_16x16x32_bf16 v[240:243], a[176:179], v[196:199], v[240:243]
  v_mfma_f32_16x16x32_bf16 v[240:243], a[180:183], a[68:71], v[240:243]
  s_waitcnt lgkmcnt(0)
  v_mfma_f32_16x16x32_bf16 v[220:223], a[184:187], v[192:195], v[220:223]
  v_mfma_f32_16x16x32_bf16 v[220:223], a[188:191], a[64:67], v[220:223]
  v_mfma_f32_16x16x32_bf16 v[244:247], a[184:187], v[196:199], v[244:247]
  v_mfma_f32_16x16x32_bf16 v[244:247], a[188:191], a[68:71], v[244:247]
  s_nop 6
  v_cvt_pk_bf16_f32 v216, v216, v217
  v_cvt_pk_bf16_f32 v217, v218, v219
  v_cvt_pk_bf16_f32 v218, v220, v221
  v_cvt_pk_bf16_f32 v219, v222, v223
  s_mov_b32 s48, s47
  buffer_store_dwordx4 v[216:219], v225, s[24:27], s48 offen sc1
  v_cvt_pk_bf16_f32 v240, v240, v241
  v_cvt_pk_bf16_f32 v241, v242, v243
  v_cvt_pk_bf16_f32 v242, v244, v245
  v_cvt_pk_bf16_f32 v243, v246, v247
  buffer_store_dwordx4 v[240:243], v225, s[24:27], s48 offen offset:1024 sc1
  s_mov_b32 s12, s88
  s_mov_b32 s13, s89
  s_mov_b32 s14, 0x240000
  s_mov_b32 s15, 0x20000
  s_mov_b32 s4, 393216
  s_mov_b32 s7, 524288
  s_add_u32 s8, s90, 131072
  buffer_load_dword v239, v251, s[60:63], s4 offen sc1
  s_mov_b32 s5, 0x3f80
  s_mov_b32 s6, 0x3f800000
  v_add_u32 v222, 8192, v248
  v_add_u32 v223, 16384, v248
  v_add_u32 v223, s51, v223
  ds_read_b128 v[192:195], v250 offset:0
  ds_read_b128 v[196:199], v250 offset:16
  ds_read_b128 v[200:203], v250 offset:512
  ds_read_b128 v[204:207], v250 offset:528
  ds_read_b128 v[208:211], v250 offset:1024
  ds_read_b128 v[212:215], v250 offset:1040
  s_waitcnt vmcnt(0)
  buffer_store_dword v252, off, s[60:63], s8 sc1
  v_cmp_ne_u32 vcc, s94, v239
  s_cbranch_vccz L_e1ok
  s_mov_b32 s96, 0
L_poll17:
  buffer_load_dword v239, v251, s[60:63], s4 offen sc1
  s_add_u32 s96, s96, 1
  s_waitcnt vmcnt(0)
  v_cmp_ne_u32 vcc, s94, v239
  s_cbranch_vccz L_pd18
  s_cmp_lt_u32 s96, 200000
  s_cbranch_scc1 L_poll17
L_pd18:
L_e1ok:
  s_mov_b32 s9, 0
  buffer_load_dwordx4 v[32:35], v248, s[24:27], s9 offen sc1
  s_add_u32 s9, s9, 2359296
  buffer_load_dwordx4 v[36:39], v248, s[24:27], s9 offen sc1
  s_add_u32 s9, s9, 2359296
  buffer_load_dwordx4 v[40:43], v248, s[24:27], s9 offen sc1
  s_add_u32 s9, s9, 2359296
  buffer_load_dwordx4 v[44:47], v248, s[24:27], s9 offen sc1
  s_add_u32 s9, s9, 2359296
  buffer_load_dwordx4 v[48:51], v248, s[24:27], s9 offen sc1
  s_add_u32 s9, s9, 2359296
  buffer_load_dwordx4 v[52:55], v248, s[24:27], s9 offen sc1
  s_add_u32 s9, s9, 2359296
  buffer_load_dwordx4 v[56:59], v248, s[24:27], s9 offen sc1
  s_add_u32 s9, s9, 2359296
  buffer_load_dwordx4 v[60:63], v248, s[24:27], s9 offen sc1
  s_mov_b32 s96, 0
L_poll19:
  buffer_load_dword v239, v251, s[60:63], s7 offen sc1
  s_add_u32 s96, s96, 1
  s_waitcnt vmcnt(0)
  v_cmp_ne_u32 vcc, s94, v239
  s_cbranch_vccz L_pd20
  s_cmp_lt_u32 s96, 200000
  s_cbranch_scc1 L_poll19
L_pd20:
  s_mov_b32 s9, 0
  buffer_load_dwordx4 v[64:67], v222, s[24:27], s9 offen sc1
  s_add_u32 s9, s9, 2359296
  buffer_load_dwordx4 v[68:71], v222, s[24:27], s9 offen sc1
  s_add_u32 s9, s9, 2359296
  buffer_load_dwordx4 v[72:75], v222, s[24:27], s9 offen sc1
  s_add_u32 s9, s9, 2359296
  buffer_load_dwordx4 v[76:79], v222, s[24:27], s9 offen sc1
  s_add_u32 s9, s9, 2359296
  buffer_load_dwordx4 v[80:83], v222, s[24:27], s9 offen sc1
  s_add_u32 s9, s9, 2359296
  buffer_load_dwordx4 v[84:87], v222, s[24:27], s9 offen sc1
  s_add_u32 s9, s9, 2359296
  buffer_load_dwordx4 v[88:91], v222, s[24:27], s9 offen sc1
  s_add_u32 s9, s9, 2359296
  buffer_load_dwordx4 v[92:95], v222, s[24:27], s9 offen sc1
  s_mov_b32 s9, 0
  buffer_load_dwordx4 v[128:131], v223, s[24:27], s9 offen sc1
  s_add_u32 s9, s9, 2359296
  buffer_load_dwordx4 v[132:135], v223, s[24:27], s9 offen sc1
  s_add_u32 s9, s9, 2359296
  buffer_load_dwordx4 v[136:139], v223, s[24:27], s9 offen sc1
  s_add_u32 s9, s9, 2359296
  buffer_load_dwordx4 v[140:143], v223, s[24:27], s9 offen sc1
  s_add_u32 s9, s9, 2359296
  buffer_load_dwordx4 v[144:147], v223, s[24:27], s9 offen sc1
  s_add_u32 s9, s9, 2359296
  buffer_load_dwordx4 v[148:151], v223, s[24:27], s9 offen sc1
  s_add_u32 s9, s9, 2359296
  buffer_load_dwordx4 v[152:155], v223, s[24:27], s9 offen sc1
  s_add_u32 s9, s9, 2359296
  buffer_load_dwordx4 v[156:159], v223, s[24:27], s9 offen sc1
  s_waitcnt lgkmcnt(0)
  v_mov_b32 v226, 0
  v_mov_b32 v227, 0
  v_mov_b32 v228, 0
  v_mov_b32 v229, 0
  v_mov_b32 v230, 0
  v_mov_b32 v231, 0
  v_mov_b32 v232, 0
  v_mov_b32 v233, 0
  v_dot2_f32_bf16 v226, v32, s5, v226
  v_dot2_f32_bf16 v227, v32, s6, v227
  v_dot2_f32_bf16 v228, v33, s5, v228
  v_dot2_f32_bf16 v229, v33, s6, v229
  v_dot2_f32_bf16 v230, v34, s5, v230
  v_dot2_f32_bf16 v231, v34, s6, v231
  v_dot2_f32_bf16 v232, v35, s5, v232
  v_dot2_f32_bf16 v233, v35, s6, v233
  v_dot2_f32_bf16 v226, v36, s5, v226
  v_dot2_f32_bf16 v227, v36, s6, v227
  v_dot2_f32_bf16 v228, v37, s5, v228
  v_dot2_f32_bf16 v229, v37, s6, v229
  v_dot2_f32_bf16 v230, v38, s5, v230
  v_dot2_f32_bf16 v231, v38, s6, v231
  v_dot2_f32_bf16 v232, v39, s5, v232
  v_dot2_f32_bf16 v233, v39, s6, v233
  v_dot2_f32_bf16 v226, v40, s5, v226
  v_dot2_f32_bf16 v227, v40, s6, v227
  v_dot2_f32_bf16 v228, v41, s5, v228
  v_dot2_f32_bf16 v229, v41, s6, v229
  v_dot2_f32_bf16 v230, v42, s5, v230
  v_dot2_f32_bf16 v231, v42, s6, v231
  v_dot2_f32_bf16 v232, v43, s5, v232
  v_dot2_f32_bf16 v233, v43, s6, v233
  v_dot2_f32_bf16 v226, v44, s5, v226
  v_dot2_f32_bf16 v227, v44, s6, v227
  v_dot2_f32_bf16 v228, v45, s5, v228
  v_dot2_f32_bf16 v229, v45, s6, v229
  v_dot2_f32_bf16 v230, v46, s5, v230
  v_dot2_f32_bf16 v231, v46, s6, v231
  v_dot2_f32_bf16 v232, v47, s5, v232
  v_dot2_f32_bf16 v233, v47, s6, v233
  v_dot2_f32_bf16 v226, v48, s5, v226
  v_dot2_f32_bf16 v227, v48, s6, v227
  v_dot2_f32_bf16 v228, v49, s5, v228
  v_dot2_f32_bf16 v229, v49, s6, v229
  v_dot2_f32_bf16 v230, v50, s5, v230
  v_dot2_f32_bf16 v231, v50, s6, v231
  v_dot2_f32_bf16 v232, v51, s5, v232
  v_dot2_f32_bf16 v233, v51, s6, v233
  v_dot2_f32_bf16 v226, v52, s5, v226
  v_dot2_f32_bf16 v227, v52, s6, v227
  v_dot2_f32_bf16 v228, v53, s5, v228
  v_dot2_f32_bf16 v229, v53, s6, v229
  v_dot2_f32_bf16 v230, v54, s5, v230
  v_dot2_f32_bf16 v231, v54, s6, v231
  v_dot2_f32_bf16 v232, v55, s5, v232
  v_dot2_f32_bf16 v233, v55, s6, v233
  v_dot2_f32_bf16 v226, v56, s5, v226
  v_dot2_f32_bf16 v227, v56, s6, v227
  v_dot2_f32_bf16 v228, v57, s5, v228
  v_dot2_f32_bf16 v229, v57, s6, v229
  v_dot2_f32_bf16 v230, v58, s5, v230
  v_dot2_f32_bf16 v231, v58, s6, v231
  v_dot2_f32_bf16 v232, v59, s5, v232
  v_dot2_f32_bf16 v233, v59, s6, v233
  v_dot2_f32_bf16 v226, v60, s5, v226
  v_dot2_f32_bf16 v227, v60, s6, v227
  v_dot2_f32_bf16 v228, v61, s5, v228
  v_dot2_f32_bf16 v229, v61, s6, v229
  v_dot2_f32_bf16 v230, v62, s5, v230
  v_dot2_f32_bf16 v231, v62, s6, v231
  v_dot2_f32_bf16 v232, v63, s5, v232
  v_dot2_f32_bf16 v233, v63, s6, v233
  v_accvgpr_read_b32 v240, a208
  v_accvgpr_read_b32 v241, a209
  v_accvgpr_read_b32 v242, a210
  v_accvgpr_read_b32 v243, a211
  v_permlane32_swap_b32 v226, v230
  v_permlane32_swap_b32 v227, v231
  v_permlane32_swap_b32 v228, v232
  v_permlane32_swap_b32 v229, v233
  v_lshlrev_b32 v234, 16, v240
  v_and_b32 v235, 0xffff0000, v240
  v_pk_fma_f32 v[234:235], v[226:227], v[192:193], v[234:235]
  v_cvt_pk_bf16_f32 v244, v234, v235
  v_lshlrev_b32 v234, 16, v241
  v_and_b32 v235, 0xffff0000, v241
  v_pk_fma_f32 v[234:235], v[228:229], v[194:195], v[234:235]
  v_cvt_pk_bf16_f32 v245, v234, v235
  v_lshlrev_b32 v234, 16, v242
  v_and_b32 v235, 0xffff0000, v242
  v_pk_fma_f32 v[234:235], v[230:231], v[196:197], v[234:235]
  v_cvt_pk_bf16_f32 v246, v234, v235
  v_lshlrev_b32 v234, 16, v243
  v_and_b32 v235, 0xffff0000, v243
  v_pk_fma_f32 v[234:235], v[232:233], v[198:199], v[234:235]
  v_cvt_pk_bf16_f32 v247, v234, v235
  buffer_store_dwordx4 v[244:247], v249, s[12:15], 0 offen sc1
  s_nop 1
  v_mov_b32 v226, 0
  v_mov_b32 v227, 0
  v_mov_b32 v228, 0
  v_mov_b32 v229, 0
  v_mov_b32 v230, 0
  v_mov_b32 v231, 0
  v_mov_b32 v232, 0
  v_mov_b32 v233, 0
  s_waitcnt vmcnt(16)
  v_dot2_f32_bf16 v226, v64, s5, v226
  v_dot2_f32_bf16 v227, v64, s6, v227
  v_dot2_f32_bf16 v228, v65, s5, v228
  v_dot2_f32_bf16 v229, v65, s6, v229
  v_dot2_f32_bf16 v230, v66, s5, v230
  v_dot2_f32_bf16 v231, v66, s6, v231
  v_dot2_f32_bf16 v232, v67, s5, v232
  v_dot2_f32_bf16 v233, v67, s6, v233
  s_waitcnt vmcnt(15)
  v_dot2_f32_bf16 v226, v68, s5, v226
  v_dot2_f32_bf16 v227, v68, s6, v227
  v_dot2_f32_bf16 v228, v69, s5, v228
  v_dot2_f32_bf16 v229, v69, s6, v229
  v_dot2_f32_bf16 v230, v70, s5, v230
  v_dot2_f32_bf16 v231, v70, s6, v231
  v_dot2_f32_bf16 v232, v71, s5, v232
  v_dot2_f32_bf16 v233, v71, s6, v233
  s_waitcnt vmcnt(14)
  v_dot2_f32_bf16 v226, v72, s5, v226
  v_dot2_f32_bf16 v227, v72, s6, v227
  v_dot2_f32_bf16 v228, v73, s5, v228
  v_dot2_f32_bf16 v229, v73, s6, v229
  v_dot2_f32_bf16 v230, v74, s5, v230
  v_dot2_f32_bf16 v231, v74, s6, v231
  v_dot2_f32_bf16 v232, v75, s5, v232
  v_dot2_f32_bf16 v233, v75, s6, v233
  s_waitcnt vmcnt(13)
  v_dot2_f32_bf16 v226, v76, s5, v226
  v_dot2_f32_bf16 v227, v76, s6, v227
  v_dot2_f32_bf16 v228, v77, s5, v228
  v_dot2_f32_bf16 v229, v77, s6, v229
  v_dot2_f32_bf16 v230, v78, s5, v230
  v_dot2_f32_bf16 v231, v78, s6, v231
  v_dot2_f32_bf16 v232, v79, s5, v232
  v_dot2_f32_bf16 v233, v79, s6, v233
  s_waitcnt vmcnt(12)
  v_dot2_f32_bf16 v226, v80, s5, v226
  v_dot2_f32_bf16 v227, v80, s6, v227
  v_dot2_f32_bf16 v228, v81, s5, v228
  v_dot2_f32_bf16 v229, v81, s6, v229
  v_dot2_f32_bf16 v230, v82, s5, v230
  v_dot2_f32_bf16 v231, v82, s6, v231
  v_dot2_f32_bf16 v232, v83, s5, v232
  v_dot2_f32_bf16 v233, v83, s6, v233
  s_waitcnt vmcnt(11)
  v_dot2_f32_bf16 v226, v84, s5, v226
  v_dot2_f32_bf16 v227, v84, s6, v227
  v_dot2_f32_bf16 v228, v85, s5, v228
  v_dot2_f32_bf16 v229, v85, s6, v229
  v_dot2_f32_bf16 v230, v86, s5, v230
  v_dot2_f32_bf16 v231, v86, s6, v231
  v_dot2_f32_bf16 v232, v87, s5, v232
  v_dot2_f32_bf16 v233, v87, s6, v233
  s_waitcnt vmcnt(10)
  v_dot2_f32_bf16 v226, v88, s5, v226
  v_dot2_f32_bf16 v227, v88, s6, v227
  v_dot2_f32_bf16 v228, v89, s5, v228
  v_dot2_f32_bf16 v229, v89, s6, v229
  v_dot2_f32_bf16 v230, v90, s5, v230
  v_dot2_f32_bf16 v231, v90, s6, v231
  v_dot2_f32_bf16 v232, v91, s5, v232
  v_dot2_f32_bf16 v233, v91, s6, v233
  s_waitcnt vmcnt(9)
  v_dot2_f32_bf16 v226, v92, s5, v226
  v_dot2_f32_bf16 v227, v92, s6, v227
  v_dot2_f32_bf16 v228, v93, s5, v228
  v_dot2_f32_bf16 v229, v93, s6, v229
  v_dot2_f32_bf16 v230, v94, s5, v230
  v_dot2_f32_bf16 v231, v94, s6, v231
  v_dot2_f32_bf16 v232, v95, s5, v232
  v_dot2_f32_bf16 v233, v95, s6, v233
  v_accvgpr_read_b32 v240, a212
  v_accvgpr_read_b32 v241, a213
  v_accvgpr_read_b32 v242, a214
  v_accvgpr_read_b32 v243, a215
  v_permlane32_swap_b32 v226, v230
  v_permlane32_swap_b32 v227, v231
  v_permlane32_swap_b32 v228, v232
  v_permlane32_swap_b32 v229, v233
  v_lshlrev_b32 v234, 16, v240
  v_and_b32 v235, 0xffff0000, v240
  v_pk_fma_f32 v[234:235], v[226:227], v[200:201], v[234:235]
  v_cvt_pk_bf16_f32 v244, v234, v235
  v_lshlrev_b32 v234, 16, v241
  v_and_b32 v235, 0xffff0000, v241
  v_pk_fma_f32 v[234:235], v[228:229], v[202:203], v[234:235]
  v_cvt_pk_bf16_f32 v245, v234, v235
  v_lshlrev_b32 v234, 16, v242
  v_and_b32 v235, 0xffff0000, v242
  v_pk_fma_f32 v[234:235], v[230:231], v[204:205], v[234:235]
  v_cvt_pk_bf16_f32 v246, v234, v235
  v_lshlrev_b32 v234, 16, v243
  v_and_b32 v235, 0xffff0000, v243
  v_pk_fma_f32 v[234:235], v[232:233], v[206:207], v[234:235]
  v_cvt_pk_bf16_f32 v247, v234, v235
  buffer_store_dwordx4 v[244:247], v249, s[12:15], 0 offen offset:256 sc1
  s_nop 1
  v_mov_b32 v226, 0
  v_mov_b32 v227, 0
  v_mov_b32 v228, 0
  v_mov_b32 v229, 0
  v_mov_b32 v230, 0
  v_mov_b32 v231, 0
  v_mov_b32 v232, 0
  v_mov_b32 v233, 0
  s_waitcnt vmcnt(9)
  v_dot2_f32_bf16 v226, v128, s5, v226
  v_dot2_f32_bf16 v227, v128, s6, v227
  v_dot2_f32_bf16 v228, v129, s5, v228
  v_dot2_f32_bf16 v229, v129, s6, v229
  v_dot2_f32_bf16 v230, v130, s5, v230
  v_dot2_f32_bf16 v231, v130, s6, v231
  v_dot2_f32_bf16 v232, v131, s5, v232
  v_dot2_f32_bf16 v233, v131, s6, v233
  s_waitcnt vmcnt(8)
  v_dot2_f32_bf16 v226, v132, s5, v226
  v_dot2_f32_bf16 v227, v132, s6, v227
  v_dot2_f32_bf16 v228, v133, s5, v228
  v_dot2_f32_bf16 v229, v133, s6, v229
  v_dot2_f32_bf16 v230, v134, s5, v230
  v_dot2_f32_bf16 v231, v134, s6, v231
  v_dot2_f32_bf16 v232, v135, s5, v232
  v_dot2_f32_bf16 v233, v135, s6, v233
  s_waitcnt vmcnt(7)
  v_dot2_f32_bf16 v226, v136, s5, v226
  v_dot2_f32_bf16 v227, v136, s6, v227
  v_dot2_f32_bf16 v228, v137, s5, v228
  v_dot2_f32_bf16 v229, v137, s6, v229
  v_dot2_f32_bf16 v230, v138, s5, v230
  v_dot2_f32_bf16 v231, v138, s6, v231
  v_dot2_f32_bf16 v232, v139, s5, v232
  v_dot2_f32_bf16 v233, v139, s6, v233
  s_waitcnt vmcnt(6)
  v_dot2_f32_bf16 v226, v140, s5, v226
  v_dot2_f32_bf16 v227, v140, s6, v227
  v_dot2_f32_bf16 v228, v141, s5, v228
  v_dot2_f32_bf16 v229, v141, s6, v229
  v_dot2_f32_bf16 v230, v142, s5, v230
  v_dot2_f32_bf16 v231, v142, s6, v231
  v_dot2_f32_bf16 v232, v143, s5, v232
  v_dot2_f32_bf16 v233, v143, s6, v233
  s_waitcnt vmcnt(5)
  v_dot2_f32_bf16 v226, v144, s5, v226
  v_dot2_f32_bf16 v227, v144, s6, v227
  v_dot2_f32_bf16 v228, v145, s5, v228
  v_dot2_f32_bf16 v229, v145, s6, v229
  v_dot2_f32_bf16 v230, v146, s5, v230
  v_dot2_f32_bf16 v231, v146, s6, v231
  v_dot2_f32_bf16 v232, v147, s5, v232
  v_dot2_f32_bf16 v233, v147, s6, v233
  s_waitcnt vmcnt(4)
  v_dot2_f32_bf16 v226, v148, s5, v226
  v_dot2_f32_bf16 v227, v148, s6, v227
  v_dot2_f32_bf16 v228, v149, s5, v228
  v_dot2_f32_bf16 v229, v149, s6, v229
  v_dot2_f32_bf16 v230, v150, s5, v230
  v_dot2_f32_bf16 v231, v150, s6, v231
  v_dot2_f32_bf16 v232, v151, s5, v232
  v_dot2_f32_bf16 v233, v151, s6, v233
  s_waitcnt vmcnt(3)
  v_dot2_f32_bf16 v226, v152, s5, v226
  v_dot2_f32_bf16 v227, v152, s6, v227
  v_dot2_f32_bf16 v228, v153, s5, v228
  v_dot2_f32_bf16 v229, v153, s6, v229
  v_dot2_f32_bf16 v230, v154, s5, v230
  v_dot2_f32_bf16 v231, v154, s6, v231
  v_dot2_f32_bf16 v232, v155, s5, v232
  v_dot2_f32_bf16 v233, v155, s6, v233
  s_waitcnt vmcnt(2)
  v_dot2_f32_bf16 v226, v156, s5, v226
  v_dot2_f32_bf16 v227, v156, s6, v227
  v_dot2_f32_bf16 v228, v157, s5, v228
  v_dot2_f32_bf16 v229, v157, s6, v229
  v_dot2_f32_bf16 v230, v158, s5, v230
  v_dot2_f32_bf16 v231, v158, s6, v231
  v_dot2_f32_bf16 v232, v159, s5, v232
  v_dot2_f32_bf16 v233, v159, s6, v233
  v_accvgpr_read_b32 v240, a216
  v_accvgpr_read_b32 v241, a217
  v_accvgpr_read_b32 v242, a218
  v_accvgpr_read_b32 v243, a219
  v_permlane32_swap_b32 v226, v230
  v_permlane32_swap_b32 v227, v231
  v_permlane32_swap_b32 v228, v232
  v_permlane32_swap_b32 v229, v233
  v_lshlrev_b32 v234, 16, v240
  v_and_b32 v235, 0xffff0000, v240
  v_pk_fma_f32 v[234:235], v[226:227], v[208:209], v[234:235]
  v_cvt_pk_bf16_f32 v244, v234, v235
  v_lshlrev_b32 v234, 16, v241
  v_and_b32 v235, 0xffff0000, v241
  v_pk_fma_f32 v[234:235], v[228:229], v[210:211], v[234:235]
  v_cvt_pk_bf16_f32 v245, v234, v235
  v_lshlrev_b32 v234, 16, v242
  v_and_b32 v235, 0xffff0000, v242
  v_pk_fma_f32 v[234:235], v[230:231], v[212:213], v[234:235]
  v_cvt_pk_bf16_f32 v246, v234, v235
  v_lshlrev_b32 v234, 16, v243
  v_and_b32 v235, 0xffff0000, v243
  v_pk_fma_f32 v[234:235], v[232:233], v[214:215], v[234:235]
  v_cvt_pk_bf16_f32 v247, v234, v235
  buffer_store_dwordx4 v[244:247], v249, s[12:15], s51 offen offset:512 sc1
  s_nop 1
  s_cmp_lg_u32 s2, 0
  s_cbranch_scc1 L_noep
  s_cmp_lg_u32 s95, 0
  s_cbranch_scc1 L_noep
  s_add_u32 s20, s92, 0xa00000
  s_addc_u32 s21, s93, 0
  s_mov_b32 s22, 0x4
  s_mov_b32 s23, 0x20000
  v_mov_b32 v239, s94
  s_mov_b64 exec, 1
  buffer_store_dword v239, off, s[20:23], 0 sc1
  s_mov_b64 exec, -1
L_noep:
L_end:
  s_endpgm
L_code_end:
.section .rodata,"a"
.p2align 6
.amdhsa_kernel adaLN_cond__ssm_conv_h3__glu_gated_geglu__prompt_kernel
  .amdhsa_next_free_vgpr 476
  .amdhsa_next_free_sgpr 102
  .amdhsa_accum_offset 256
  .amdhsa_group_segment_fixed_size 0
  .amdhsa_kernarg_size 120
  .amdhsa_user_sgpr_count 2
  .amdhsa_user_sgpr_kernarg_segment_ptr 1
  .amdhsa_system_sgpr_workgroup_id_x 1
  .amdhsa_float_denorm_mode_32 3
.end_amdhsa_kernel
```
